```python
import torch

def _softmax(x, axis=-1):
    return torch.softmax(x, dim=axis)

def _gelu(x):
    return torch.nn.functional.gelu(x, approximate='tanh')

def _silu(x):
    return torch.nn.functional.silu(x)

def _sigmoid(x):
    return torch.sigmoid(x)

def _layernorm(x, axis=-1, eps=1e-05):
    m = x.mean(dim=axis, keepdim=True)
    v = x.var(dim=axis, keepdim=True, unbiased=False)
    return (x - m) / torch.sqrt(v + eps)

def _scatter_add(tgt, idx, src, axis=0):
    return tgt.clone().index_add_(axis, idx, src)

def _segment_sum(src, seg, n):
    out = torch.zeros((n,) + src.shape[1:], dtype=src.dtype)
    return out.index_add_(0, seg, src)

def _pad(x, pw):
    flat = tuple((v for pair in reversed(pw) for v in pair))
    return torch.nn.functional.pad(x, flat)
kernel_name = 'adaLN_cond__ssm_conv_h3__glu_gated_reglu__prompt'

def setup_inputs():

    _w = lambda a: (lambda t: t.to(torch.bfloat16) if t.is_floating_point() else t)(torch.as_tensor(a))

    def _A_setup():
        B, S, D = (1, 2048, 640)
        ks = 4
        return {'q': _w((lambda *s: torch.randn(*s, dtype=torch.bfloat16) * 0.05)(B, S, D)), 'k': _w((lambda *s: torch.randn(*s, dtype=torch.bfloat16) * 0.8)(B, S, D)), 'v': _w((lambda *s: torch.randn(*s, dtype=torch.bfloat16) * 0.8)(B, S, D)), 'shift_k': _w((lambda *s: torch.randn(*s, dtype=torch.bfloat16) * 0.8)(D, ks) * 0.5), 'ssm_k': _w((lambda *s: torch.randn(*s, dtype=torch.bfloat16) * 0.8)(D, S) * (1.0 / S ** 0.5)), 'ssm_D': _w((lambda *s: torch.randn(*s, dtype=torch.bfloat16) * 0.8)(D))}
    _A_in = _A_setup()

    def _B_setup():
        B, S, D, F = (1, 2048, 640, 1536)
        return {'x': _w((lambda *s: torch.randn(*s, dtype=torch.bfloat16) * 0.05)(B, S, D)), 'W_gate': _w((lambda *s: torch.randn(*s, dtype=torch.bfloat16) * 0.8)(D, F) * (2.0 / D) ** 0.5), 'W_up': _w((lambda *s: torch.randn(*s, dtype=torch.bfloat16) * 0.8)(D, F) * (2.0 / D) ** 0.5), 'W_down': _w((lambda *s: torch.randn(*s, dtype=torch.bfloat16) * 0.8)(F, D) * (1.0 / F) ** 0.5)}
    _B_in = _B_setup()
    return {'A_q': _A_in['q'], 'A_k': _A_in['k'], 'A_v': _A_in['v'], 'A_shift_k': _A_in['shift_k'], 'A_ssm_k': _A_in['ssm_k'], 'A_ssm_D': _A_in['ssm_D'], 'B_x': _B_in['x'], 'B_W_gate': _B_in['W_gate'], 'B_W_up': _B_in['W_up'], 'B_W_down': _B_in['W_down'], 'c': _w((lambda *s: torch.randn(*s, dtype=torch.bfloat16) * 0.2)(1, 640) * 8.0), 'w_mod': _w((lambda *s: torch.randn(*s, dtype=torch.bfloat16) * 0.2)(640, 6 * 640) * 640 ** (-0.5) * 8.0)}

def reference(A_q, A_k, A_v, A_shift_k, A_ssm_k, A_ssm_D, B_x, B_W_gate, B_W_up, B_W_down, c, w_mod):

    def _A_ref(q, k, v, shift_k, ssm_k, ssm_D):
        B, S, D = q.shape
        ks = shift_k.shape[-1]
        k_pad = _pad(k, ((0, 0), (ks - 1, 0), (0, 0)))
        k_shift = torch.zeros_like(k)
        for t in range(ks):
            k_shift = k_shift + k_pad[:, t:t + S, :] * shift_k[:, ks - 1 - t][None, None, :]
        kv = k_shift * v
        L = 2 * S
        kv_pad = _pad(kv, ((0, 0), (0, S), (0, 0)))
        kf_pad = _pad(ssm_k, ((0, 0), (0, S)))
        kv_f = (lambda x, axes=(-2, -1): torch.fft.rfft2(x.float(), dim=axes))(kv_pad[:, None, :, :], axes=(1, 2))
        kf_f = (lambda x, axes=(-2, -1): torch.fft.rfft2(x.float(), dim=axes))(kf_pad[:, None, :], axes=(1, 2))
        kf_f = (lambda x, *d: x.permute(*d))(kf_f, 1, 2, 0)
        y_f = kv_f * kf_f[None, :, :, :]
        y = (lambda x, s, axes=(-2, -1): torch.fft.irfft2(x, s=s, dim=axes).to(torch.bfloat16))(y_f, (1, L), axes=(1, 2))[:, 0, :S, :]
        y = y + kv * ssm_D[None, None, :]
        return q * y

    def _B_ref(x, W_gate, W_up, W_down):
        gate = torch.einsum('bsd,df->bsf', x, W_gate)
        up = torch.einsum('bsd,df->bsf', x, W_up)
        gate = gate * (lambda x, dt: x.to(dt))(gate > 0, gate.dtype)
        h = gate * up
        return torch.einsum('bsf,fd->bsd', h, W_down)
    x = A_q
    mod = (_silu(c) @ w_mod).reshape(c.shape[0], 6, 1, -1)
    sa, ca, ga, sb, cb, gb = (mod[:, 0].clone(), mod[:, 1].clone(), mod[:, 2].clone(), mod[:, 3].clone(), mod[:, 4].clone(), mod[:, 5].clone())
    h = _layernorm(x, axis=-1) * (1 + ca) + sa
    x = x + ga * _A_ref(h, A_k, A_v, A_shift_k, A_ssm_k, A_ssm_D)
    h = _layernorm(x, axis=-1) * (1 + cb) + sb
    x = x + gb * _B_ref(h, B_W_gate, B_W_up, B_W_down)
    return x
```

```asm
; @launch grid=(256,1,1) block=(256,1,1) lds=163840
.amdgcn_target "amdgcn-amd-amdhsa--gfx950"
.text
.globl adaLN_cond__ssm_conv_h3__glu_gated_reglu__prompt_kernel
.p2align 8
.type adaLN_cond__ssm_conv_h3__glu_gated_reglu__prompt_kernel,@function
adaLN_cond__ssm_conv_h3__glu_gated_reglu__prompt_kernel:
    s_cmp_ge_u32 s2, 256
    s_cbranch_scc1 L_end
    s_load_dwordx2 s[40:41], s[0:1], 8
    s_load_dwordx2 s[44:45], s[0:1], 16
    s_load_dwordx2 s[56:57], s[0:1], 112
    s_load_dwordx16 s[8:23], s[0:1], 0
    s_load_dwordx8 s[24:31], s[0:1], 64
    s_load_dwordx4 s[32:35], s[0:1], 96
    s_getpc_b64 s[74:75]
L_pc:
    s_lshr_b32 s4, s2, 3
    v_lshl_add_u32 v9, v0, 5, s4
    v_cmp_gt_u32 vcc, (L_codeend-L_pc)/128, v9
    v_lshlrev_b32 v9, 7, v9
    s_and_saveexec_b64 s[76:77], vcc
    s_cbranch_execz L_nopf
    global_load_dword v126, v9, s[74:75]
L_nopf:
    s_mov_b64 exec, -1
    v_lshrrev_b32 v6, 6, v0
    s_and_b32 s3, s2, 7
    v_readfirstlane_b32 s5, v6
    s_lshr_b32 s4, s2, 3
    s_mul_i32 s65, s4, 81920
    s_mul_i32 s66, s3, 160
    s_add_u32 s65, s65, s66
    s_sub_u32 s66, s65, 5120
    s_lshl_b32 s67, s5, 10
    s_mov_b32 s42, 2621440
    s_mov_b32 s43, 0x20000
    s_mov_b32 s46, s42
    s_mov_b32 s47, 0x20000
    s_mov_b32 s58, 25165824
    s_mov_b32 s59, 0x20000
    v_mul_u32_u24 v7, 6554, v0
    v_lshrrev_b32 v7, 16, v7
    v_mul_u32_u24 v7, 1120, v7
    v_lshl_add_u32 v16, v0, 4, v7
    v_add_u32 v20, s66, v16
    v_add_u32 v6, 192, v0
    v_mul_u32_u24 v7, 6554, v6
    v_lshrrev_b32 v7, 16, v7
    v_mul_u32_u24 v7, 1120, v7
    v_lshl_add_u32 v17, v6, 4, v7
    v_add_u32 v21, s66, v17
    v_add_u32 v6, 384, v0
    v_mul_u32_u24 v7, 6554, v6
    v_lshrrev_b32 v7, 16, v7
    v_mul_u32_u24 v7, 1120, v7
    v_lshl_add_u32 v18, v6, 4, v7
    v_add_u32 v22, s66, v18
    v_add_u32 v6, 576, v0
    v_mul_u32_u24 v7, 6554, v6
    v_lshrrev_b32 v7, 16, v7
    v_mul_u32_u24 v7, 1120, v7
    v_lshl_add_u32 v19, v6, 4, v7
    v_add_u32 v23, s66, v19
    v_and_b32 v1, 63, v0
    v_lshlrev_b32 v2, 4, v1
    v_mov_b32 v10, 0
    v_mov_b32 v11, 0
    s_lshl_b32 s63, s3, 15
    s_add_u32 s63, s63, 3145728
    s_cmp_lg_u32 s5, 3
    s_waitcnt lgkmcnt(0)
    s_cbranch_scc1 L_go
    s_cmp_lg_u32 s4, 0
    s_cbranch_scc1 L_b0
    s_mov_b32 s52, s34
    s_mov_b32 s53, s35
    s_mov_b32 s54, 256
    s_mov_b32 s55, 0x20000
    s_mov_b32 s73, 3080192
    buffer_load_dword v253, v10, s[56:59], s73 offen sc1
    s_getreg_b32 s78, hwreg(HW_REG_XCC_ID, 0, 3)
    s_or_b32 s78, s78, 0x80
    s_lshl_b32 s72, s3, 2
    v_mov_b32 v14, s78
    v_lshlrev_b32 v15, 26, v1
    buffer_store_dword v14, v15, s[52:55], s72 offen sc1
    v_mov_b32 v252, 1
    s_cmp_lg_u32 s3, 0
    s_cbranch_scc1 L_b0
    s_waitcnt vmcnt(1)
    v_add_u32 v253, 0x9e3779b9, v253
    buffer_store_dwordx2 v[252:253], v15, s[52:55], 0 offen offset:128 sc1
    buffer_store_dword v253, v15, s[56:59], s73 offen sc1
    s_branch L_b0
L_go:
    s_add_u32 m0, s67, 0
    s_nop 0
    buffer_load_dwordx4 v20, s[40:43], 0 offen lds
    s_add_u32 m0, s67, 12288
    s_nop 0
    buffer_load_dwordx4 v16, s[44:47], s65 offen lds
    s_add_u32 m0, s67, 3072
    s_nop 0
    buffer_load_dwordx4 v21, s[40:43], 0 offen lds
    s_add_u32 m0, s67, 15360
    s_nop 0
    buffer_load_dwordx4 v17, s[44:47], s65 offen lds
    s_add_u32 m0, s67, 6144
    s_nop 0
    buffer_load_dwordx4 v22, s[40:43], 0 offen lds
    s_add_u32 m0, s67, 18432
    s_nop 0
    buffer_load_dwordx4 v18, s[44:47], s65 offen lds
    s_cmp_ge_u32 s5, 2
    s_cbranch_scc1 L_kvdma_done
    s_add_u32 m0, s67, 9216
    s_nop 0
    buffer_load_dwordx4 v23, s[40:43], 0 offen lds
    s_cmp_ge_u32 s5, 1
    s_cbranch_scc1 L_kvdma_done
    s_add_u32 m0, s67, 21504
    s_nop 0
    buffer_load_dwordx4 v19, s[44:47], s65 offen lds
L_kvdma_done:
    s_mov_b32 s48, s14
    s_mov_b32 s49, s15
    s_mov_b32 s50, 5120
    s_mov_b32 s51, 0x20000
    v_and_b32 v6, 15, v1
    s_mul_i32 s68, s3, 80
    s_lshl_b32 s69, s5, 4
    s_add_u32 s69, s69, s68
    v_add_u32 v6, s69, v6
    v_lshlrev_b32 v7, 3, v6
    buffer_load_dwordx2 v[16:17], v7, s[48:51], 0 offen
    buffer_load_dwordx2 v[18:19], v7, s[48:51], 0 offen offset:384
L_b0:
    s_lshr_b32 s60, s4, 3
    s_and_b32 s61, s4, 7
    s_mov_b32 s7, 0x200000
    s_mov_b32 s64, 0xffff0000
    s_mov_b32 s6, 0
    v_lshrrev_b32 v3, 4, v1
    v_bfe_u32 v4, v1, 2, 2
    v_and_b32 v5, 3, v1
    v_mov_b32 v25, 1
    s_barrier
    s_cmp_eq_u32 s5, 3
    s_cbranch_scc1 L_w3
    s_mov_b32 s40, s16
    s_mov_b32 s41, s17
    s_mov_b32 s42, 2621440
    s_mov_b32 s43, 0x20000
    s_mov_b32 s44, s18
    s_mov_b32 s45, s19
    s_mov_b32 s46, 1280
    s_mov_b32 s47, 0x20000
    s_mov_b32 s52, s34
    s_mov_b32 s53, s35
    s_mov_b32 s54, 256
    s_mov_b32 s55, 0x20000
    s_mul_i32 s70, s4, 3
    s_lshl_b32 s71, s4, 1
    s_add_u32 s71, s71, 16
    s_cmp_lt_u32 s4, 16
    s_cselect_b32 s70, s70, s71
    s_cselect_b32 s71, 2, 1
    s_min_u32 s71, s71, s5
    s_sub_u32 s81, s5, s71
    s_add_u32 s70, s70, s71
    s_lshr_b32 s72, s70, 4
    s_add_u32 s62, s70, s68
    s_lshl_b32 s73, s62, 12
    s_mul_i32 s74, s5, 4160
    s_add_u32 s74, s74, 122944
    s_mul_i32 s75, s5, 4608
    s_add_u32 s75, s75, 135872
    s_mov_b32 m0, s74
    s_lshl_b32 s76, s62, 1
    v_mov_b32 v8, 0
    v_min_u32 v9, 31, v1
    v_lshlrev_b32 v9, 7, v9
    v_mov_b32 v127, v9
    buffer_load_dword v22, v127, s[56:59], s73 offen sc1
    buffer_load_dwordx4 v2, s[40:43], s73 offen offset:0 nt lds
    buffer_load_dwordx4 v2, s[40:43], s73 offen offset:1024 nt lds
    buffer_load_dwordx4 v2, s[40:43], s73 offen offset:2048 nt lds
    buffer_load_dwordx4 v2, s[40:43], s73 offen offset:3072 nt lds
    buffer_load_ushort v20, v8, s[40:43], s73 offen
    buffer_load_ushort v21, v8, s[44:47], s76 offen
    v_lshrrev_b32 v7, 3, v1
    v_and_b32 v9, 7, v1
    v_lshlrev_b32 v23, 12, v7
    v_lshl_add_u32 v23, v9, 4, v23
    s_lshl_b32 s77, s5, 4
    s_add_u32 s77, s77, s68
    s_lshl_b32 s77, s77, 12
    s_lshl_b32 s69, s4, 7
    s_add_u32 s77, s77, s69
    s_add_u32 s80, s77, 32768
    s_mul_i32 s69, s5, 4608
    s_add_u32 s69, s69, 24576
    v_mul_u32_u24 v27, 144, v7
    v_lshl_add_u32 v27, v9, 4, v27
    v_add_u32 v27, s69, v27
    v_and_b32 v9, 15, v1
    v_mul_u32_u24 v26, 144, v9
    v_lshl_add_u32 v26, v3, 5, v26
    v_add_u32 v26, s69, v26
    v_mul_u32_u24 v24, 2560, v3
    v_mul_u32_u24 v7, 160, v4
    v_add_u32 v24, v24, v7
    v_lshl_add_u32 v24, v5, 3, v24
    s_lshl_b32 s69, s5, 5
    v_add_u32 v24, s69, v24
    v_lshlrev_b32 v7, 3, v1
    s_sub_u32 s69, s75, 512
    v_add_u32 v7, s69, v7
    ds_write_b64 v7, v[10:11]
    v_and_b32 v7, 7, v1
    s_sub_u32 s69, s74, 64
    v_lshl_add_u32 v7, v7, 3, s69
    ds_write_b64 v7, v[10:11]
    s_lshl_b32 s78, s4, 2
    s_lshl_b32 s69, s5, 8
    s_add_u32 s78, s78, s69
    s_add_u32 s78, s78, s63
    s_cmp_lt_u32 s5, 2
    s_cselect_b32 s69, 2, 1
    v_mul_u32_u24 v120, 768, v1
    v_cmp_gt_u32 vcc, s69, v1
    v_mov_b32 v10, 2130706432
    v_lshlrev_b32 v121, 2, v1
    v_cndmask_b32 v120, v10, v120, vcc
    s_lshl_b32 s72, s72, 8
    s_add_u32 s72, s72, s63
    v_lshlrev_b32 v10, 6, v3
    v_lshl_add_u32 v10, v4, 3, v10
    v_lshl_add_u32 v14, v5, 5, v10
    s_sub_u32 s69, s75, 224
    v_add_u32 v14, s69, v14
    v_lshlrev_b32 v15, 3, v5
    v_sub_u32 v15, v15, v10
    s_add_u32 s69, s74, 192
    v_add_u32 v15, s69, v15
    s_lshl_b32 s79, s62, 7
    s_add_u32 s79, s79, 4194304
    v_lshrrev_b32 v13, 3, v1
    v_mul_u32_u24 v13, 327552, v13
    v_add_u32 v13, v13, v2
    v_and_b32 v122, 15, v1
    v_min_u32 v122, 14, v122
    v_lshlrev_b32 v122, 2, v122
    v_lshl_add_u32 v122, v3, 7, v122
    s_lshl_b32 s38, s5, 9
    s_add_u32 s38, s38, s63
    s_add_u32 s38, s38, 8192
    s_getreg_b32 s39, hwreg(HW_REG_XCC_ID, 0, 3)
    s_or_b32 s39, s39, 0x80
    s_lshl_b32 s67, s3, 2
    v_and_b32 v123, 1, v1
    v_lshl_add_u32 v123, v123, 2, 64
    v_add_u32 v123, 64, v123
    v_mov_b32 v124, s67
    v_cmp_gt_u32 vcc, 2, v1
    s_nop 1
    v_cndmask_b32 v123, v124, v123, vcc
    s_waitcnt vmcnt(7)
    s_barrier
    buffer_load_dword v125, v123, s[52:55], 0 offen sc1
    ds_read_b64_tr_b16 v[28:29], v24 offset:0
    ds_read_b64_tr_b16 v[30:31], v24 offset:640
    ds_read_b64_tr_b16 v[32:33], v24 offset:1280
    ds_read_b64_tr_b16 v[34:35], v24 offset:1920
    ds_read_b64_tr_b16 v[36:37], v24 offset:2560
    ds_read_b64_tr_b16 v[38:39], v24 offset:12288
    ds_read_b64_tr_b16 v[40:41], v24 offset:12928
    ds_read_b64_tr_b16 v[42:43], v24 offset:13568
    ds_read_b64_tr_b16 v[44:45], v24 offset:14208
    v_alignbit_b32 v72, v16, v16, 16
    v_alignbit_b32 v73, v17, v17, 16
    v_and_b32 v74, 0xffff, v16
    v_bfi_b32 v75, s64, v16, v17
    v_and_b32 v76, s64, v17
    s_waitcnt lgkmcnt(4)
    v_dot2_f32_bf16 v56, v28, v76, 0
    v_dot2_f32_bf16 v57, v29, v73, 0
    v_dot2_f32_bf16 v58, v29, v76, 0
    v_dot2_f32_bf16 v59, v30, v73, 0
    v_dot2_f32_bf16 v60, v30, v76, 0
    v_dot2_f32_bf16 v61, v31, v73, 0
    v_dot2_f32_bf16 v62, v31, v76, 0
    v_dot2_f32_bf16 v63, v32, v73, 0
    v_dot2_f32_bf16 v64, v32, v76, 0
    v_dot2_f32_bf16 v65, v33, v73, 0
    v_dot2_f32_bf16 v66, v33, v76, 0
    v_dot2_f32_bf16 v67, v34, v73, 0
    v_dot2_f32_bf16 v68, v34, v76, 0
    v_dot2_f32_bf16 v69, v35, v73, 0
    v_dot2_f32_bf16 v70, v35, v76, 0
    v_dot2_f32_bf16 v71, v36, v73, 0
    v_dot2_f32_bf16 v56, v29, v75, v56
    v_dot2_f32_bf16 v57, v30, v72, v57
    v_dot2_f32_bf16 v58, v30, v75, v58
    v_dot2_f32_bf16 v59, v31, v72, v59
    v_dot2_f32_bf16 v60, v31, v75, v60
    v_dot2_f32_bf16 v61, v32, v72, v61
    v_dot2_f32_bf16 v62, v32, v75, v62
    v_dot2_f32_bf16 v63, v33, v72, v63
    v_dot2_f32_bf16 v64, v33, v75, v64
    v_dot2_f32_bf16 v65, v34, v72, v65
    v_dot2_f32_bf16 v66, v34, v75, v66
    v_dot2_f32_bf16 v67, v35, v72, v67
    v_dot2_f32_bf16 v68, v35, v75, v68
    v_dot2_f32_bf16 v69, v36, v72, v69
    v_dot2_f32_bf16 v70, v36, v75, v70
    v_dot2_f32_bf16 v71, v37, v72, v71
    v_dot2_f32_bf16 v56, v30, v74, v56
    v_dot2_f32_bf16 v58, v31, v74, v58
    v_dot2_f32_bf16 v60, v32, v74, v60
    v_dot2_f32_bf16 v62, v33, v74, v62
    v_dot2_f32_bf16 v64, v34, v74, v64
    v_dot2_f32_bf16 v66, v35, v74, v66
    v_dot2_f32_bf16 v68, v36, v74, v68
    v_dot2_f32_bf16 v70, v37, v74, v70
    s_waitcnt lgkmcnt(0)
    v_lshlrev_b32 v78, 16, v38
    v_and_b32 v79, s64, v38
    v_lshlrev_b32 v80, 16, v39
    v_and_b32 v81, s64, v39
    v_lshlrev_b32 v82, 16, v40
    v_and_b32 v83, s64, v40
    v_lshlrev_b32 v84, 16, v41
    v_and_b32 v85, s64, v41
    v_lshlrev_b32 v86, 16, v42
    v_and_b32 v87, s64, v42
    v_lshlrev_b32 v88, 16, v43
    v_and_b32 v89, s64, v43
    v_lshlrev_b32 v90, 16, v44
    v_and_b32 v91, s64, v44
    v_lshlrev_b32 v92, 16, v45
    v_and_b32 v93, s64, v45
    v_pk_mul_f32 v[56:57], v[56:57], v[78:79]
    v_pk_mul_f32 v[58:59], v[58:59], v[80:81]
    v_pk_mul_f32 v[60:61], v[60:61], v[82:83]
    v_pk_mul_f32 v[62:63], v[62:63], v[84:85]
    v_pk_mul_f32 v[64:65], v[64:65], v[86:87]
    v_pk_mul_f32 v[66:67], v[66:67], v[88:89]
    v_pk_mul_f32 v[68:69], v[68:69], v[90:91]
    v_pk_mul_f32 v[70:71], v[70:71], v[92:93]
    v_cvt_pk_bf16_f32 v48, v56, v57
    v_cvt_pk_bf16_f32 v49, v58, v59
    v_cvt_pk_bf16_f32 v50, v60, v61
    v_cvt_pk_bf16_f32 v51, v62, v63
    ds_write_b128 v26, v[48:51] offset:0
    v_cvt_pk_bf16_f32 v52, v64, v65
    v_cvt_pk_bf16_f32 v53, v66, v67
    v_cvt_pk_bf16_f32 v54, v68, v69
    v_cvt_pk_bf16_f32 v55, v70, v71
    ds_write_b128 v26, v[52:55] offset:16
    ds_read_b128 v[104:107], v27 offset:0
    ds_read_b128 v[108:111], v27 offset:1152
    s_cmp_ge_u32 s5, 2
    s_cbranch_scc1 L_kvdone
    ds_read_b64_tr_b16 v[28:29], v24 offset:96
    ds_read_b64_tr_b16 v[30:31], v24 offset:736
    ds_read_b64_tr_b16 v[32:33], v24 offset:1376
    ds_read_b64_tr_b16 v[34:35], v24 offset:2016
    ds_read_b64_tr_b16 v[36:37], v24 offset:2656
    ds_read_b64_tr_b16 v[38:39], v24 offset:12384
    ds_read_b64_tr_b16 v[40:41], v24 offset:13024
    ds_read_b64_tr_b16 v[42:43], v24 offset:13664
    ds_read_b64_tr_b16 v[44:45], v24 offset:14304
    v_alignbit_b32 v72, v18, v18, 16
    v_alignbit_b32 v73, v19, v19, 16
    v_and_b32 v74, 0xffff, v18
    v_bfi_b32 v75, s64, v18, v19
    v_and_b32 v76, s64, v19
    s_waitcnt lgkmcnt(4)
    v_dot2_f32_bf16 v56, v28, v76, 0
    v_dot2_f32_bf16 v57, v29, v73, 0
    v_dot2_f32_bf16 v58, v29, v76, 0
    v_dot2_f32_bf16 v59, v30, v73, 0
    v_dot2_f32_bf16 v60, v30, v76, 0
    v_dot2_f32_bf16 v61, v31, v73, 0
    v_dot2_f32_bf16 v62, v31, v76, 0
    v_dot2_f32_bf16 v63, v32, v73, 0
    v_dot2_f32_bf16 v64, v32, v76, 0
    v_dot2_f32_bf16 v65, v33, v73, 0
    v_dot2_f32_bf16 v66, v33, v76, 0
    v_dot2_f32_bf16 v67, v34, v73, 0
    v_dot2_f32_bf16 v68, v34, v76, 0
    v_dot2_f32_bf16 v69, v35, v73, 0
    v_dot2_f32_bf16 v70, v35, v76, 0
    v_dot2_f32_bf16 v71, v36, v73, 0
    v_dot2_f32_bf16 v56, v29, v75, v56
    v_dot2_f32_bf16 v57, v30, v72, v57
    v_dot2_f32_bf16 v58, v30, v75, v58
    v_dot2_f32_bf16 v59, v31, v72, v59
    v_dot2_f32_bf16 v60, v31, v75, v60
    v_dot2_f32_bf16 v61, v32, v72, v61
    v_dot2_f32_bf16 v62, v32, v75, v62
    v_dot2_f32_bf16 v63, v33, v72, v63
    v_dot2_f32_bf16 v64, v33, v75, v64
    v_dot2_f32_bf16 v65, v34, v72, v65
    v_dot2_f32_bf16 v66, v34, v75, v66
    v_dot2_f32_bf16 v67, v35, v72, v67
    v_dot2_f32_bf16 v68, v35, v75, v68
    v_dot2_f32_bf16 v69, v36, v72, v69
    v_dot2_f32_bf16 v70, v36, v75, v70
    v_dot2_f32_bf16 v71, v37, v72, v71
    v_dot2_f32_bf16 v56, v30, v74, v56
    v_dot2_f32_bf16 v58, v31, v74, v58
    v_dot2_f32_bf16 v60, v32, v74, v60
    v_dot2_f32_bf16 v62, v33, v74, v62
    v_dot2_f32_bf16 v64, v34, v74, v64
    v_dot2_f32_bf16 v66, v35, v74, v66
    v_dot2_f32_bf16 v68, v36, v74, v68
    v_dot2_f32_bf16 v70, v37, v74, v70
    s_waitcnt lgkmcnt(0)
    v_lshlrev_b32 v78, 16, v38
    v_and_b32 v79, s64, v38
    v_lshlrev_b32 v80, 16, v39
    v_and_b32 v81, s64, v39
    v_lshlrev_b32 v82, 16, v40
    v_and_b32 v83, s64, v40
    v_lshlrev_b32 v84, 16, v41
    v_and_b32 v85, s64, v41
    v_lshlrev_b32 v86, 16, v42
    v_and_b32 v87, s64, v42
    v_lshlrev_b32 v88, 16, v43
    v_and_b32 v89, s64, v43
    v_lshlrev_b32 v90, 16, v44
    v_and_b32 v91, s64, v44
    v_lshlrev_b32 v92, 16, v45
    v_and_b32 v93, s64, v45
    v_pk_mul_f32 v[56:57], v[56:57], v[78:79]
    v_pk_mul_f32 v[58:59], v[58:59], v[80:81]
    v_pk_mul_f32 v[60:61], v[60:61], v[82:83]
    v_pk_mul_f32 v[62:63], v[62:63], v[84:85]
    v_pk_mul_f32 v[64:65], v[64:65], v[86:87]
    v_pk_mul_f32 v[66:67], v[66:67], v[88:89]
    v_pk_mul_f32 v[68:69], v[68:69], v[90:91]
    v_pk_mul_f32 v[70:71], v[70:71], v[92:93]
    v_cvt_pk_bf16_f32 v96, v56, v57
    v_cvt_pk_bf16_f32 v97, v58, v59
    v_cvt_pk_bf16_f32 v98, v60, v61
    v_cvt_pk_bf16_f32 v99, v62, v63
    ds_write_b128 v26, v[96:99] offset:2304
    v_cvt_pk_bf16_f32 v100, v64, v65
    v_cvt_pk_bf16_f32 v101, v66, v67
    v_cvt_pk_bf16_f32 v102, v68, v69
    v_cvt_pk_bf16_f32 v103, v70, v71
    ds_write_b128 v26, v[100:103] offset:2320
    ds_read_b128 v[112:115], v27 offset:2304
    ds_read_b128 v[116:119], v27 offset:3456
L_kvdone:
    s_waitcnt vmcnt(0)
L_ldr:
    v_readlane_b32 s70, v125, 0
    v_readlane_b32 s69, v125, 2
    v_readlane_b32 s36, v125, 1
    s_mul_i32 s70, s70, s69
    s_cmp_eq_u32 s70, 0
    s_cbranch_scc1 L_ldr2
    v_mov_b32 v0, s36
    s_cmp_eq_u32 s69, s39
    s_cselect_b32 s6, 1, 2
    s_waitcnt lgkmcnt(0)
    s_cmp_lg_u32 s6, 1
    s_cbranch_scc1 L_kvslow
    buffer_store_dwordx4 v[104:107], v23, s[56:59], s77 offen
    buffer_store_dwordx4 v[108:111], v23, s[56:59], s80 offen
    s_cmp_ge_u32 s5, 2
    s_cbranch_scc1 L_kvp1
    s_add_u32 s69, s77, 196608
    s_add_u32 s70, s80, 196608
    buffer_store_dwordx4 v[112:115], v23, s[56:59], s69 offen
    buffer_store_dwordx4 v[116:119], v23, s[56:59], s70 offen
L_kvp1:
    s_waitcnt vmcnt(0)
    buffer_store_dword v0, v120, s[56:59], s78 offen
L_kvback:
    v_lshlrev_b32 v20, 16, v20
    v_lshlrev_b32 v21, 16, v21
    v_add_f32 v20, v20, v21
    v_cvt_pk_bf16_f32 v20, v20, v20
    v_mov_b32 v21, s74
    ds_write_b16 v21, v20
    s_mov_b32 m0, s75
    v_mov_b32 v84, 0
    v_mov_b32 v71, 0
    v_mov_b32 v79, 0
    buffer_load_dword v10, v121, s[56:59], s72 offen sc1
    ds_read_b64_tr_b16 a[128:129], v15 offset:32
    ds_read_b64_tr_b16 a[130:131], v15 offset:0
    ds_read_b64_tr_b16 a[132:133], v15 offset:288
    ds_read_b64_tr_b16 a[134:135], v15 offset:256
    s_waitcnt lgkmcnt(8)
    ds_read_b64_tr_b16 a[136:137], v15 offset:544
    ds_read_b64_tr_b16 a[138:139], v15 offset:512
    ds_read_b64_tr_b16 a[140:141], v15 offset:800
    ds_read_b64_tr_b16 a[142:143], v15 offset:768
    s_waitcnt lgkmcnt(8)
    ds_read_b64_tr_b16 a[144:145], v15 offset:1056
    ds_read_b64_tr_b16 a[146:147], v15 offset:1024
    ds_read_b64_tr_b16 a[148:149], v15 offset:1312
    ds_read_b64_tr_b16 a[150:151], v15 offset:1280
    s_waitcnt lgkmcnt(8)
    ds_read_b64_tr_b16 a[152:153], v15 offset:1568
    ds_read_b64_tr_b16 a[154:155], v15 offset:1536
    ds_read_b64_tr_b16 a[156:157], v15 offset:1824
    ds_read_b64_tr_b16 a[158:159], v15 offset:1792
    s_waitcnt lgkmcnt(8)
    ds_read_b64_tr_b16 a[160:161], v15 offset:2080
    ds_read_b64_tr_b16 a[162:163], v15 offset:2048
    ds_read_b64_tr_b16 a[164:165], v15 offset:2336
    ds_read_b64_tr_b16 a[166:167], v15 offset:2304
    s_waitcnt lgkmcnt(8)
    ds_read_b64_tr_b16 a[168:169], v15 offset:2592
    ds_read_b64_tr_b16 a[170:171], v15 offset:2560
    ds_read_b64_tr_b16 a[172:173], v15 offset:2848
    ds_read_b64_tr_b16 a[174:175], v15 offset:2816
    s_waitcnt lgkmcnt(8)
    ds_read_b64_tr_b16 a[176:177], v15 offset:3104
    ds_read_b64_tr_b16 a[178:179], v15 offset:3072
    ds_read_b64_tr_b16 a[180:181], v15 offset:3360
    ds_read_b64_tr_b16 a[182:183], v15 offset:3328
    s_waitcnt lgkmcnt(8)
    ds_read_b64_tr_b16 a[184:185], v15 offset:3616
    ds_read_b64_tr_b16 a[186:187], v15 offset:3584
    ds_read_b64_tr_b16 a[188:189], v15 offset:3872
    ds_read_b64_tr_b16 a[190:191], v15 offset:3840
    s_waitcnt lgkmcnt(8)
    s_waitcnt vmcnt(0)
L_l1chk:
    v_cmp_eq_u32 vcc, s36, v10
    s_mov_b32 s70, -1
    s_mov_b32 s71, 0
    s_cmp_eq_u64 vcc, s[70:71]
    s_cbranch_scc0 L_l1else
L_l1ok:
    s_cmp_eq_u32 s81, 1
    s_cbranch_scc1 L_noconv
    buffer_load_dwordx4 v2, s[56:59], s73 offen offset:0 sc1 lds
    v_mov_b32 v9, 161984
    v_mov_b32 v10, s6
    ds_write_b32 v9, v0 offset:12
    ds_write_b32 v9, v10
    buffer_load_dwordx4 v2, s[56:59], s73 offen offset:1024 sc1 lds
    buffer_load_dwordx4 v2, s[56:59], s73 offen offset:2048 sc1 lds
    buffer_load_dwordx4 v2, s[56:59], s73 offen offset:3072 sc1 lds
    s_barrier
    s_waitcnt vmcnt(3)
    ds_read_b64_tr_b16 a[0:1], v14 offset:0
    ds_read_b64_tr_b16 a[2:3], v14 offset:32
    ds_read_b64_tr_b16 a[4:5], v14 offset:128
    ds_read_b64_tr_b16 a[6:7], v14 offset:160
    ds_read_b64_tr_b16 a[8:9], v14 offset:256
    ds_read_b64_tr_b16 a[10:11], v14 offset:288
    ds_read_b64_tr_b16 a[12:13], v14 offset:384
    ds_read_b64_tr_b16 a[14:15], v14 offset:416
    s_waitcnt lgkmcnt(0)
    v_mfma_f32_16x16x32_bf16 v[40:43], a[0:3], a[132:135], 0
    ds_read_b64_tr_b16 a[16:17], v14 offset:512
    ds_read_b64_tr_b16 a[18:19], v14 offset:544
    v_mfma_f32_16x16x32_bf16 v[44:47], a[4:7], a[132:135], 0
    ds_read_b64_tr_b16 a[20:21], v14 offset:640
    ds_read_b64_tr_b16 a[22:23], v14 offset:672
    v_mfma_f32_16x16x32_bf16 v[32:35], a[0:3], a[128:131], 0
    ds_read_b64_tr_b16 a[24:25], v14 offset:768
    ds_read_b64_tr_b16 a[26:27], v14 offset:800
    v_mfma_f32_16x16x32_bf16 v[36:39], a[4:7], a[128:131], 0
    ds_read_b64_tr_b16 a[28:29], v14 offset:896
    ds_read_b64_tr_b16 a[30:31], v14 offset:928
    v_mfma_f32_16x16x32_bf16 v[40:43], a[8:11], a[128:131], v[40:43]
    v_mfma_f32_16x16x32_bf16 v[44:47], a[12:15], a[128:131], v[44:47]
    s_waitcnt lgkmcnt(0)
    v_mfma_f32_16x16x32_bf16 v[56:59], a[0:3], a[140:143], 0
    s_waitcnt vmcnt(2)
    ds_read_b64_tr_b16 a[32:33], v14 offset:1024
    ds_read_b64_tr_b16 a[34:35], v14 offset:1056
    v_mfma_f32_16x16x32_bf16 v[60:63], a[4:7], a[140:143], 0
    ds_read_b64_tr_b16 a[36:37], v14 offset:1152
    ds_read_b64_tr_b16 a[38:39], v14 offset:1184
    ds_read_b64_tr_b16 a[40:41], v14 offset:1280
    v_mfma_f32_16x16x32_bf16 v[48:51], a[0:3], a[136:139], 0
    ds_read_b64_tr_b16 a[42:43], v14 offset:1312
    ds_read_b64_tr_b16 a[44:45], v14 offset:1408
    ds_read_b64_tr_b16 a[46:47], v14 offset:1440
    v_mfma_f32_16x16x32_bf16 v[52:55], a[4:7], a[136:139], 0
    v_add_f32_dpp v64, v84, v34 wave_ror:1 row_mask:0xf bank_mask:0xf
    v_add_f32_dpp v65, v35, v38 wave_ror:1 row_mask:0xf bank_mask:0xf
    v_add_f32_dpp v66, v39, v42 wave_ror:1 row_mask:0xf bank_mask:0xf
    v_mfma_f32_16x16x32_bf16 v[56:59], a[8:11], a[136:139], v[56:59]
    v_add_f32_dpp v67, v43, v46 wave_ror:1 row_mask:0xf bank_mask:0xf
    v_add_f32_dpp v64, v35, v34 wave_shr:1 row_mask:0xf bank_mask:0xf
    v_add_f32_dpp v65, v39, v38 wave_shr:1 row_mask:0xf bank_mask:0xf
    v_mfma_f32_16x16x32_bf16 v[60:63], a[12:15], a[136:139], v[60:63]
    v_add_f32_dpp v66, v43, v42 wave_shr:1 row_mask:0xf bank_mask:0xf
    v_add_f32_dpp v67, v47, v46 wave_shr:1 row_mask:0xf bank_mask:0xf
    v_mov_b32 v84, v47
    v_mfma_f32_16x16x32_bf16 v[48:51], a[8:11], a[132:135], v[48:51]
    v_add_f32_dpp v72, v71, v33 wave_ror:1 row_mask:0xf bank_mask:0xf
    v_add_f32_dpp v73, v64, v37 wave_ror:1 row_mask:0xf bank_mask:0xf
    v_add_f32_dpp v74, v65, v41 wave_ror:1 row_mask:0xf bank_mask:0xf
    v_mfma_f32_16x16x32_bf16 v[52:55], a[12:15], a[132:135], v[52:55]
    v_add_f32_dpp v75, v66, v45 wave_ror:1 row_mask:0xf bank_mask:0xf
    v_add_f32_dpp v72, v64, v33 wave_shr:1 row_mask:0xf bank_mask:0xf
    v_add_f32_dpp v73, v65, v37 wave_shr:1 row_mask:0xf bank_mask:0xf
    v_mfma_f32_16x16x32_bf16 v[56:59], a[16:19], a[132:135], v[56:59]
    v_add_f32_dpp v74, v66, v41 wave_shr:1 row_mask:0xf bank_mask:0xf
    v_add_f32_dpp v75, v67, v45 wave_shr:1 row_mask:0xf bank_mask:0xf
    v_add_f32_dpp v80, v79, v32 wave_ror:1 row_mask:0xf bank_mask:0xf
    v_mfma_f32_16x16x32_bf16 v[60:63], a[20:23], a[132:135], v[60:63]
    v_add_f32_dpp v81, v72, v36 wave_ror:1 row_mask:0xf bank_mask:0xf
    v_add_f32_dpp v82, v73, v40 wave_ror:1 row_mask:0xf bank_mask:0xf
    v_add_f32_dpp v83, v74, v44 wave_ror:1 row_mask:0xf bank_mask:0xf
    v_mfma_f32_16x16x32_bf16 v[48:51], a[16:19], a[128:131], v[48:51]
    v_add_f32_dpp v80, v72, v32 wave_shr:1 row_mask:0xf bank_mask:0xf
    v_add_f32_dpp v81, v73, v36 wave_shr:1 row_mask:0xf bank_mask:0xf
    v_add_f32_dpp v82, v74, v40 wave_shr:1 row_mask:0xf bank_mask:0xf
    v_mfma_f32_16x16x32_bf16 v[52:55], a[20:23], a[128:131], v[52:55]
    v_add_f32_dpp v83, v75, v44 wave_shr:1 row_mask:0xf bank_mask:0xf
    v_cvt_pk_bf16_f32 v88, v80, v81
    v_cvt_pk_bf16_f32 v89, v82, v83
    v_mfma_f32_16x16x32_bf16 v[56:59], a[24:27], a[128:131], v[56:59]
    v_mfma_f32_16x16x32_bf16 v[60:63], a[28:31], a[128:131], v[60:63]
    s_waitcnt lgkmcnt(0)
    v_mfma_f32_16x16x32_bf16 v[40:43], a[0:3], a[148:151], 0
    ds_read_b64_tr_b16 a[48:49], v14 offset:1536
    ds_read_b64_tr_b16 a[50:51], v14 offset:1568
    v_mfma_f32_16x16x32_bf16 v[44:47], a[4:7], a[148:151], 0
    ds_read_b64_tr_b16 a[52:53], v14 offset:1664
    ds_read_b64_tr_b16 a[54:55], v14 offset:1696
    v_mfma_f32_16x16x32_bf16 v[32:35], a[0:3], a[144:147], 0
    ds_read_b64_tr_b16 a[56:57], v14 offset:1792
    ds_read_b64_tr_b16 a[58:59], v14 offset:1824
    v_mfma_f32_16x16x32_bf16 v[36:39], a[4:7], a[144:147], 0
    ds_read_b64_tr_b16 a[60:61], v14 offset:1920
    ds_read_b64_tr_b16 a[62:63], v14 offset:1952
    v_mfma_f32_16x16x32_bf16 v[40:43], a[8:11], a[144:147], v[40:43]
    v_add_f32_dpp v68, v84, v50 wave_ror:1 row_mask:0xf bank_mask:0xf
    v_add_f32_dpp v69, v51, v54 wave_ror:1 row_mask:0xf bank_mask:0xf
    v_mfma_f32_16x16x32_bf16 v[44:47], a[12:15], a[144:147], v[44:47]
    v_add_f32_dpp v70, v55, v58 wave_ror:1 row_mask:0xf bank_mask:0xf
    v_add_f32_dpp v71, v59, v62 wave_ror:1 row_mask:0xf bank_mask:0xf
    v_mfma_f32_16x16x32_bf16 v[32:35], a[8:11], a[140:143], v[32:35]
    v_add_f32_dpp v68, v51, v50 wave_shr:1 row_mask:0xf bank_mask:0xf
    v_add_f32_dpp v69, v55, v54 wave_shr:1 row_mask:0xf bank_mask:0xf
    v_mfma_f32_16x16x32_bf16 v[36:39], a[12:15], a[140:143], v[36:39]
    v_add_f32_dpp v70, v59, v58 wave_shr:1 row_mask:0xf bank_mask:0xf
    v_add_f32_dpp v71, v63, v62 wave_shr:1 row_mask:0xf bank_mask:0xf
    v_mfma_f32_16x16x32_bf16 v[40:43], a[16:19], a[140:143], v[40:43]
    v_mov_b32 v84, v63
    v_add_f32_dpp v76, v67, v49 wave_ror:1 row_mask:0xf bank_mask:0xf
    v_mfma_f32_16x16x32_bf16 v[44:47], a[20:23], a[140:143], v[44:47]
    v_add_f32_dpp v77, v68, v53 wave_ror:1 row_mask:0xf bank_mask:0xf
    v_add_f32_dpp v78, v69, v57 wave_ror:1 row_mask:0xf bank_mask:0xf
    v_mfma_f32_16x16x32_bf16 v[32:35], a[16:19], a[136:139], v[32:35]
    v_add_f32_dpp v79, v70, v61 wave_ror:1 row_mask:0xf bank_mask:0xf
    v_add_f32_dpp v76, v68, v49 wave_shr:1 row_mask:0xf bank_mask:0xf
    v_mfma_f32_16x16x32_bf16 v[36:39], a[20:23], a[136:139], v[36:39]
    v_add_f32_dpp v77, v69, v53 wave_shr:1 row_mask:0xf bank_mask:0xf
    v_add_f32_dpp v78, v70, v57 wave_shr:1 row_mask:0xf bank_mask:0xf
    v_mfma_f32_16x16x32_bf16 v[40:43], a[24:27], a[136:139], v[40:43]
    v_add_f32_dpp v79, v71, v61 wave_shr:1 row_mask:0xf bank_mask:0xf
    v_add_f32_dpp v80, v75, v48 wave_ror:1 row_mask:0xf bank_mask:0xf
    v_mfma_f32_16x16x32_bf16 v[44:47], a[28:31], a[136:139], v[44:47]
    v_add_f32_dpp v81, v76, v52 wave_ror:1 row_mask:0xf bank_mask:0xf
    v_add_f32_dpp v82, v77, v56 wave_ror:1 row_mask:0xf bank_mask:0xf
    v_mfma_f32_16x16x32_bf16 v[32:35], a[24:27], a[132:135], v[32:35]
    v_add_f32_dpp v83, v78, v60 wave_ror:1 row_mask:0xf bank_mask:0xf
    v_add_f32_dpp v80, v76, v48 wave_shr:1 row_mask:0xf bank_mask:0xf
    v_mfma_f32_16x16x32_bf16 v[36:39], a[28:31], a[132:135], v[36:39]
    v_add_f32_dpp v81, v77, v52 wave_shr:1 row_mask:0xf bank_mask:0xf
    v_add_f32_dpp v82, v78, v56 wave_shr:1 row_mask:0xf bank_mask:0xf
    v_mfma_f32_16x16x32_bf16 v[40:43], a[32:35], a[132:135], v[40:43]
    v_add_f32_dpp v83, v79, v60 wave_shr:1 row_mask:0xf bank_mask:0xf
    v_cvt_pk_bf16_f32 v90, v80, v81
    v_mfma_f32_16x16x32_bf16 v[44:47], a[36:39], a[132:135], v[44:47]
    v_cvt_pk_bf16_f32 v91, v82, v83
    buffer_store_dwordx4 v[88:91], v13, s[56:59], s79 offen sc1
    v_mfma_f32_16x16x32_bf16 v[32:35], a[32:35], a[128:131], v[32:35]
    s_add_u32 s79, s79, 81920
    v_mfma_f32_16x16x32_bf16 v[36:39], a[36:39], a[128:131], v[36:39]
    v_mfma_f32_16x16x32_bf16 v[40:43], a[40:43], a[128:131], v[40:43]
    v_mfma_f32_16x16x32_bf16 v[44:47], a[44:47], a[128:131], v[44:47]
    s_waitcnt lgkmcnt(0)
    v_mfma_f32_16x16x32_bf16 v[56:59], a[0:3], a[156:159], 0
    s_waitcnt vmcnt(2)
    ds_read_b64_tr_b16 a[64:65], v14 offset:2048
    v_mfma_f32_16x16x32_bf16 v[60:63], a[4:7], a[156:159], 0
    ds_read_b64_tr_b16 a[66:67], v14 offset:2080
    ds_read_b64_tr_b16 a[68:69], v14 offset:2176
    v_mfma_f32_16x16x32_bf16 v[48:51], a[0:3], a[152:155], 0
    ds_read_b64_tr_b16 a[70:71], v14 offset:2208
    ds_read_b64_tr_b16 a[72:73], v14 offset:2304
    v_mfma_f32_16x16x32_bf16 v[52:55], a[4:7], a[152:155], 0
    ds_read_b64_tr_b16 a[74:75], v14 offset:2336
    ds_read_b64_tr_b16 a[76:77], v14 offset:2432
    v_mfma_f32_16x16x32_bf16 v[56:59], a[8:11], a[152:155], v[56:59]
    ds_read_b64_tr_b16 a[78:79], v14 offset:2464
    v_add_f32_dpp v64, v84, v34 wave_ror:1 row_mask:0xf bank_mask:0xf
    v_mfma_f32_16x16x32_bf16 v[60:63], a[12:15], a[152:155], v[60:63]
    v_add_f32_dpp v65, v35, v38 wave_ror:1 row_mask:0xf bank_mask:0xf
    v_add_f32_dpp v66, v39, v42 wave_ror:1 row_mask:0xf bank_mask:0xf
    v_mfma_f32_16x16x32_bf16 v[48:51], a[8:11], a[148:151], v[48:51]
    v_add_f32_dpp v67, v43, v46 wave_ror:1 row_mask:0xf bank_mask:0xf
    v_add_f32_dpp v64, v35, v34 wave_shr:1 row_mask:0xf bank_mask:0xf
    v_mfma_f32_16x16x32_bf16 v[52:55], a[12:15], a[148:151], v[52:55]
    v_add_f32_dpp v65, v39, v38 wave_shr:1 row_mask:0xf bank_mask:0xf
    v_add_f32_dpp v66, v43, v42 wave_shr:1 row_mask:0xf bank_mask:0xf
    v_mfma_f32_16x16x32_bf16 v[56:59], a[16:19], a[148:151], v[56:59]
    v_add_f32_dpp v67, v47, v46 wave_shr:1 row_mask:0xf bank_mask:0xf
    v_mov_b32 v84, v47
    v_mfma_f32_16x16x32_bf16 v[60:63], a[20:23], a[148:151], v[60:63]
    v_add_f32_dpp v72, v71, v33 wave_ror:1 row_mask:0xf bank_mask:0xf
    v_add_f32_dpp v73, v64, v37 wave_ror:1 row_mask:0xf bank_mask:0xf
    v_mfma_f32_16x16x32_bf16 v[48:51], a[16:19], a[144:147], v[48:51]
    v_add_f32_dpp v74, v65, v41 wave_ror:1 row_mask:0xf bank_mask:0xf
    v_add_f32_dpp v75, v66, v45 wave_ror:1 row_mask:0xf bank_mask:0xf
    v_mfma_f32_16x16x32_bf16 v[52:55], a[20:23], a[144:147], v[52:55]
    v_add_f32_dpp v72, v64, v33 wave_shr:1 row_mask:0xf bank_mask:0xf
    v_add_f32_dpp v73, v65, v37 wave_shr:1 row_mask:0xf bank_mask:0xf
    v_mfma_f32_16x16x32_bf16 v[56:59], a[24:27], a[144:147], v[56:59]
    v_add_f32_dpp v74, v66, v41 wave_shr:1 row_mask:0xf bank_mask:0xf
    v_add_f32_dpp v75, v67, v45 wave_shr:1 row_mask:0xf bank_mask:0xf
    v_mfma_f32_16x16x32_bf16 v[60:63], a[28:31], a[144:147], v[60:63]
    v_add_f32_dpp v80, v79, v32 wave_ror:1 row_mask:0xf bank_mask:0xf
    v_add_f32_dpp v81, v72, v36 wave_ror:1 row_mask:0xf bank_mask:0xf
    v_mfma_f32_16x16x32_bf16 v[48:51], a[24:27], a[140:143], v[48:51]
    v_add_f32_dpp v82, v73, v40 wave_ror:1 row_mask:0xf bank_mask:0xf
    v_add_f32_dpp v83, v74, v44 wave_ror:1 row_mask:0xf bank_mask:0xf
    v_mfma_f32_16x16x32_bf16 v[52:55], a[28:31], a[140:143], v[52:55]
    v_add_f32_dpp v80, v72, v32 wave_shr:1 row_mask:0xf bank_mask:0xf
    v_add_f32_dpp v81, v73, v36 wave_shr:1 row_mask:0xf bank_mask:0xf
    v_mfma_f32_16x16x32_bf16 v[56:59], a[32:35], a[140:143], v[56:59]
    v_add_f32_dpp v82, v74, v40 wave_shr:1 row_mask:0xf bank_mask:0xf
    v_add_f32_dpp v83, v75, v44 wave_shr:1 row_mask:0xf bank_mask:0xf
    v_mfma_f32_16x16x32_bf16 v[60:63], a[36:39], a[140:143], v[60:63]
    v_cvt_pk_bf16_f32 v92, v80, v81
    v_cvt_pk_bf16_f32 v93, v82, v83
    v_mfma_f32_16x16x32_bf16 v[48:51], a[32:35], a[136:139], v[48:51]
    v_mfma_f32_16x16x32_bf16 v[52:55], a[36:39], a[136:139], v[52:55]
    v_mfma_f32_16x16x32_bf16 v[56:59], a[40:43], a[136:139], v[56:59]
    v_mfma_f32_16x16x32_bf16 v[60:63], a[44:47], a[136:139], v[60:63]
    v_mfma_f32_16x16x32_bf16 v[48:51], a[40:43], a[132:135], v[48:51]
    v_mfma_f32_16x16x32_bf16 v[52:55], a[44:47], a[132:135], v[52:55]
    v_mfma_f32_16x16x32_bf16 v[56:59], a[48:51], a[132:135], v[56:59]
    v_mfma_f32_16x16x32_bf16 v[60:63], a[52:55], a[132:135], v[60:63]
    v_mfma_f32_16x16x32_bf16 v[48:51], a[48:51], a[128:131], v[48:51]
    v_mfma_f32_16x16x32_bf16 v[52:55], a[52:55], a[128:131], v[52:55]
    v_mfma_f32_16x16x32_bf16 v[56:59], a[56:59], a[128:131], v[56:59]
    v_mfma_f32_16x16x32_bf16 v[60:63], a[60:63], a[128:131], v[60:63]
    s_waitcnt lgkmcnt(0)
    v_mfma_f32_16x16x32_bf16 v[40:43], a[0:3], a[164:167], 0
    ds_read_b64_tr_b16 a[80:81], v14 offset:2560
    ds_read_b64_tr_b16 a[82:83], v14 offset:2592
    v_mfma_f32_16x16x32_bf16 v[44:47], a[4:7], a[164:167], 0
    ds_read_b64_tr_b16 a[84:85], v14 offset:2688
    ds_read_b64_tr_b16 a[86:87], v14 offset:2720
    v_mfma_f32_16x16x32_bf16 v[32:35], a[0:3], a[160:163], 0
    ds_read_b64_tr_b16 a[88:89], v14 offset:2816
    ds_read_b64_tr_b16 a[90:91], v14 offset:2848
    v_mfma_f32_16x16x32_bf16 v[36:39], a[4:7], a[160:163], 0
    ds_read_b64_tr_b16 a[92:93], v14 offset:2944
    ds_read_b64_tr_b16 a[94:95], v14 offset:2976
    v_mfma_f32_16x16x32_bf16 v[40:43], a[8:11], a[160:163], v[40:43]
    v_add_f32_dpp v68, v84, v50 wave_ror:1 row_mask:0xf bank_mask:0xf
    v_add_f32_dpp v69, v51, v54 wave_ror:1 row_mask:0xf bank_mask:0xf
    v_mfma_f32_16x16x32_bf16 v[44:47], a[12:15], a[160:163], v[44:47]
    v_add_f32_dpp v70, v55, v58 wave_ror:1 row_mask:0xf bank_mask:0xf
    v_add_f32_dpp v71, v59, v62 wave_ror:1 row_mask:0xf bank_mask:0xf
    v_mfma_f32_16x16x32_bf16 v[32:35], a[8:11], a[156:159], v[32:35]
    v_add_f32_dpp v68, v51, v50 wave_shr:1 row_mask:0xf bank_mask:0xf
    v_add_f32_dpp v69, v55, v54 wave_shr:1 row_mask:0xf bank_mask:0xf
    v_mfma_f32_16x16x32_bf16 v[36:39], a[12:15], a[156:159], v[36:39]
    v_add_f32_dpp v70, v59, v58 wave_shr:1 row_mask:0xf bank_mask:0xf
    v_add_f32_dpp v71, v63, v62 wave_shr:1 row_mask:0xf bank_mask:0xf
    v_mfma_f32_16x16x32_bf16 v[40:43], a[16:19], a[156:159], v[40:43]
    v_mov_b32 v84, v63
    v_add_f32_dpp v76, v67, v49 wave_ror:1 row_mask:0xf bank_mask:0xf
    v_mfma_f32_16x16x32_bf16 v[44:47], a[20:23], a[156:159], v[44:47]
    v_add_f32_dpp v77, v68, v53 wave_ror:1 row_mask:0xf bank_mask:0xf
    v_add_f32_dpp v78, v69, v57 wave_ror:1 row_mask:0xf bank_mask:0xf
    v_mfma_f32_16x16x32_bf16 v[32:35], a[16:19], a[152:155], v[32:35]
    v_add_f32_dpp v79, v70, v61 wave_ror:1 row_mask:0xf bank_mask:0xf
    v_add_f32_dpp v76, v68, v49 wave_shr:1 row_mask:0xf bank_mask:0xf
    v_mfma_f32_16x16x32_bf16 v[36:39], a[20:23], a[152:155], v[36:39]
    v_add_f32_dpp v77, v69, v53 wave_shr:1 row_mask:0xf bank_mask:0xf
    v_add_f32_dpp v78, v70, v57 wave_shr:1 row_mask:0xf bank_mask:0xf
    v_mfma_f32_16x16x32_bf16 v[40:43], a[24:27], a[152:155], v[40:43]
    v_add_f32_dpp v79, v71, v61 wave_shr:1 row_mask:0xf bank_mask:0xf
    v_add_f32_dpp v80, v75, v48 wave_ror:1 row_mask:0xf bank_mask:0xf
    v_mfma_f32_16x16x32_bf16 v[44:47], a[28:31], a[152:155], v[44:47]
    v_add_f32_dpp v81, v76, v52 wave_ror:1 row_mask:0xf bank_mask:0xf
    v_add_f32_dpp v82, v77, v56 wave_ror:1 row_mask:0xf bank_mask:0xf
    v_mfma_f32_16x16x32_bf16 v[32:35], a[24:27], a[148:151], v[32:35]
    v_add_f32_dpp v83, v78, v60 wave_ror:1 row_mask:0xf bank_mask:0xf
    v_add_f32_dpp v80, v76, v48 wave_shr:1 row_mask:0xf bank_mask:0xf
    v_mfma_f32_16x16x32_bf16 v[36:39], a[28:31], a[148:151], v[36:39]
    v_add_f32_dpp v81, v77, v52 wave_shr:1 row_mask:0xf bank_mask:0xf
    v_add_f32_dpp v82, v78, v56 wave_shr:1 row_mask:0xf bank_mask:0xf
    v_mfma_f32_16x16x32_bf16 v[40:43], a[32:35], a[148:151], v[40:43]
    v_add_f32_dpp v83, v79, v60 wave_shr:1 row_mask:0xf bank_mask:0xf
    v_cvt_pk_bf16_f32 v94, v80, v81
    v_mfma_f32_16x16x32_bf16 v[44:47], a[36:39], a[148:151], v[44:47]
    v_cvt_pk_bf16_f32 v95, v82, v83
    buffer_store_dwordx4 v[92:95], v13, s[56:59], s79 offen sc1
    v_mfma_f32_16x16x32_bf16 v[32:35], a[32:35], a[144:147], v[32:35]
    s_add_u32 s79, s79, 81920
    v_mfma_f32_16x16x32_bf16 v[36:39], a[36:39], a[144:147], v[36:39]
    v_mfma_f32_16x16x32_bf16 v[40:43], a[40:43], a[144:147], v[40:43]
    v_mfma_f32_16x16x32_bf16 v[44:47], a[44:47], a[144:147], v[44:47]
    v_mfma_f32_16x16x32_bf16 v[32:35], a[40:43], a[140:143], v[32:35]
    v_mfma_f32_16x16x32_bf16 v[36:39], a[44:47], a[140:143], v[36:39]
    v_mfma_f32_16x16x32_bf16 v[40:43], a[48:51], a[140:143], v[40:43]
    v_mfma_f32_16x16x32_bf16 v[44:47], a[52:55], a[140:143], v[44:47]
    v_mfma_f32_16x16x32_bf16 v[32:35], a[48:51], a[136:139], v[32:35]
    v_mfma_f32_16x16x32_bf16 v[36:39], a[52:55], a[136:139], v[36:39]
    v_mfma_f32_16x16x32_bf16 v[40:43], a[56:59], a[136:139], v[40:43]
    v_mfma_f32_16x16x32_bf16 v[44:47], a[60:63], a[136:139], v[44:47]
    v_mfma_f32_16x16x32_bf16 v[32:35], a[56:59], a[132:135], v[32:35]
    v_mfma_f32_16x16x32_bf16 v[36:39], a[60:63], a[132:135], v[36:39]
    v_mfma_f32_16x16x32_bf16 v[40:43], a[64:67], a[132:135], v[40:43]
    v_mfma_f32_16x16x32_bf16 v[44:47], a[68:71], a[132:135], v[44:47]
    v_mfma_f32_16x16x32_bf16 v[32:35], a[64:67], a[128:131], v[32:35]
    v_mfma_f32_16x16x32_bf16 v[36:39], a[68:71], a[128:131], v[36:39]
    v_mfma_f32_16x16x32_bf16 v[40:43], a[72:75], a[128:131], v[40:43]
    v_mfma_f32_16x16x32_bf16 v[44:47], a[76:79], a[128:131], v[44:47]
    s_waitcnt lgkmcnt(0)
    v_mfma_f32_16x16x32_bf16 v[56:59], a[0:3], a[172:175], 0
    s_waitcnt vmcnt(2)
    ds_read_b64_tr_b16 a[96:97], v14 offset:3072
    v_mfma_f32_16x16x32_bf16 v[60:63], a[4:7], a[172:175], 0
    ds_read_b64_tr_b16 a[98:99], v14 offset:3104
    ds_read_b64_tr_b16 a[100:101], v14 offset:3200
    v_mfma_f32_16x16x32_bf16 v[48:51], a[0:3], a[168:171], 0
    ds_read_b64_tr_b16 a[102:103], v14 offset:3232
    ds_read_b64_tr_b16 a[104:105], v14 offset:3328
    v_mfma_f32_16x16x32_bf16 v[52:55], a[4:7], a[168:171], 0
    ds_read_b64_tr_b16 a[106:107], v14 offset:3360
    ds_read_b64_tr_b16 a[108:109], v14 offset:3456
    v_mfma_f32_16x16x32_bf16 v[56:59], a[8:11], a[168:171], v[56:59]
    ds_read_b64_tr_b16 a[110:111], v14 offset:3488
    v_add_f32_dpp v64, v84, v34 wave_ror:1 row_mask:0xf bank_mask:0xf
    v_mfma_f32_16x16x32_bf16 v[60:63], a[12:15], a[168:171], v[60:63]
    v_add_f32_dpp v65, v35, v38 wave_ror:1 row_mask:0xf bank_mask:0xf
    v_add_f32_dpp v66, v39, v42 wave_ror:1 row_mask:0xf bank_mask:0xf
    v_mfma_f32_16x16x32_bf16 v[48:51], a[8:11], a[164:167], v[48:51]
    v_add_f32_dpp v67, v43, v46 wave_ror:1 row_mask:0xf bank_mask:0xf
    v_add_f32_dpp v64, v35, v34 wave_shr:1 row_mask:0xf bank_mask:0xf
    v_mfma_f32_16x16x32_bf16 v[52:55], a[12:15], a[164:167], v[52:55]
    v_add_f32_dpp v65, v39, v38 wave_shr:1 row_mask:0xf bank_mask:0xf
    v_add_f32_dpp v66, v43, v42 wave_shr:1 row_mask:0xf bank_mask:0xf
    v_mfma_f32_16x16x32_bf16 v[56:59], a[16:19], a[164:167], v[56:59]
    v_add_f32_dpp v67, v47, v46 wave_shr:1 row_mask:0xf bank_mask:0xf
    v_mov_b32 v84, v47
    v_mfma_f32_16x16x32_bf16 v[60:63], a[20:23], a[164:167], v[60:63]
    v_add_f32_dpp v72, v71, v33 wave_ror:1 row_mask:0xf bank_mask:0xf
    v_add_f32_dpp v73, v64, v37 wave_ror:1 row_mask:0xf bank_mask:0xf
    v_mfma_f32_16x16x32_bf16 v[48:51], a[16:19], a[160:163], v[48:51]
    v_add_f32_dpp v74, v65, v41 wave_ror:1 row_mask:0xf bank_mask:0xf
    v_add_f32_dpp v75, v66, v45 wave_ror:1 row_mask:0xf bank_mask:0xf
    v_mfma_f32_16x16x32_bf16 v[52:55], a[20:23], a[160:163], v[52:55]
    v_add_f32_dpp v72, v64, v33 wave_shr:1 row_mask:0xf bank_mask:0xf
    v_add_f32_dpp v73, v65, v37 wave_shr:1 row_mask:0xf bank_mask:0xf
    v_mfma_f32_16x16x32_bf16 v[56:59], a[24:27], a[160:163], v[56:59]
    v_add_f32_dpp v74, v66, v41 wave_shr:1 row_mask:0xf bank_mask:0xf
    v_add_f32_dpp v75, v67, v45 wave_shr:1 row_mask:0xf bank_mask:0xf
    v_mfma_f32_16x16x32_bf16 v[60:63], a[28:31], a[160:163], v[60:63]
    v_add_f32_dpp v80, v79, v32 wave_ror:1 row_mask:0xf bank_mask:0xf
    v_add_f32_dpp v81, v72, v36 wave_ror:1 row_mask:0xf bank_mask:0xf
    v_mfma_f32_16x16x32_bf16 v[48:51], a[24:27], a[156:159], v[48:51]
    v_add_f32_dpp v82, v73, v40 wave_ror:1 row_mask:0xf bank_mask:0xf
    v_add_f32_dpp v83, v74, v44 wave_ror:1 row_mask:0xf bank_mask:0xf
    v_mfma_f32_16x16x32_bf16 v[52:55], a[28:31], a[156:159], v[52:55]
    v_add_f32_dpp v80, v72, v32 wave_shr:1 row_mask:0xf bank_mask:0xf
    v_add_f32_dpp v81, v73, v36 wave_shr:1 row_mask:0xf bank_mask:0xf
    v_mfma_f32_16x16x32_bf16 v[56:59], a[32:35], a[156:159], v[56:59]
    v_add_f32_dpp v82, v74, v40 wave_shr:1 row_mask:0xf bank_mask:0xf
    v_add_f32_dpp v83, v75, v44 wave_shr:1 row_mask:0xf bank_mask:0xf
    v_mfma_f32_16x16x32_bf16 v[60:63], a[36:39], a[156:159], v[60:63]
    v_cvt_pk_bf16_f32 v88, v80, v81
    v_cvt_pk_bf16_f32 v89, v82, v83
    v_mfma_f32_16x16x32_bf16 v[48:51], a[32:35], a[152:155], v[48:51]
    v_mfma_f32_16x16x32_bf16 v[52:55], a[36:39], a[152:155], v[52:55]
    v_mfma_f32_16x16x32_bf16 v[56:59], a[40:43], a[152:155], v[56:59]
    v_mfma_f32_16x16x32_bf16 v[60:63], a[44:47], a[152:155], v[60:63]
    v_mfma_f32_16x16x32_bf16 v[48:51], a[40:43], a[148:151], v[48:51]
    v_mfma_f32_16x16x32_bf16 v[52:55], a[44:47], a[148:151], v[52:55]
    v_mfma_f32_16x16x32_bf16 v[56:59], a[48:51], a[148:151], v[56:59]
    v_mfma_f32_16x16x32_bf16 v[60:63], a[52:55], a[148:151], v[60:63]
    v_mfma_f32_16x16x32_bf16 v[48:51], a[48:51], a[144:147], v[48:51]
    v_mfma_f32_16x16x32_bf16 v[52:55], a[52:55], a[144:147], v[52:55]
    v_mfma_f32_16x16x32_bf16 v[56:59], a[56:59], a[144:147], v[56:59]
    v_mfma_f32_16x16x32_bf16 v[60:63], a[60:63], a[144:147], v[60:63]
    v_mfma_f32_16x16x32_bf16 v[48:51], a[56:59], a[140:143], v[48:51]
    v_mfma_f32_16x16x32_bf16 v[52:55], a[60:63], a[140:143], v[52:55]
    v_mfma_f32_16x16x32_bf16 v[56:59], a[64:67], a[140:143], v[56:59]
    v_mfma_f32_16x16x32_bf16 v[60:63], a[68:71], a[140:143], v[60:63]
    v_mfma_f32_16x16x32_bf16 v[48:51], a[64:67], a[136:139], v[48:51]
    v_mfma_f32_16x16x32_bf16 v[52:55], a[68:71], a[136:139], v[52:55]
    v_mfma_f32_16x16x32_bf16 v[56:59], a[72:75], a[136:139], v[56:59]
    v_mfma_f32_16x16x32_bf16 v[60:63], a[76:79], a[136:139], v[60:63]
    v_mfma_f32_16x16x32_bf16 v[48:51], a[72:75], a[132:135], v[48:51]
    v_mfma_f32_16x16x32_bf16 v[52:55], a[76:79], a[132:135], v[52:55]
    v_mfma_f32_16x16x32_bf16 v[56:59], a[80:83], a[132:135], v[56:59]
    v_mfma_f32_16x16x32_bf16 v[60:63], a[84:87], a[132:135], v[60:63]
    v_mfma_f32_16x16x32_bf16 v[48:51], a[80:83], a[128:131], v[48:51]
    v_mfma_f32_16x16x32_bf16 v[52:55], a[84:87], a[128:131], v[52:55]
    v_mfma_f32_16x16x32_bf16 v[56:59], a[88:91], a[128:131], v[56:59]
    v_mfma_f32_16x16x32_bf16 v[60:63], a[92:95], a[128:131], v[60:63]
    s_waitcnt lgkmcnt(0)
    v_mfma_f32_16x16x32_bf16 v[40:43], a[0:3], a[180:183], 0
    ds_read_b64_tr_b16 a[112:113], v14 offset:3584
    ds_read_b64_tr_b16 a[114:115], v14 offset:3616
    v_mfma_f32_16x16x32_bf16 v[44:47], a[4:7], a[180:183], 0
    ds_read_b64_tr_b16 a[116:117], v14 offset:3712
    ds_read_b64_tr_b16 a[118:119], v14 offset:3744
    v_mfma_f32_16x16x32_bf16 v[32:35], a[0:3], a[176:179], 0
    ds_read_b64_tr_b16 a[120:121], v14 offset:3840
    ds_read_b64_tr_b16 a[122:123], v14 offset:3872
    v_mfma_f32_16x16x32_bf16 v[36:39], a[4:7], a[176:179], 0
    ds_read_b64_tr_b16 a[124:125], v14 offset:3968
    ds_read_b64_tr_b16 a[126:127], v14 offset:4000
    v_mfma_f32_16x16x32_bf16 v[40:43], a[8:11], a[176:179], v[40:43]
    v_add_f32_dpp v68, v84, v50 wave_ror:1 row_mask:0xf bank_mask:0xf
    v_add_f32_dpp v69, v51, v54 wave_ror:1 row_mask:0xf bank_mask:0xf
    v_mfma_f32_16x16x32_bf16 v[44:47], a[12:15], a[176:179], v[44:47]
    v_add_f32_dpp v70, v55, v58 wave_ror:1 row_mask:0xf bank_mask:0xf
    v_add_f32_dpp v71, v59, v62 wave_ror:1 row_mask:0xf bank_mask:0xf
    v_mfma_f32_16x16x32_bf16 v[32:35], a[8:11], a[172:175], v[32:35]
    v_add_f32_dpp v68, v51, v50 wave_shr:1 row_mask:0xf bank_mask:0xf
    v_add_f32_dpp v69, v55, v54 wave_shr:1 row_mask:0xf bank_mask:0xf
    v_mfma_f32_16x16x32_bf16 v[36:39], a[12:15], a[172:175], v[36:39]
    v_add_f32_dpp v70, v59, v58 wave_shr:1 row_mask:0xf bank_mask:0xf
    v_add_f32_dpp v71, v63, v62 wave_shr:1 row_mask:0xf bank_mask:0xf
    v_mfma_f32_16x16x32_bf16 v[40:43], a[16:19], a[172:175], v[40:43]
    v_mov_b32 v84, v63
    v_add_f32_dpp v76, v67, v49 wave_ror:1 row_mask:0xf bank_mask:0xf
    v_mfma_f32_16x16x32_bf16 v[44:47], a[20:23], a[172:175], v[44:47]
    v_add_f32_dpp v77, v68, v53 wave_ror:1 row_mask:0xf bank_mask:0xf
    v_add_f32_dpp v78, v69, v57 wave_ror:1 row_mask:0xf bank_mask:0xf
    v_mfma_f32_16x16x32_bf16 v[32:35], a[16:19], a[168:171], v[32:35]
    v_add_f32_dpp v79, v70, v61 wave_ror:1 row_mask:0xf bank_mask:0xf
    v_add_f32_dpp v76, v68, v49 wave_shr:1 row_mask:0xf bank_mask:0xf
    v_mfma_f32_16x16x32_bf16 v[36:39], a[20:23], a[168:171], v[36:39]
    v_add_f32_dpp v77, v69, v53 wave_shr:1 row_mask:0xf bank_mask:0xf
    v_add_f32_dpp v78, v70, v57 wave_shr:1 row_mask:0xf bank_mask:0xf
    v_mfma_f32_16x16x32_bf16 v[40:43], a[24:27], a[168:171], v[40:43]
    v_add_f32_dpp v79, v71, v61 wave_shr:1 row_mask:0xf bank_mask:0xf
    v_add_f32_dpp v80, v75, v48 wave_ror:1 row_mask:0xf bank_mask:0xf
    v_mfma_f32_16x16x32_bf16 v[44:47], a[28:31], a[168:171], v[44:47]
    v_add_f32_dpp v81, v76, v52 wave_ror:1 row_mask:0xf bank_mask:0xf
    v_add_f32_dpp v82, v77, v56 wave_ror:1 row_mask:0xf bank_mask:0xf
    v_mfma_f32_16x16x32_bf16 v[32:35], a[24:27], a[164:167], v[32:35]
    v_add_f32_dpp v83, v78, v60 wave_ror:1 row_mask:0xf bank_mask:0xf
    v_add_f32_dpp v80, v76, v48 wave_shr:1 row_mask:0xf bank_mask:0xf
    v_mfma_f32_16x16x32_bf16 v[36:39], a[28:31], a[164:167], v[36:39]
    v_add_f32_dpp v81, v77, v52 wave_shr:1 row_mask:0xf bank_mask:0xf
    v_add_f32_dpp v82, v78, v56 wave_shr:1 row_mask:0xf bank_mask:0xf
    v_mfma_f32_16x16x32_bf16 v[40:43], a[32:35], a[164:167], v[40:43]
    v_add_f32_dpp v83, v79, v60 wave_shr:1 row_mask:0xf bank_mask:0xf
    v_cvt_pk_bf16_f32 v90, v80, v81
    v_mfma_f32_16x16x32_bf16 v[44:47], a[36:39], a[164:167], v[44:47]
    v_cvt_pk_bf16_f32 v91, v82, v83
    buffer_store_dwordx4 v[88:91], v13, s[56:59], s79 offen sc1
    v_mfma_f32_16x16x32_bf16 v[32:35], a[32:35], a[160:163], v[32:35]
    s_add_u32 s79, s79, 81920
    v_mfma_f32_16x16x32_bf16 v[36:39], a[36:39], a[160:163], v[36:39]
    v_mfma_f32_16x16x32_bf16 v[40:43], a[40:43], a[160:163], v[40:43]
    v_mfma_f32_16x16x32_bf16 v[44:47], a[44:47], a[160:163], v[44:47]
    v_mfma_f32_16x16x32_bf16 v[32:35], a[40:43], a[156:159], v[32:35]
    v_mfma_f32_16x16x32_bf16 v[36:39], a[44:47], a[156:159], v[36:39]
    v_mfma_f32_16x16x32_bf16 v[40:43], a[48:51], a[156:159], v[40:43]
    v_mfma_f32_16x16x32_bf16 v[44:47], a[52:55], a[156:159], v[44:47]
    v_mfma_f32_16x16x32_bf16 v[32:35], a[48:51], a[152:155], v[32:35]
    v_mfma_f32_16x16x32_bf16 v[36:39], a[52:55], a[152:155], v[36:39]
    v_mfma_f32_16x16x32_bf16 v[40:43], a[56:59], a[152:155], v[40:43]
    v_mfma_f32_16x16x32_bf16 v[44:47], a[60:63], a[152:155], v[44:47]
    v_mfma_f32_16x16x32_bf16 v[32:35], a[56:59], a[148:151], v[32:35]
    v_mfma_f32_16x16x32_bf16 v[36:39], a[60:63], a[148:151], v[36:39]
    v_mfma_f32_16x16x32_bf16 v[40:43], a[64:67], a[148:151], v[40:43]
    v_mfma_f32_16x16x32_bf16 v[44:47], a[68:71], a[148:151], v[44:47]
    v_mfma_f32_16x16x32_bf16 v[32:35], a[64:67], a[144:147], v[32:35]
    v_mfma_f32_16x16x32_bf16 v[36:39], a[68:71], a[144:147], v[36:39]
    v_mfma_f32_16x16x32_bf16 v[40:43], a[72:75], a[144:147], v[40:43]
    v_mfma_f32_16x16x32_bf16 v[44:47], a[76:79], a[144:147], v[44:47]
    v_mfma_f32_16x16x32_bf16 v[32:35], a[72:75], a[140:143], v[32:35]
    v_mfma_f32_16x16x32_bf16 v[36:39], a[76:79], a[140:143], v[36:39]
    v_mfma_f32_16x16x32_bf16 v[40:43], a[80:83], a[140:143], v[40:43]
    v_mfma_f32_16x16x32_bf16 v[44:47], a[84:87], a[140:143], v[44:47]
    v_mfma_f32_16x16x32_bf16 v[32:35], a[80:83], a[136:139], v[32:35]
    v_mfma_f32_16x16x32_bf16 v[36:39], a[84:87], a[136:139], v[36:39]
    v_mfma_f32_16x16x32_bf16 v[40:43], a[88:91], a[136:139], v[40:43]
    v_mfma_f32_16x16x32_bf16 v[44:47], a[92:95], a[136:139], v[44:47]
    v_mfma_f32_16x16x32_bf16 v[32:35], a[88:91], a[132:135], v[32:35]
    v_mfma_f32_16x16x32_bf16 v[36:39], a[92:95], a[132:135], v[36:39]
    v_mfma_f32_16x16x32_bf16 v[40:43], a[96:99], a[132:135], v[40:43]
    v_mfma_f32_16x16x32_bf16 v[44:47], a[100:103], a[132:135], v[44:47]
    v_mfma_f32_16x16x32_bf16 v[32:35], a[96:99], a[128:131], v[32:35]
    v_mfma_f32_16x16x32_bf16 v[36:39], a[100:103], a[128:131], v[36:39]
    v_mfma_f32_16x16x32_bf16 v[40:43], a[104:107], a[128:131], v[40:43]
    v_mfma_f32_16x16x32_bf16 v[44:47], a[108:111], a[128:131], v[44:47]
    s_waitcnt lgkmcnt(0)
    v_mfma_f32_16x16x32_bf16 v[56:59], a[0:3], a[188:191], 0
    buffer_load_dword v123, v122, s[56:59], s38 offen sc1
    v_mfma_f32_16x16x32_bf16 v[60:63], a[4:7], a[188:191], 0
    v_mfma_f32_16x16x32_bf16 v[48:51], a[0:3], a[184:187], 0
    v_mfma_f32_16x16x32_bf16 v[52:55], a[4:7], a[184:187], 0
    v_mfma_f32_16x16x32_bf16 v[56:59], a[8:11], a[184:187], v[56:59]
    v_mfma_f32_16x16x32_bf16 v[60:63], a[12:15], a[184:187], v[60:63]
    v_mfma_f32_16x16x32_bf16 v[48:51], a[8:11], a[180:183], v[48:51]
    v_mfma_f32_16x16x32_bf16 v[52:55], a[12:15], a[180:183], v[52:55]
    v_add_f32_dpp v64, v84, v34 wave_ror:1 row_mask:0xf bank_mask:0xf
    v_add_f32_dpp v65, v35, v38 wave_ror:1 row_mask:0xf bank_mask:0xf
    v_mfma_f32_16x16x32_bf16 v[56:59], a[16:19], a[180:183], v[56:59]
    v_add_f32_dpp v66, v39, v42 wave_ror:1 row_mask:0xf bank_mask:0xf
    v_add_f32_dpp v67, v43, v46 wave_ror:1 row_mask:0xf bank_mask:0xf
    v_mfma_f32_16x16x32_bf16 v[60:63], a[20:23], a[180:183], v[60:63]
    v_add_f32_dpp v64, v35, v34 wave_shr:1 row_mask:0xf bank_mask:0xf
    v_add_f32_dpp v65, v39, v38 wave_shr:1 row_mask:0xf bank_mask:0xf
    v_mfma_f32_16x16x32_bf16 v[48:51], a[16:19], a[176:179], v[48:51]
    v_add_f32_dpp v66, v43, v42 wave_shr:1 row_mask:0xf bank_mask:0xf
    v_add_f32_dpp v67, v47, v46 wave_shr:1 row_mask:0xf bank_mask:0xf
    v_mfma_f32_16x16x32_bf16 v[52:55], a[20:23], a[176:179], v[52:55]
    v_mov_b32 v84, v47
    v_add_f32_dpp v72, v71, v33 wave_ror:1 row_mask:0xf bank_mask:0xf
    v_mfma_f32_16x16x32_bf16 v[56:59], a[24:27], a[176:179], v[56:59]
    v_add_f32_dpp v73, v64, v37 wave_ror:1 row_mask:0xf bank_mask:0xf
    v_add_f32_dpp v74, v65, v41 wave_ror:1 row_mask:0xf bank_mask:0xf
    v_mfma_f32_16x16x32_bf16 v[60:63], a[28:31], a[176:179], v[60:63]
    v_add_f32_dpp v75, v66, v45 wave_ror:1 row_mask:0xf bank_mask:0xf
    v_add_f32_dpp v72, v64, v33 wave_shr:1 row_mask:0xf bank_mask:0xf
    v_mfma_f32_16x16x32_bf16 v[48:51], a[24:27], a[172:175], v[48:51]
    v_add_f32_dpp v73, v65, v37 wave_shr:1 row_mask:0xf bank_mask:0xf
    v_add_f32_dpp v74, v66, v41 wave_shr:1 row_mask:0xf bank_mask:0xf
    v_mfma_f32_16x16x32_bf16 v[52:55], a[28:31], a[172:175], v[52:55]
    v_add_f32_dpp v75, v67, v45 wave_shr:1 row_mask:0xf bank_mask:0xf
    v_add_f32_dpp v80, v79, v32 wave_ror:1 row_mask:0xf bank_mask:0xf
    v_mfma_f32_16x16x32_bf16 v[56:59], a[32:35], a[172:175], v[56:59]
    v_add_f32_dpp v81, v72, v36 wave_ror:1 row_mask:0xf bank_mask:0xf
    v_add_f32_dpp v82, v73, v40 wave_ror:1 row_mask:0xf bank_mask:0xf
    v_mfma_f32_16x16x32_bf16 v[60:63], a[36:39], a[172:175], v[60:63]
    v_add_f32_dpp v83, v74, v44 wave_ror:1 row_mask:0xf bank_mask:0xf
    v_add_f32_dpp v80, v72, v32 wave_shr:1 row_mask:0xf bank_mask:0xf
    v_mfma_f32_16x16x32_bf16 v[48:51], a[32:35], a[168:171], v[48:51]
    v_add_f32_dpp v81, v73, v36 wave_shr:1 row_mask:0xf bank_mask:0xf
    v_add_f32_dpp v82, v74, v40 wave_shr:1 row_mask:0xf bank_mask:0xf
    v_mfma_f32_16x16x32_bf16 v[52:55], a[36:39], a[168:171], v[52:55]
    v_add_f32_dpp v83, v75, v44 wave_shr:1 row_mask:0xf bank_mask:0xf
    v_cvt_pk_bf16_f32 v92, v80, v81
    v_mfma_f32_16x16x32_bf16 v[56:59], a[40:43], a[168:171], v[56:59]
    v_cvt_pk_bf16_f32 v93, v82, v83
    v_mfma_f32_16x16x32_bf16 v[60:63], a[44:47], a[168:171], v[60:63]
    v_mfma_f32_16x16x32_bf16 v[48:51], a[40:43], a[164:167], v[48:51]
    v_mfma_f32_16x16x32_bf16 v[52:55], a[44:47], a[164:167], v[52:55]
    v_mfma_f32_16x16x32_bf16 v[56:59], a[48:51], a[164:167], v[56:59]
    v_mfma_f32_16x16x32_bf16 v[60:63], a[52:55], a[164:167], v[60:63]
    v_mfma_f32_16x16x32_bf16 v[48:51], a[48:51], a[160:163], v[48:51]
    v_mfma_f32_16x16x32_bf16 v[52:55], a[52:55], a[160:163], v[52:55]
    v_mfma_f32_16x16x32_bf16 v[56:59], a[56:59], a[160:163], v[56:59]
    v_mfma_f32_16x16x32_bf16 v[60:63], a[60:63], a[160:163], v[60:63]
    v_mfma_f32_16x16x32_bf16 v[48:51], a[56:59], a[156:159], v[48:51]
    v_mfma_f32_16x16x32_bf16 v[52:55], a[60:63], a[156:159], v[52:55]
    v_mfma_f32_16x16x32_bf16 v[56:59], a[64:67], a[156:159], v[56:59]
    v_mfma_f32_16x16x32_bf16 v[60:63], a[68:71], a[156:159], v[60:63]
    v_mfma_f32_16x16x32_bf16 v[48:51], a[64:67], a[152:155], v[48:51]
    v_mfma_f32_16x16x32_bf16 v[52:55], a[68:71], a[152:155], v[52:55]
    v_mfma_f32_16x16x32_bf16 v[56:59], a[72:75], a[152:155], v[56:59]
    v_mfma_f32_16x16x32_bf16 v[60:63], a[76:79], a[152:155], v[60:63]
    v_mfma_f32_16x16x32_bf16 v[48:51], a[72:75], a[148:151], v[48:51]
    v_mfma_f32_16x16x32_bf16 v[52:55], a[76:79], a[148:151], v[52:55]
    v_mfma_f32_16x16x32_bf16 v[56:59], a[80:83], a[148:151], v[56:59]
    v_mfma_f32_16x16x32_bf16 v[60:63], a[84:87], a[148:151], v[60:63]
    v_mfma_f32_16x16x32_bf16 v[48:51], a[80:83], a[144:147], v[48:51]
    v_mfma_f32_16x16x32_bf16 v[52:55], a[84:87], a[144:147], v[52:55]
    v_mfma_f32_16x16x32_bf16 v[56:59], a[88:91], a[144:147], v[56:59]
    v_mfma_f32_16x16x32_bf16 v[60:63], a[92:95], a[144:147], v[60:63]
    v_mfma_f32_16x16x32_bf16 v[48:51], a[88:91], a[140:143], v[48:51]
    v_mfma_f32_16x16x32_bf16 v[52:55], a[92:95], a[140:143], v[52:55]
    v_mfma_f32_16x16x32_bf16 v[56:59], a[96:99], a[140:143], v[56:59]
    v_mfma_f32_16x16x32_bf16 v[60:63], a[100:103], a[140:143], v[60:63]
    v_mfma_f32_16x16x32_bf16 v[48:51], a[96:99], a[136:139], v[48:51]
    v_mfma_f32_16x16x32_bf16 v[52:55], a[100:103], a[136:139], v[52:55]
    v_mfma_f32_16x16x32_bf16 v[56:59], a[104:107], a[136:139], v[56:59]
    v_mfma_f32_16x16x32_bf16 v[60:63], a[108:111], a[136:139], v[60:63]
    v_mfma_f32_16x16x32_bf16 v[48:51], a[104:107], a[132:135], v[48:51]
    v_mfma_f32_16x16x32_bf16 v[52:55], a[108:111], a[132:135], v[52:55]
    v_mfma_f32_16x16x32_bf16 v[56:59], a[112:115], a[132:135], v[56:59]
    v_mfma_f32_16x16x32_bf16 v[60:63], a[116:119], a[132:135], v[60:63]
    v_mfma_f32_16x16x32_bf16 v[48:51], a[112:115], a[128:131], v[48:51]
    v_mfma_f32_16x16x32_bf16 v[52:55], a[116:119], a[128:131], v[52:55]
    v_mfma_f32_16x16x32_bf16 v[56:59], a[120:123], a[128:131], v[56:59]
    v_mfma_f32_16x16x32_bf16 v[60:63], a[124:127], a[128:131], v[60:63]
    s_lshl_b32 s69, s61, 2
    s_add_u32 s69, s69, s5
    s_mul_i32 s67, s69, 61440
    s_add_u32 s67, s67, 10485760
    s_nop 1
    v_mov_b32 v9, 161992
    ds_read_b32 v124, v9
    v_add_f32_dpp v68, v84, v50 wave_ror:1 row_mask:0xf bank_mask:0xf
    v_add_f32_dpp v69, v51, v54 wave_ror:1 row_mask:0xf bank_mask:0xf
    v_add_f32_dpp v70, v55, v58 wave_ror:1 row_mask:0xf bank_mask:0xf
    v_add_f32_dpp v71, v59, v62 wave_ror:1 row_mask:0xf bank_mask:0xf
    v_add_f32_dpp v68, v51, v50 wave_shr:1 row_mask:0xf bank_mask:0xf
    v_add_f32_dpp v69, v55, v54 wave_shr:1 row_mask:0xf bank_mask:0xf
    v_add_f32_dpp v70, v59, v58 wave_shr:1 row_mask:0xf bank_mask:0xf
    v_add_f32_dpp v71, v63, v62 wave_shr:1 row_mask:0xf bank_mask:0xf
    v_mov_b32 v84, v63
    v_add_f32_dpp v76, v67, v49 wave_ror:1 row_mask:0xf bank_mask:0xf
    v_add_f32_dpp v77, v68, v53 wave_ror:1 row_mask:0xf bank_mask:0xf
    v_add_f32_dpp v78, v69, v57 wave_ror:1 row_mask:0xf bank_mask:0xf
    v_add_f32_dpp v79, v70, v61 wave_ror:1 row_mask:0xf bank_mask:0xf
    v_add_f32_dpp v76, v68, v49 wave_shr:1 row_mask:0xf bank_mask:0xf
    v_add_f32_dpp v77, v69, v53 wave_shr:1 row_mask:0xf bank_mask:0xf
    v_add_f32_dpp v78, v70, v57 wave_shr:1 row_mask:0xf bank_mask:0xf
    v_add_f32_dpp v79, v71, v61 wave_shr:1 row_mask:0xf bank_mask:0xf
    v_add_f32_dpp v80, v75, v48 wave_ror:1 row_mask:0xf bank_mask:0xf
    v_add_f32_dpp v81, v76, v52 wave_ror:1 row_mask:0xf bank_mask:0xf
    v_add_f32_dpp v82, v77, v56 wave_ror:1 row_mask:0xf bank_mask:0xf
    v_add_f32_dpp v83, v78, v60 wave_ror:1 row_mask:0xf bank_mask:0xf
    v_add_f32_dpp v80, v76, v48 wave_shr:1 row_mask:0xf bank_mask:0xf
    v_add_f32_dpp v81, v77, v52 wave_shr:1 row_mask:0xf bank_mask:0xf
    v_add_f32_dpp v82, v78, v56 wave_shr:1 row_mask:0xf bank_mask:0xf
    v_add_f32_dpp v83, v79, v60 wave_shr:1 row_mask:0xf bank_mask:0xf
    v_cvt_pk_bf16_f32 v94, v80, v81
    v_cvt_pk_bf16_f32 v95, v82, v83
    buffer_store_dwordx4 v[92:95], v13, s[56:59], s79 offen sc1
    s_waitcnt vmcnt(1)
    v_cmp_ne_u32 vcc, s36, v123
    s_cbranch_vccnz L_late
    buffer_load_dwordx4 a[0:3], v2, s[56:59], s67 offen offset:0 sc1
    buffer_load_dwordx4 a[4:7], v2, s[56:59], s67 offen offset:1024 sc1
    buffer_load_dwordx4 a[8:11], v2, s[56:59], s67 offen offset:2048 sc1
    buffer_load_dwordx4 a[12:15], v2, s[56:59], s67 offen offset:3072 sc1
    s_add_u32 s67, s67, 4096
    buffer_load_dwordx4 a[16:19], v2, s[56:59], s67 offen offset:0 sc1
    buffer_load_dwordx4 a[20:23], v2, s[56:59], s67 offen offset:1024 sc1
    buffer_load_dwordx4 a[24:27], v2, s[56:59], s67 offen offset:2048 sc1
    buffer_load_dwordx4 a[28:31], v2, s[56:59], s67 offen offset:3072 sc1
    s_add_u32 s67, s67, 4096
    buffer_load_dwordx4 a[32:35], v2, s[56:59], s67 offen offset:0 sc1
    buffer_load_dwordx4 a[36:39], v2, s[56:59], s67 offen offset:1024 sc1
    v_mov_b32 v9, 161988
    s_cmp_lt_u32 s4, 16
    s_cselect_b32 s71, 2, 1
    s_mov_b64 exec, 1
    s_waitcnt vmcnt(10)
    ds_add_rtn_u32 v11, v9, v25
    s_waitcnt lgkmcnt(0)
    v_readfirstlane_b32 s69, v11
    s_mov_b64 exec, -1
    s_cmp_lg_u32 s69, s71
    s_cbranch_scc1 L_mid
    s_lshl_b32 s70, s3, 2
    s_add_u32 s70, s70, s60
    s_mov_b32 s71, s61
    s_lshl_b32 s70, s70, 7
    s_lshl_b32 s71, s71, 2
    s_add_u32 s70, s70, s71
    s_add_u32 s70, s70, 3149824
    v_lshrrev_b32 v10, 3, v1
    v_lshlrev_b32 v10, 27, v10
    v_lshl_add_u32 v10, v1, 15, v10
    buffer_store_dword v0, v10, s[56:59], s70 offen sc1
L_mid:
    s_lshr_b32 s65, s5, 1
    s_and_b32 s66, s5, 1
    v_and_b32 v6, 15, v1
    s_mul_i32 s72, s3, 327680
    s_lshl_b32 s69, s60, 2
    s_add_u32 s74, s69, s5
    s_mul_i32 s69, s74, 20480
    s_add_u32 s72, s72, s69
    s_mul_i32 s69, s61, 2560
    s_add_u32 s72, s72, s69
    s_lshl_b32 s73, s3, 15
    s_lshl_b32 s69, s74, 11
    s_add_u32 s73, s73, s69
    s_add_u32 s73, s73, 2752512
    s_lshl_b32 s69, s61, 8
    s_add_u32 s77, s73, s69
    s_sub_u32 s69, s77, s72
    v_lshlrev_b32 v9, 7, v1
    v_and_b32 v10, 128, v9
    v_add_u32 v10, s69, v10
    v_cmp_gt_u32 vcc, 0, v1
    s_lshl_b32 s68, s65, 10
    s_and_b32 s69, s60, 1
    v_cndmask_b32 v9, v10, v9, vcc
    buffer_load_dword v229, v9, s[56:59], s72 offen sc1
    s_lshl_b32 s78, s69, 9
    s_add_u32 s68, s68, s78
    s_mul_i32 s75, s69, 640
    s_mul_i32 s69, s61, 80
    s_add_u32 s75, s75, s69
    s_lshl_b32 s75, s75, 7
    s_mul_i32 s69, s3, 327552
    s_add_u32 s75, s75, s69
    s_lshl_b32 s69, s3, 1
    s_lshr_b32 s78, s60, 1
    s_add_u32 s69, s69, s78
    s_lshl_b32 s78, s69, 6
    s_add_u32 s75, s75, s78
    s_add_u32 s75, s75, 4194304
    s_lshl_b32 s69, s69, 2
    s_add_u32 s68, s68, s69
    s_lshl_b32 s69, s66, 1
    s_add_u32 s68, s68, s69
    s_mul_i32 s68, s68, 1280
    s_mul_i32 s69, s61, 160
    s_add_u32 s68, s68, s69
    v_lshrrev_b32 v9, 2, v1
    v_lshlrev_b32 v9, 7, v9
    v_lshl_add_u32 v15, v5, 4, v9
    s_mul_i32 s78, s65, 5120
    s_add_u32 s78, s78, 149184
    s_lshl_b32 s69, s66, 5
    s_add_u32 s78, s78, s69
    v_lshlrev_b32 v9, 6, v4
    v_lshl_add_u32 v9, v5, 3, v9
    v_add_u32 v9, s78, v9
    v_lshl_add_u32 v13, v3, 9, v9
    v_lshl_add_u32 v14, v3, 8, v9
    s_mul_i32 s69, s5, 2560
    s_add_u32 s69, s69, 112640
    v_mul_u32_u24 v9, 160, v6
    v_add_u32 v9, s69, v9
    v_lshl_add_u32 v224, v3, 4, v9
    v_lshl_add_u32 v225, v3, 3, v9
    v_mov_b32 v9, 159424
    v_lshl_add_u32 v226, v3, 5, v9
    v_lshl_add_u32 v227, v3, 4, v9
    s_lshl_b32 s69, s5, 7
    s_add_u32 s69, s69, 161344
    v_lshlrev_b32 v9, 3, v6
    v_add_u32 v228, s69, v9
    v_lshlrev_b32 v9, 4, v6
    v_lshl_add_u32 v9, v3, 2, v9
    v_and_b32 v10, 1, v3
    v_lshl_add_u32 v30, v10, 26, v9
    v_lshrrev_b32 v9, 1, v3
    v_lshlrev_b32 v9, 8, v9
    v_lshl_add_u32 v9, v6, 4, v9
    v_and_b32 v10, 1, v3
    v_lshl_add_u32 v12, v10, 3, v9
    s_lshl_b32 s69, s74, 5
    s_add_u32 s69, s69, s63
    s_add_u32 s79, s69, 1280
    s_lshl_b32 s69, s61, 2
    s_add_u32 s80, s79, s69
    s_add_u32 s81, s80, 512
    s_mul_i32 s39, s5, 4096
    s_lshr_b32 s62, s4, 1
    s_mul_i32 s62, s62, 245760
    s_add_u32 s62, s62, s39
    s_add_u32 s62, s62, 20971520
    v_and_b32 v122, 15, v1
    v_min_u32 v122, 7, v122
    v_lshlrev_b32 v122, 2, v122
    v_lshl_add_u32 v122, v3, 7, v122
    s_lshr_b32 s38, s4, 2
    s_lshl_b32 s38, s38, 9
    s_add_u32 s38, s38, s63
    s_add_u32 s38, s38, 16384
    buffer_load_dword v123, v122, s[56:59], s38 offen sc1
    buffer_load_dwordx4 a[40:43], v2, s[56:59], s67 offen offset:2048 sc1
    buffer_load_dwordx4 a[44:47], v2, s[56:59], s67 offen offset:3072 sc1
    s_add_u32 s67, s67, 4096
    buffer_load_dwordx4 a[48:51], v2, s[56:59], s67 offen offset:0 sc1
    buffer_load_dwordx4 a[52:55], v2, s[56:59], s67 offen offset:1024 sc1
    buffer_load_dwordx4 a[56:59], v2, s[56:59], s67 offen offset:2048 sc1
    buffer_load_dwordx4 a[60:63], v2, s[56:59], s67 offen offset:3072 sc1
    s_add_u32 s67, s67, 4096
    buffer_load_dwordx4 a[64:67], v2, s[56:59], s67 offen offset:0 sc1
    buffer_load_dwordx4 a[68:71], v2, s[56:59], s67 offen offset:1024 sc1
    s_waitcnt vmcnt(8)
    v_cmp_ne_u32 vcc, s36, v123
    s_cbranch_vccnz Lapoll_1
Lok_2:
    s_add_u32 m0, s39, 0
    s_nop 0
    buffer_load_dwordx4 v2, s[56:59], s62 offen offset:0 sc1 lds
    buffer_load_dwordx4 v2, s[56:59], s62 offen offset:1024 sc1 lds
    buffer_load_dwordx4 v2, s[56:59], s62 offen offset:2048 sc1 lds
    buffer_load_dwordx4 v2, s[56:59], s62 offen offset:3072 sc1 lds
    s_add_u32 s62, s62, 12288
    buffer_load_dwordx4 a[72:75], v2, s[56:59], s67 offen offset:2048 sc1
    buffer_load_dwordx4 a[76:79], v2, s[56:59], s67 offen offset:3072 sc1
    s_add_u32 s67, s67, 4096
    buffer_load_dwordx4 a[80:83], v2, s[56:59], s67 offen offset:0 sc1
    s_add_u32 m0, s39, 12288
    s_nop 0
    buffer_load_dwordx4 v2, s[56:59], s62 offen offset:0 sc1 lds
    buffer_load_dwordx4 v2, s[56:59], s62 offen offset:1024 sc1 lds
    buffer_load_dwordx4 v2, s[56:59], s62 offen offset:2048 sc1 lds
    buffer_load_dwordx4 v2, s[56:59], s62 offen offset:3072 sc1 lds
    s_add_u32 s62, s62, 12288
    buffer_load_dwordx4 a[84:87], v2, s[56:59], s67 offen offset:1024 sc1
    buffer_load_dwordx4 a[88:91], v2, s[56:59], s67 offen offset:2048 sc1
    buffer_load_dwordx4 a[92:95], v2, s[56:59], s67 offen offset:3072 sc1
    s_add_u32 s67, s67, 4096
    s_cmp_eq_u32 s5, 2
    s_cbranch_scc1 L_prm
    s_lshl_b32 s38, s61, 9
    s_add_u32 s38, s38, s63
    s_add_u32 s38, s38, 4096
    s_mul_i32 s69, s5, 163840
    s_add_u32 s75, s75, s69
    s_mul_i32 s76, s5, 5120
    s_add_u32 s76, s76, 149184
    buffer_load_dword v123, v122, s[56:59], s38 offen sc1
    s_waitcnt vmcnt(0)
    v_cmp_ne_u32 vcc, s36, v123
    s_cbranch_vccnz Lapoll_3
Lok_4:
    s_add_u32 m0, s76, 0
    s_nop 0
    buffer_load_dwordx4 v15, s[56:59], s75 offen sc1 lds
    s_add_u32 s75, s75, 2048
    s_add_u32 m0, s76, 1024
    s_nop 0
    buffer_load_dwordx4 v15, s[56:59], s75 offen sc1 lds
    s_add_u32 s75, s75, 2048
    s_add_u32 m0, s76, 2048
    s_nop 0
    buffer_load_dwordx4 v15, s[56:59], s75 offen sc1 lds
    s_add_u32 s75, s75, 2048
    s_add_u32 m0, s76, 3072
    s_nop 0
    buffer_load_dwordx4 v15, s[56:59], s75 offen sc1 lds
    s_add_u32 s75, s75, 2048
    s_add_u32 m0, s76, 4096
    s_nop 0
    buffer_load_dwordx4 v15, s[56:59], s75 offen sc1 lds
    s_add_u32 s75, s75, 2048
    buffer_load_dwordx4 a[96:99], v2, s[56:59], s67 offen offset:0 sc1
    buffer_load_dwordx4 a[100:103], v2, s[56:59], s67 offen offset:1024 sc1
    buffer_load_dwordx4 a[104:107], v2, s[56:59], s67 offen offset:2048 sc1
    buffer_load_dwordx4 a[108:111], v2, s[56:59], s67 offen offset:3072 sc1
    s_add_u32 s67, s67, 4096
    s_branch L_join
L_prm:
    v_min_u32 v9, 59, v1
    v_lshlrev_b32 v247, 3, v9
    v_add_u32 v247, 159424, v247
    v_mul_u32_u24 v10, 1639, v9
    v_lshrrev_b32 v10, 16, v10
    v_mul_u32_u24 v244, 4480, v10
    v_cmp_eq_u32 vcc, 1, v10
    v_lshl_add_u32 v244, v9, 4, v244
    s_nop 0
    v_cndmask_b32 v248, 0, 1.0, vcc
    v_add_u32 v9, 60, v9
    v_mul_u32_u24 v10, 1639, v9
    v_lshrrev_b32 v10, 16, v10
    v_mul_u32_u24 v245, 4480, v10
    v_cmp_eq_u32 vcc, 1, v10
    v_lshl_add_u32 v245, v9, 4, v245
    s_nop 0
    v_cndmask_b32 v249, 0, 1.0, vcc
    v_lshlrev_b32 v246, 3, v1
    v_add_u32 v246, 161344, v246
    s_mul_i32 s38, s61, 640
    s_add_u32 s38, s38, 2621440
    s_lshl_b32 s101, s3, 12
    s_lshl_b32 s70, s60, 10
    s_add_u32 s101, s101, s70
    s_add_u32 s101, s101, 3014656
    s_add_u32 s69, s38, 0
    buffer_load_dwordx4 v[32:35], v244, s[56:59], s69 offen sc1
    buffer_load_dwordx4 v[36:39], v245, s[56:59], s69 offen sc1
    s_add_u32 s69, s38, 15360
    buffer_load_dwordx4 v[40:43], v244, s[56:59], s69 offen sc1
    buffer_load_dwordx4 v[44:47], v245, s[56:59], s69 offen sc1
    s_add_u32 s69, s38, 30720
    buffer_load_dwordx4 v[48:51], v244, s[56:59], s69 offen sc1
    buffer_load_dwordx4 v[52:55], v245, s[56:59], s69 offen sc1
    s_add_u32 s69, s38, 46080
    buffer_load_dwordx4 v[56:59], v244, s[56:59], s69 offen sc1
    buffer_load_dwordx4 v[60:63], v245, s[56:59], s69 offen sc1
    s_add_u32 s69, s38, 61440
    buffer_load_dwordx4 v[64:67], v244, s[56:59], s69 offen sc1
    buffer_load_dwordx4 v[68:71], v245, s[56:59], s69 offen sc1
    s_add_u32 s69, s38, 76800
    buffer_load_dwordx4 v[72:75], v244, s[56:59], s69 offen sc1
    buffer_load_dwordx4 v[76:79], v245, s[56:59], s69 offen sc1
    s_add_u32 s69, s38, 92160
    buffer_load_dwordx4 v[80:83], v244, s[56:59], s69 offen sc1
    buffer_load_dwordx4 v[84:87], v245, s[56:59], s69 offen sc1
    s_add_u32 s69, s38, 107520
    buffer_load_dwordx4 v[88:91], v244, s[56:59], s69 offen sc1
    buffer_load_dwordx4 v[92:95], v245, s[56:59], s69 offen sc1
    buffer_load_dwordx4 v[96:99], v2, s[56:59], s101 offen sc1
    buffer_load_dwordx4 a[96:99], v2, s[56:59], s67 offen offset:0 sc1
    buffer_load_dwordx4 a[100:103], v2, s[56:59], s67 offen offset:1024 sc1
    buffer_load_dwordx4 a[104:107], v2, s[56:59], s67 offen offset:2048 sc1
    buffer_load_dwordx4 a[108:111], v2, s[56:59], s67 offen offset:3072 sc1
    s_add_u32 s67, s67, 4096
    s_waitcnt vmcnt(4)
L_prmchk:
    v_min3_u32 v10, v0, v33, v35
    v_max3_u32 v11, v0, v33, v35
    v_min3_u32 v10, v10, v37, v39
    v_max3_u32 v11, v11, v37, v39
    v_min3_u32 v10, v10, v41, v43
    v_max3_u32 v11, v11, v41, v43
    v_min3_u32 v10, v10, v45, v47
    v_max3_u32 v11, v11, v45, v47
    v_min3_u32 v10, v10, v49, v51
    v_max3_u32 v11, v11, v49, v51
    v_min3_u32 v10, v10, v53, v55
    v_max3_u32 v11, v11, v53, v55
    v_min3_u32 v10, v10, v57, v59
    v_max3_u32 v11, v11, v57, v59
    v_min3_u32 v10, v10, v61, v63
    v_max3_u32 v11, v11, v61, v63
    v_min3_u32 v10, v10, v65, v67
    v_max3_u32 v11, v11, v65, v67
    v_min3_u32 v10, v10, v69, v71
    v_max3_u32 v11, v11, v69, v71
    v_min3_u32 v10, v10, v73, v75
    v_max3_u32 v11, v11, v73, v75
    v_min3_u32 v10, v10, v77, v79
    v_max3_u32 v11, v11, v77, v79
    v_min3_u32 v10, v10, v81, v83
    v_max3_u32 v11, v11, v81, v83
    v_min3_u32 v10, v10, v85, v87
    v_max3_u32 v11, v11, v85, v87
    v_min3_u32 v10, v10, v89, v91
    v_max3_u32 v11, v11, v89, v91
    v_min3_u32 v10, v10, v93, v95
    v_max3_u32 v11, v11, v93, v95
    v_cmp_ne_u32 vcc, v10, v11
    s_cbranch_vccnz L_prmagain
    v_add_f32 v32, v32, v48
    v_add_f32 v64, v64, v80
    v_add_f32 v34, v34, v50
    v_add_f32 v66, v66, v82
    v_add_f32 v36, v36, v52
    v_add_f32 v68, v68, v84
    v_add_f32 v38, v38, v54
    v_add_f32 v70, v70, v86
    v_add_f32 v40, v40, v56
    v_add_f32 v72, v72, v88
    v_add_f32 v42, v42, v58
    v_add_f32 v74, v74, v90
    v_add_f32 v44, v44, v60
    v_add_f32 v76, v76, v92
    v_add_f32 v46, v46, v62
    v_add_f32 v78, v78, v94
    v_add_f32 v32, v32, v64
    v_add_f32 v34, v34, v66
    v_add_f32 v36, v36, v68
    v_add_f32 v38, v38, v70
    v_add_f32 v40, v40, v72
    v_add_f32 v42, v42, v74
    v_add_f32 v44, v44, v76
    v_add_f32 v46, v46, v78
    v_cvt_pk_bf16_f32 v48, 0, v32
    v_cvt_pk_bf16_f32 v49, 0, v34
    v_cvt_pk_bf16_f32 v50, 0, v36
    v_cvt_pk_bf16_f32 v51, 0, v38
    v_cvt_pk_bf16_f32 v52, 0, v40
    v_cvt_pk_bf16_f32 v53, 0, v42
    v_cvt_pk_bf16_f32 v54, 0, v44
    v_cvt_pk_bf16_f32 v55, 0, v46
    v_add_f32 v48, v248, v48
    v_add_f32 v49, v248, v49
    v_add_f32 v50, v249, v50
    v_add_f32 v51, v249, v51
    v_add_f32 v52, v248, v52
    v_add_f32 v53, v248, v53
    v_add_f32 v54, v249, v54
    v_add_f32 v55, v249, v55
    v_cvt_pk_bf16_f32 v48, 0, v48
    v_cvt_pk_bf16_f32 v49, 0, v49
    v_cvt_pk_bf16_f32 v50, 0, v50
    v_cvt_pk_bf16_f32 v51, 0, v51
    v_cvt_pk_bf16_f32 v52, 0, v52
    v_cvt_pk_bf16_f32 v53, 0, v53
    v_cvt_pk_bf16_f32 v54, 0, v54
    v_cvt_pk_bf16_f32 v55, 0, v55
    ds_write_b64 v247, v[48:49] offset:0
    ds_write_b64 v247, v[50:51] offset:480
    ds_write_b64 v247, v[52:53] offset:960
    ds_write_b64 v247, v[54:55] offset:1440
L_st1chk:
    v_min3_u32 v10, v0, v97, v99
    v_max3_u32 v11, v0, v97, v99
    v_cmp_ne_u32 vcc, v10, v11
    s_cbranch_vccnz L_st1again
    v_mov_b32 v97, v98
    ds_write_b64 v246, v[96:97]
    s_waitcnt lgkmcnt(0)
    s_branch L_join
L_late:
    v_mov_b32 v9, 161988
    s_cmp_lt_u32 s4, 16
    s_cselect_b32 s71, 2, 1
    s_mov_b64 exec, 1
    s_waitcnt vmcnt(0)
    ds_add_rtn_u32 v11, v9, v25
    s_waitcnt lgkmcnt(0)
    v_readfirstlane_b32 s69, v11
    s_mov_b64 exec, -1
    s_cmp_lg_u32 s69, s71
    s_cbranch_scc1 L_late2
    s_lshl_b32 s70, s3, 2
    s_add_u32 s70, s70, s60
    s_mov_b32 s71, s61
    s_lshl_b32 s70, s70, 7
    s_lshl_b32 s71, s71, 2
    s_add_u32 s70, s70, s71
    s_add_u32 s70, s70, 3149824
    v_lshrrev_b32 v10, 3, v1
    v_lshlrev_b32 v10, 27, v10
    v_lshl_add_u32 v10, v1, 15, v10
    buffer_store_dword v0, v10, s[56:59], s70 offen sc1
    s_branch L_late2
L_noconv:
    s_barrier
    s_lshl_b32 s69, s61, 2
    s_add_u32 s69, s69, s5
    s_mul_i32 s67, s69, 61440
    s_add_u32 s67, s67, 10485760
    s_nop 1
    v_mov_b32 v9, 161992
Llw_5:
    ds_read_b32 v10, v9
    s_waitcnt lgkmcnt(0)
    v_readfirstlane_b32 s69, v10
    s_nop 0
    s_cmp_lg_u32 s69, 0
    s_cbranch_scc1 Lok_6
    s_sub_u32 s7, s7, 1
    s_cbranch_scc0 Llw_5
    s_endpgm
Lok_6:
L_late2:
Lpoll_7:
    buffer_load_dword v123, v122, s[56:59], s38 offen sc1
    s_waitcnt vmcnt(0)
    v_cmp_ne_u32 vcc, s36, v123
    s_cbranch_vccz Lok_8
    s_sleep 1
    s_sub_u32 s7, s7, 1
    s_cbranch_scc0 Lpoll_7
    s_endpgm
Lok_8:
    buffer_load_dwordx4 a[0:3], v2, s[56:59], s67 offen offset:0 sc1
    buffer_load_dwordx4 a[4:7], v2, s[56:59], s67 offen offset:1024 sc1
    buffer_load_dwordx4 a[8:11], v2, s[56:59], s67 offen offset:2048 sc1
    buffer_load_dwordx4 a[12:15], v2, s[56:59], s67 offen offset:3072 sc1
    s_add_u32 s67, s67, 4096
    buffer_load_dwordx4 a[16:19], v2, s[56:59], s67 offen offset:0 sc1
    buffer_load_dwordx4 a[20:23], v2, s[56:59], s67 offen offset:1024 sc1
    buffer_load_dwordx4 a[24:27], v2, s[56:59], s67 offen offset:2048 sc1
    buffer_load_dwordx4 a[28:31], v2, s[56:59], s67 offen offset:3072 sc1
    s_add_u32 s67, s67, 4096
    buffer_load_dwordx4 a[32:35], v2, s[56:59], s67 offen offset:0 sc1
    buffer_load_dwordx4 a[36:39], v2, s[56:59], s67 offen offset:1024 sc1
    s_branch L_mid
L_w3:
    s_mov_b32 s44, s28
    s_mov_b32 s45, s29
    s_mov_b32 s46, 1280
    s_mov_b32 s47, 0x20000
    v_mov_b32 v7, 161984
    ds_write_b64 v7, v[10:11]
    ds_write_b64 v7, v[10:11] offset:8
    s_sub_u32 s80, s2, 16
    s_cmp_lt_u32 s2, 240
    s_cselect_b32 s80, s2, s80
    s_mul_i32 s76, s80, 1093
    s_lshr_b32 s76, s76, 16
    s_mul_i32 s77, s76, 60
    s_sub_u32 s77, s80, s77
    v_lshlrev_b32 v9, 1, v1
    s_mul_i32 s69, s76, 320
    buffer_load_ushort v16, v9, s[44:47], s69 offen offset:0
    buffer_load_ushort v17, v9, s[44:47], s69 offen offset:128
    buffer_load_ushort v18, v9, s[44:47], s69 offen offset:256
    v_min_u32 v9, 4, v1
    v_mul_u32_u24 v9, 4096, v9
    s_lshl_b32 s69, s4, 7
    s_add_u32 s69, s69, s63
    buffer_load_dword v19, v9, s[56:59], s69 offen sc1
    s_mov_b32 s44, s26
    s_mov_b32 s45, s27
    s_mov_b32 s46, 1966080
    s_mov_b32 s47, 0x20000
    s_mov_b32 s40, s30
    s_mov_b32 s41, s31
    s_mov_b32 s42, 4915200
    s_mov_b32 s43, 0x20000
    s_mul_i32 s65, s80, 13108
    s_lshr_b32 s65, s65, 16
    s_mul_i32 s66, s65, 5
    s_sub_u32 s66, s80, s66
    s_mul_i32 s67, s65, 40960
    s_lshl_b32 s69, s66, 8
    s_add_u32 s68, s67, s69
    v_mul_u32_u24 v26, 1280, v3
    v_and_b32 v9, 15, v1
    v_lshl_add_u32 v26, v9, 4, v26
    v_lshrrev_b32 v10, 3, v1
    v_and_b32 v11, 7, v1
    v_mul_u32_u24 v8, 7680, v10
    v_lshl_add_u32 v8, v11, 4, v8
    s_mul_i32 s80, s76, 1228800
    s_lshl_b32 s69, s77, 7
    s_add_u32 s80, s80, s69
    s_waitcnt lgkmcnt(0)
    v_mul_u32_u24 v9, 81920, v10
    v_lshl_add_u32 v9, v11, 4, v9
    s_and_b32 s69, s60, 1
    s_lshl_b32 s101, s69, 9
    s_lshr_b32 s69, s60, 1
    s_lshl_b32 s69, s69, 2
    s_add_u32 s101, s101, s69
    s_lshl_b32 s69, s3, 3
    s_add_u32 s101, s101, s69
    s_lshr_b32 s81, s61, 2
    s_lshl_b32 s81, s81, 10
    s_and_b32 s69, s61, 3
    s_add_u32 s81, s81, s69
    s_add_u32 s81, s81, s101
    s_mul_i32 s81, s81, 1280
    s_mul_i32 s101, s101, 1280
    s_mul_i32 s69, s61, 160
    s_add_u32 s101, s101, s69
    v_mul_u32_u24 v12, 80, v10
    v_add_u32 v12, 161344, v12
    v_mul_u32_u24 v13, 80, v11
    v_lshl_add_u32 v13, v10, 2, v13
    v_add_u32 v13, 161344, v13
    v_lshlrev_b32 v27, 11, v3
    v_lshl_add_u32 v27, v4, 8, v27
    v_add_u32 v27, 81920, v27
    v_and_b32 v6, 1, v5
    v_lshlrev_b32 v6, 4, v6
    v_lshrrev_b32 v15, 1, v5
    v_lshl_add_u32 v6, v15, 3, v6
    v_add_u32 v23, v27, v6
    v_lshl_add_u32 v27, v5, 3, v27
    v_bfe_u32 v6, v1, 3, 1
    v_mul_u32_u24 v6, 896, v6
    v_add_u32 v24, v6, v2
    s_mul_i32 s69, s65, 21846
    s_lshr_b32 s69, s69, 16
    s_mul_i32 s71, s69, 3
    s_sub_u32 s71, s65, s71
    s_and_b32 s72, s69, 3
    s_lshl_b32 s78, s72, 1
    s_add_u32 s78, s78, s71
    s_add_u32 s78, s78, 4
    s_cmp_eq_u32 s71, 2
    s_cselect_b32 s78, s72, s78
    s_lshr_b32 s69, s69, 2
    s_mul_i32 s69, s69, 12
    s_add_u32 s78, s78, s69
    s_mul_i32 s78, s78, 5120
    s_add_u32 s78, s78, 10485760
    s_lshl_b32 s79, s66, 3
    s_add_u32 s69, s79, 0
    s_mul_i32 s72, s69, 13108
    s_lshr_b32 s72, s72, 16
    s_mul_i32 s71, s72, 5
    s_sub_u32 s69, s69, s71
    s_cmp_eq_u32 s69, 4
    s_cselect_b64 vcc, -1, 0
    v_cndmask_b32 v152, v23, v27, vcc
    v_cndmask_b32 v216, v24, v2, vcc
    s_mul_i32 s72, s72, 245760
    s_lshr_b32 s71, s69, 1
    s_lshl_b32 s71, s71, 11
    s_add_u32 s72, s72, s71
    s_and_b32 s71, s69, 1
    s_lshl_b32 s71, s71, 7
    s_add_u32 s72, s72, s71
    v_add_u32 v216, s72, v216
    s_add_u32 s69, s79, 1
    s_mul_i32 s72, s69, 13108
    s_lshr_b32 s72, s72, 16
    s_mul_i32 s71, s72, 5
    s_sub_u32 s69, s69, s71
    s_cmp_eq_u32 s69, 4
    s_cselect_b64 vcc, -1, 0
    v_cndmask_b32 v153, v23, v27, vcc
    v_cndmask_b32 v217, v24, v2, vcc
    s_mul_i32 s72, s72, 245760
    s_lshr_b32 s71, s69, 1
    s_lshl_b32 s71, s71, 11
    s_add_u32 s72, s72, s71
    s_and_b32 s71, s69, 1
    s_lshl_b32 s71, s71, 7
    s_add_u32 s72, s72, s71
    v_add_u32 v217, s72, v217
    s_add_u32 s69, s79, 2
    s_mul_i32 s72, s69, 13108
    s_lshr_b32 s72, s72, 16
    s_mul_i32 s71, s72, 5
    s_sub_u32 s69, s69, s71
    s_cmp_eq_u32 s69, 4
    s_cselect_b64 vcc, -1, 0
    v_cndmask_b32 v154, v23, v27, vcc
    v_cndmask_b32 v218, v24, v2, vcc
    s_mul_i32 s72, s72, 245760
    s_lshr_b32 s71, s69, 1
    s_lshl_b32 s71, s71, 11
    s_add_u32 s72, s72, s71
    s_and_b32 s71, s69, 1
    s_lshl_b32 s71, s71, 7
    s_add_u32 s72, s72, s71
    v_add_u32 v218, s72, v218
    s_add_u32 s69, s79, 3
    s_mul_i32 s72, s69, 13108
    s_lshr_b32 s72, s72, 16
    s_mul_i32 s71, s72, 5
    s_sub_u32 s69, s69, s71
    s_cmp_eq_u32 s69, 4
    s_cselect_b64 vcc, -1, 0
    v_cndmask_b32 v155, v23, v27, vcc
    v_cndmask_b32 v219, v24, v2, vcc
    s_mul_i32 s72, s72, 245760
    s_lshr_b32 s71, s69, 1
    s_lshl_b32 s71, s71, 11
    s_add_u32 s72, s72, s71
    s_and_b32 s71, s69, 1
    s_lshl_b32 s71, s71, 7
    s_add_u32 s72, s72, s71
    v_add_u32 v219, s72, v219
    s_add_u32 s69, s79, 4
    s_mul_i32 s72, s69, 13108
    s_lshr_b32 s72, s72, 16
    s_mul_i32 s71, s72, 5
    s_sub_u32 s69, s69, s71
    s_cmp_eq_u32 s69, 4
    s_cselect_b64 vcc, -1, 0
    v_cndmask_b32 v156, v23, v27, vcc
    v_cndmask_b32 v220, v24, v2, vcc
    s_mul_i32 s72, s72, 245760
    s_lshr_b32 s71, s69, 1
    s_lshl_b32 s71, s71, 11
    s_add_u32 s72, s72, s71
    s_and_b32 s71, s69, 1
    s_lshl_b32 s71, s71, 7
    s_add_u32 s72, s72, s71
    v_add_u32 v220, s72, v220
    s_add_u32 s69, s79, 5
    s_mul_i32 s72, s69, 13108
    s_lshr_b32 s72, s72, 16
    s_mul_i32 s71, s72, 5
    s_sub_u32 s69, s69, s71
    s_cmp_eq_u32 s69, 4
    s_cselect_b64 vcc, -1, 0
    v_cndmask_b32 v157, v23, v27, vcc
    v_cndmask_b32 v221, v24, v2, vcc
    s_mul_i32 s72, s72, 245760
    s_lshr_b32 s71, s69, 1
    s_lshl_b32 s71, s71, 11
    s_add_u32 s72, s72, s71
    s_and_b32 s71, s69, 1
    s_lshl_b32 s71, s71, 7
    s_add_u32 s72, s72, s71
    v_add_u32 v221, s72, v221
    s_add_u32 s69, s79, 6
    s_mul_i32 s72, s69, 13108
    s_lshr_b32 s72, s72, 16
    s_mul_i32 s71, s72, 5
    s_sub_u32 s69, s69, s71
    s_cmp_eq_u32 s69, 4
    s_cselect_b64 vcc, -1, 0
    v_cndmask_b32 v158, v23, v27, vcc
    v_cndmask_b32 v222, v24, v2, vcc
    s_mul_i32 s72, s72, 245760
    s_lshr_b32 s71, s69, 1
    s_lshl_b32 s71, s71, 11
    s_add_u32 s72, s72, s71
    s_and_b32 s71, s69, 1
    s_lshl_b32 s71, s71, 7
    s_add_u32 s72, s72, s71
    v_add_u32 v222, s72, v222
    s_add_u32 s69, s79, 7
    s_mul_i32 s72, s69, 13108
    s_lshr_b32 s72, s72, 16
    s_mul_i32 s71, s72, 5
    s_sub_u32 s69, s69, s71
    s_cmp_eq_u32 s69, 4
    s_cselect_b64 vcc, -1, 0
    v_cndmask_b32 v159, v23, v27, vcc
    v_cndmask_b32 v223, v24, v2, vcc
    s_mul_i32 s72, s72, 245760
    s_lshr_b32 s71, s69, 1
    s_lshl_b32 s71, s71, 11
    s_add_u32 s72, s72, s71
    s_and_b32 s71, s69, 1
    s_lshl_b32 s71, s71, 7
    s_add_u32 s72, s72, s71
    v_add_u32 v223, s72, v223
    v_add_u32 v6, 0, v1
    v_mul_u32_u24 v15, 2731, v6
    v_lshrrev_b32 v15, 16, v15
    v_mul_u32_u24 v15, 2688, v15
    v_lshl_add_u32 v232, v6, 4, v15
    v_add_u32 v6, 64, v1
    v_mul_u32_u24 v15, 2731, v6
    v_lshrrev_b32 v15, 16, v15
    v_mul_u32_u24 v15, 2688, v15
    v_lshl_add_u32 v233, v6, 4, v15
    v_add_u32 v6, 128, v1
    v_mul_u32_u24 v15, 2731, v6
    v_lshrrev_b32 v15, 16, v15
    v_mul_u32_u24 v15, 2688, v15
    v_lshl_add_u32 v234, v6, 4, v15
    s_lshr_b32 s69, s2, 4
    s_mul_i32 s62, s69, 122880
    s_mul_i32 s39, s69, 5
    s_bfe_u32 s69, s2, 0x30001
    s_mul_i32 s38, s69, 491520
    s_mul_i32 s69, s69, 384
    s_add_u32 s62, s62, s69
    s_and_b32 s69, s2, 1
    s_mul_i32 s71, s69, 6144
    s_add_u32 s38, s38, s71
    s_add_u32 s38, s38, 20971520
    s_cmp_eq_u32 s69, 0
    s_cselect_b32 s48, s22, s24
    s_cselect_b32 s49, s23, s25
    s_mov_b32 s50, 1966080
    s_mov_b32 s51, 0x20000
    v_mul_u32_u24 v235, 384, v4
    v_mul_u32_u24 v6, 96, v3
    v_add_u32 v235, v235, v6
    v_lshl_add_u32 v235, v5, 3, v235
    v_add_u32 v235, 90112, v235
    v_lshrrev_b32 v6, 1, v3
    v_mul_u32_u24 v245, 245760, v6
    v_and_b32 v6, 1, v3
    v_mul_u32_u24 v6, 3072, v6
    v_add_u32 v245, v245, v6
    v_and_b32 v6, 15, v1
    v_lshl_add_u32 v245, v6, 4, v245
    s_barrier
    s_add_u32 s69, s68, 0
    s_mov_b32 m0, 81920
    s_nop 0
    buffer_load_dwordx4 v26, s[44:47], s69 offen nt lds
    s_add_u32 s69, s68, 20480
    s_mov_b32 m0, 82944
    s_nop 0
    buffer_load_dwordx4 v26, s[44:47], s69 offen nt lds
    s_add_u32 s69, s68, 5120
    s_mov_b32 m0, 83968
    s_nop 0
    buffer_load_dwordx4 v26, s[44:47], s69 offen nt lds
    s_add_u32 s69, s68, 25600
    s_mov_b32 m0, 84992
    s_nop 0
    buffer_load_dwordx4 v26, s[44:47], s69 offen nt lds
    s_add_u32 s69, s68, 10240
    s_mov_b32 m0, 86016
    s_nop 0
    buffer_load_dwordx4 v26, s[44:47], s69 offen nt lds
    s_add_u32 s69, s68, 30720
    s_mov_b32 m0, 87040
    s_nop 0
    buffer_load_dwordx4 v26, s[44:47], s69 offen nt lds
    s_add_u32 s69, s68, 15360
    s_mov_b32 m0, 88064
    s_nop 0
    buffer_load_dwordx4 v26, s[44:47], s69 offen nt lds
    s_add_u32 s69, s68, 35840
    s_mov_b32 m0, 89088
    s_nop 0
    buffer_load_dwordx4 v26, s[44:47], s69 offen nt lds
    s_mov_b32 m0, 90112
    s_nop 0
    buffer_load_dwordx4 v232, s[48:51], s62 offen nt lds
    s_mov_b32 m0, 91136
    s_nop 0
    buffer_load_dwordx4 v233, s[48:51], s62 offen nt lds
    s_mov_b32 m0, 92160
    s_nop 0
    buffer_load_dwordx4 v234, s[48:51], s62 offen nt lds
    s_add_u32 s62, s62, 24576
    s_mov_b32 m0, 93184
    s_nop 0
    buffer_load_dwordx4 v232, s[48:51], s62 offen nt lds
    s_mov_b32 m0, 94208
    s_nop 0
    buffer_load_dwordx4 v233, s[48:51], s62 offen nt lds
    s_mov_b32 m0, 95232
    s_nop 0
    buffer_load_dwordx4 v234, s[48:51], s62 offen nt lds
    s_add_u32 s62, s62, 24576
    v_add_u32 v6, 0, v1
    v_mul_u32_u24 v7, 6554, v6
    v_lshrrev_b32 v7, 16, v7
    v_mul_u32_u24 v10, 160, v7
    v_lshlrev_b32 v6, 4, v6
    v_sub_u32 v6, v6, v10
    v_and_b32 v10, 7, v7
    v_lshlrev_b32 v10, 6, v10
    v_lshrrev_b32 v7, 3, v7
    v_add_u32 v10, v10, v7
    v_mul_u32_u24 v10, 1280, v10
    v_add_u32 v240, v6, v10
    v_add_u32 v6, 64, v1
    v_mul_u32_u24 v7, 6554, v6
    v_lshrrev_b32 v7, 16, v7
    v_mul_u32_u24 v10, 160, v7
    v_lshlrev_b32 v6, 4, v6
    v_sub_u32 v6, v6, v10
    v_and_b32 v10, 7, v7
    v_lshlrev_b32 v10, 6, v10
    v_lshrrev_b32 v7, 3, v7
    v_add_u32 v10, v10, v7
    v_mul_u32_u24 v10, 1280, v10
    v_add_u32 v241, v6, v10
    v_add_u32 v6, 128, v1
    v_mul_u32_u24 v7, 6554, v6
    v_lshrrev_b32 v7, 16, v7
    v_mul_u32_u24 v10, 160, v7
    v_lshlrev_b32 v6, 4, v6
    v_sub_u32 v6, v6, v10
    v_and_b32 v10, 7, v7
    v_lshlrev_b32 v10, 6, v10
    v_lshrrev_b32 v7, 3, v7
    v_add_u32 v10, v10, v7
    v_mul_u32_u24 v10, 1280, v10
    v_add_u32 v242, v6, v10
    v_add_u32 v6, 192, v1
    v_mul_u32_u24 v7, 6554, v6
    v_lshrrev_b32 v7, 16, v7
    v_mul_u32_u24 v10, 160, v7
    v_lshlrev_b32 v6, 4, v6
    v_sub_u32 v6, v6, v10
    v_and_b32 v10, 7, v7
    v_lshlrev_b32 v10, 6, v10
    v_lshrrev_b32 v7, 3, v7
    v_add_u32 v10, v10, v7
    v_mul_u32_u24 v10, 1280, v10
    v_add_u32 v243, v6, v10
    v_add_u32 v6, 256, v1
    v_mul_u32_u24 v7, 6554, v6
    v_lshrrev_b32 v7, 16, v7
    v_mul_u32_u24 v10, 160, v7
    v_lshlrev_b32 v6, 4, v6
    v_sub_u32 v6, v6, v10
    v_and_b32 v10, 7, v7
    v_lshlrev_b32 v10, 6, v10
    v_lshrrev_b32 v7, 3, v7
    v_add_u32 v10, v10, v7
    v_mul_u32_u24 v10, 1280, v10
    v_add_u32 v244, v6, v10
    s_waitcnt vmcnt(14)
    v_lshlrev_b32 v16, 16, v16
    v_mul_f32 v20, 0xbfb8aa3b, v16
    v_exp_f32 v20, v20
    s_nop 0
    v_add_f32 v20, 1.0, v20
    v_rcp_f32 v20, v20
    s_nop 0
    v_mul_f32 v20, v20, v16
    v_cvt_pk_bf16_f32 v20, v20, 0
    v_lshlrev_b32 v17, 16, v17
    v_mul_f32 v21, 0xbfb8aa3b, v17
    v_exp_f32 v21, v21
    s_nop 0
    v_add_f32 v21, 1.0, v21
    v_rcp_f32 v21, v21
    s_nop 0
    v_mul_f32 v21, v21, v17
    v_cvt_pk_bf16_f32 v21, v21, 0
    v_lshlrev_b32 v18, 16, v18
    v_mul_f32 v22, 0xbfb8aa3b, v18
    v_exp_f32 v22, v22
    s_nop 0
    v_add_f32 v22, 1.0, v22
    v_rcp_f32 v22, v22
    s_nop 0
    v_mul_f32 v22, v22, v18
    v_cvt_pk_bf16_f32 v22, v22, 0
    ds_write_b32 v13, v20
    ds_write_b32 v13, v21 offset:32
    s_mov_b32 exec_hi, 0
    ds_write_b32 v13, v22 offset:64
    s_mov_b64 exec, -1
    ds_read_b128 v[160:163], v12 offset:0
    ds_read_b128 v[164:167], v12 offset:16
    ds_read_b128 v[168:171], v12 offset:32
    ds_read_b128 v[172:175], v12 offset:48
    ds_read_b128 v[176:179], v12 offset:64
    s_waitcnt vmcnt(6)
    ds_read_b64_tr_b16 v[184:185], v152 offset:0
    ds_read_b64_tr_b16 v[186:187], v152 offset:1024
    ds_read_b64_tr_b16 v[188:189], v153 offset:32
    ds_read_b64_tr_b16 v[190:191], v153 offset:1056
    ds_read_b64_tr_b16 v[192:193], v154 offset:64
    ds_read_b64_tr_b16 v[194:195], v154 offset:1088
    ds_read_b64_tr_b16 v[196:197], v155 offset:96
    ds_read_b64_tr_b16 v[198:199], v155 offset:1120
    s_waitcnt lgkmcnt(0)
    ds_read_b64_tr_b16 v[200:201], v156 offset:128
    ds_read_b64_tr_b16 v[202:203], v156 offset:1152
    ds_read_b64_tr_b16 v[204:205], v157 offset:160
    ds_read_b64_tr_b16 v[206:207], v157 offset:1184
    ds_read_b64_tr_b16 v[208:209], v158 offset:192
    ds_read_b64_tr_b16 v[210:211], v158 offset:1216
    ds_read_b64_tr_b16 v[212:213], v159 offset:224
    ds_read_b64_tr_b16 v[214:215], v159 offset:1248
    buffer_store_dwordx4 v[184:187], v216, s[56:59], s78 offen sc1
    buffer_store_dwordx4 v[188:191], v217, s[56:59], s78 offen sc1
    buffer_store_dwordx4 v[192:195], v218, s[56:59], s78 offen sc1
    buffer_store_dwordx4 v[196:199], v219, s[56:59], s78 offen sc1
    s_waitcnt lgkmcnt(0)
    buffer_store_dwordx4 v[200:203], v220, s[56:59], s78 offen sc1
    buffer_store_dwordx4 v[204:207], v221, s[56:59], s78 offen sc1
    buffer_store_dwordx4 v[208:211], v222, s[56:59], s78 offen sc1
    buffer_store_dwordx4 v[212:215], v223, s[56:59], s78 offen sc1
    s_mov_b32 s52, s8
    s_mov_b32 s53, s9
    s_mov_b32 s54, 2621440
    s_mov_b32 s55, 0x20000
    s_barrier
    s_mov_b32 m0, 96256
    s_nop 0
    buffer_load_dwordx4 v232, s[48:51], s62 offen nt lds
    s_mov_b32 m0, 97280
    s_nop 0
    buffer_load_dwordx4 v233, s[48:51], s62 offen nt lds
    s_mov_b32 m0, 98304
    s_nop 0
    buffer_load_dwordx4 v234, s[48:51], s62 offen nt lds
    s_add_u32 s62, s62, 24576
    s_mov_b32 m0, 99328
    s_nop 0
    buffer_load_dwordx4 v232, s[48:51], s62 offen nt lds
    s_mov_b32 m0, 100352
    s_nop 0
    buffer_load_dwordx4 v233, s[48:51], s62 offen nt lds
    s_mov_b32 m0, 101376
    s_nop 0
    buffer_load_dwordx4 v234, s[48:51], s62 offen nt lds
    s_add_u32 s62, s62, 24576
    s_mov_b32 m0, 102400
    s_nop 0
    buffer_load_dwordx4 v232, s[48:51], s62 offen nt lds
    s_mov_b32 m0, 103424
    s_nop 0
    buffer_load_dwordx4 v233, s[48:51], s62 offen nt lds
    s_mov_b32 m0, 104448
    s_nop 0
    buffer_load_dwordx4 v234, s[48:51], s62 offen nt lds
    s_add_u32 s62, s62, 24576
    buffer_load_dwordx4 v[32:35], v8, s[40:43], s80 offen nt
    s_add_u32 s80, s80, 61440
    buffer_load_dwordx4 v[36:39], v8, s[40:43], s80 offen nt
    s_add_u32 s80, s80, 61440
    buffer_load_dwordx4 v[40:43], v8, s[40:43], s80 offen nt
    s_add_u32 s80, s80, 61440
    buffer_load_dwordx4 v[44:47], v8, s[40:43], s80 offen nt
    s_add_u32 s80, s80, 61440
    buffer_load_dwordx4 v[48:51], v8, s[40:43], s80 offen nt
    s_add_u32 s80, s80, 61440
    buffer_load_dwordx4 v[52:55], v8, s[40:43], s80 offen nt
    s_add_u32 s80, s80, 61440
    v_mov_b32 v7, 161984
Llw_9:
    ds_read_b32 v15, v7
    s_waitcnt lgkmcnt(0)
    v_readfirstlane_b32 s6, v15
    s_nop 0
    s_cmp_lg_u32 s6, 0
    s_cbranch_scc1 Lok_10
    s_sub_u32 s7, s7, 1
    s_cbranch_scc0 Llw_9
    s_endpgm
Lok_10:
    ds_read_b32 v0, v7 offset:12
    s_waitcnt lgkmcnt(0)
    v_readfirstlane_b32 s36, v0
    s_waitcnt vmcnt(15)
    s_mul_i32 s70, s65, 21846
    s_lshr_b32 s70, s70, 16
    s_mul_i32 s71, s70, 3
    s_sub_u32 s71, s65, s71
    s_mul_i32 s71, s71, 5
    s_add_u32 s71, s71, s66
    s_lshl_b32 s70, s70, 7
    s_lshl_b32 s71, s71, 2
    s_add_u32 s70, s70, s71
    s_add_u32 s70, s70, 3153920
    v_lshrrev_b32 v10, 3, v1
    v_lshlrev_b32 v10, 27, v10
    v_lshl_add_u32 v10, v1, 15, v10
    buffer_store_dword v0, v10, s[56:59], s70 offen sc1
    ds_read_b64_tr_b16 v[184:185], v235 offset:0
    ds_read_b64_tr_b16 v[186:187], v235 offset:1536
    ds_read_b64_tr_b16 v[188:189], v235 offset:32
    ds_read_b64_tr_b16 v[190:191], v235 offset:1568
    ds_read_b64_tr_b16 v[192:193], v235 offset:64
    ds_read_b64_tr_b16 v[194:195], v235 offset:1600
    buffer_load_dwordx4 v[56:59], v8, s[40:43], s80 offen nt
    s_add_u32 s80, s80, 61440
    buffer_load_dwordx4 v[60:63], v8, s[40:43], s80 offen nt
    s_add_u32 s80, s80, 61440
    s_lshr_b32 s69, s39, 2
    s_mul_i32 s69, s69, 11264
    s_lshl_b32 s72, s39, 8
    s_add_u32 s69, s69, s72
    s_add_u32 s69, s69, s38
    s_add_u32 s39, s39, 1
    s_waitcnt lgkmcnt(0)
    buffer_store_dwordx4 v[184:187], v245, s[56:59], s69 offen offset:0 sc1
    buffer_store_dwordx4 v[188:191], v245, s[56:59], s69 offen offset:1024 sc1
    buffer_store_dwordx4 v[192:195], v245, s[56:59], s69 offen offset:2048 sc1
    ds_read_b64_tr_b16 v[196:197], v235 offset:3072
    ds_read_b64_tr_b16 v[198:199], v235 offset:4608
    ds_read_b64_tr_b16 v[200:201], v235 offset:3104
    ds_read_b64_tr_b16 v[202:203], v235 offset:4640
    ds_read_b64_tr_b16 v[204:205], v235 offset:3136
    ds_read_b64_tr_b16 v[206:207], v235 offset:4672
    buffer_load_dwordx4 v[64:67], v8, s[40:43], s80 offen nt
    s_add_u32 s80, s80, 61440
    buffer_load_dwordx4 v[68:71], v8, s[40:43], s80 offen nt
    s_add_u32 s80, s80, 61440
    s_lshr_b32 s69, s39, 2
    s_mul_i32 s69, s69, 11264
    s_lshl_b32 s72, s39, 8
    s_add_u32 s69, s69, s72
    s_add_u32 s69, s69, s38
    s_add_u32 s39, s39, 1
    s_waitcnt lgkmcnt(0)
    buffer_store_dwordx4 v[196:199], v245, s[56:59], s69 offen offset:0 sc1
    buffer_store_dwordx4 v[200:203], v245, s[56:59], s69 offen offset:1024 sc1
    buffer_store_dwordx4 v[204:207], v245, s[56:59], s69 offen offset:2048 sc1
    s_waitcnt vmcnt(23)
    ds_read_b64_tr_b16 v[184:185], v235 offset:6144
    ds_read_b64_tr_b16 v[186:187], v235 offset:7680
    ds_read_b64_tr_b16 v[188:189], v235 offset:6176
    ds_read_b64_tr_b16 v[190:191], v235 offset:7712
    ds_read_b64_tr_b16 v[192:193], v235 offset:6208
    ds_read_b64_tr_b16 v[194:195], v235 offset:7744
    buffer_load_dwordx4 v[72:75], v8, s[40:43], s80 offen nt
    s_add_u32 s80, s80, 61440
    buffer_load_dwordx4 v[76:79], v8, s[40:43], s80 offen nt
    s_add_u32 s80, s80, 61440
    s_lshr_b32 s69, s39, 2
    s_mul_i32 s69, s69, 11264
    s_lshl_b32 s72, s39, 8
    s_add_u32 s69, s69, s72
    s_add_u32 s69, s69, s38
    s_add_u32 s39, s39, 1
    s_waitcnt lgkmcnt(0)
    buffer_store_dwordx4 v[184:187], v245, s[56:59], s69 offen offset:0 sc1
    buffer_store_dwordx4 v[188:191], v245, s[56:59], s69 offen offset:1024 sc1
    buffer_store_dwordx4 v[192:195], v245, s[56:59], s69 offen offset:2048 sc1
    s_waitcnt vmcnt(25)
    ds_read_b64_tr_b16 v[196:197], v235 offset:9216
    ds_read_b64_tr_b16 v[198:199], v235 offset:10752
    ds_read_b64_tr_b16 v[200:201], v235 offset:9248
    ds_read_b64_tr_b16 v[202:203], v235 offset:10784
    ds_read_b64_tr_b16 v[204:205], v235 offset:9280
    ds_read_b64_tr_b16 v[206:207], v235 offset:10816
    buffer_load_dwordx4 v[80:83], v8, s[40:43], s80 offen nt
    s_add_u32 s80, s80, 61440
    buffer_load_dwordx4 v[84:87], v8, s[40:43], s80 offen nt
    s_add_u32 s80, s80, 61440
    s_lshr_b32 s69, s39, 2
    s_mul_i32 s69, s69, 11264
    s_lshl_b32 s72, s39, 8
    s_add_u32 s69, s69, s72
    s_add_u32 s69, s69, s38
    s_add_u32 s39, s39, 1
    s_waitcnt lgkmcnt(0)
    buffer_store_dwordx4 v[196:199], v245, s[56:59], s69 offen offset:0 sc1
    buffer_store_dwordx4 v[200:203], v245, s[56:59], s69 offen offset:1024 sc1
    buffer_store_dwordx4 v[204:207], v245, s[56:59], s69 offen offset:2048 sc1
    s_waitcnt vmcnt(27)
    ds_read_b64_tr_b16 v[184:185], v235 offset:12288
    ds_read_b64_tr_b16 v[186:187], v235 offset:13824
    ds_read_b64_tr_b16 v[188:189], v235 offset:12320
    ds_read_b64_tr_b16 v[190:191], v235 offset:13856
    ds_read_b64_tr_b16 v[192:193], v235 offset:12352
    ds_read_b64_tr_b16 v[194:195], v235 offset:13888
    buffer_load_dwordx4 v[88:91], v8, s[40:43], s80 offen nt
    s_add_u32 s80, s80, 61440
    buffer_load_dwordx4 v[92:95], v8, s[40:43], s80 offen nt
    s_add_u32 s80, s80, 61440
    s_lshr_b32 s69, s39, 2
    s_mul_i32 s69, s69, 11264
    s_lshl_b32 s72, s39, 8
    s_add_u32 s69, s69, s72
    s_add_u32 s69, s69, s38
    s_add_u32 s39, s39, 1
    s_waitcnt lgkmcnt(0)
    buffer_store_dwordx4 v[184:187], v245, s[56:59], s69 offen offset:0 sc1
    buffer_store_dwordx4 v[188:191], v245, s[56:59], s69 offen offset:1024 sc1
    buffer_store_dwordx4 v[192:195], v245, s[56:59], s69 offen offset:2048 sc1
    buffer_load_dwordx4 v[96:99], v8, s[40:43], s80 offen nt
    s_add_u32 s80, s80, 61440
    buffer_load_dwordx4 v[100:103], v8, s[40:43], s80 offen nt
    s_add_u32 s80, s80, 61440
    buffer_load_dwordx4 v[104:107], v8, s[40:43], s80 offen nt
    s_add_u32 s80, s80, 61440
    buffer_load_dwordx4 v[108:111], v8, s[40:43], s80 offen nt
    s_add_u32 s80, s80, 61440
    buffer_load_dwordx4 v[112:115], v9, s[52:55], s81 offen offset:0
    v_lshlrev_b32 v24, 16, v160
    s_waitcnt vmcnt(36)
    buffer_load_dwordx4 v[116:119], v9, s[52:55], s81 offen offset:128
    v_dot2_f32_bf16 v16, v32, v160, 0
    v_dot2_f32_bf16 v18, v33, v160, 0
    v_dot2_f32_bf16 v20, v34, v160, 0
    v_dot2_f32_bf16 v22, v35, v160, 0
    v_dot2_f32_bf16 v17, v32, v24, 0
    v_dot2_f32_bf16 v19, v33, v24, 0
    v_dot2_f32_bf16 v21, v34, v24, 0
    v_dot2_f32_bf16 v23, v35, v24, 0
    v_lshlrev_b32 v24, 16, v161
    s_waitcnt vmcnt(36)
    buffer_load_dwordx4 v[120:123], v9, s[52:55], s81 offen offset:256
    v_dot2_f32_bf16 v16, v36, v161, v16
    v_dot2_f32_bf16 v18, v37, v161, v18
    v_dot2_f32_bf16 v20, v38, v161, v20
    v_dot2_f32_bf16 v22, v39, v161, v22
    v_dot2_f32_bf16 v17, v36, v24, v17
    v_dot2_f32_bf16 v19, v37, v24, v19
    v_dot2_f32_bf16 v21, v38, v24, v21
    v_dot2_f32_bf16 v23, v39, v24, v23
    v_lshlrev_b32 v24, 16, v162
    s_waitcnt vmcnt(36)
    buffer_load_dwordx4 v[124:127], v9, s[52:55], s81 offen offset:384
    v_dot2_f32_bf16 v16, v40, v162, v16
    v_dot2_f32_bf16 v18, v41, v162, v18
    v_dot2_f32_bf16 v20, v42, v162, v20
    v_dot2_f32_bf16 v22, v43, v162, v22
    v_dot2_f32_bf16 v17, v40, v24, v17
    v_dot2_f32_bf16 v19, v41, v24, v19
    v_dot2_f32_bf16 v21, v42, v24, v21
    v_dot2_f32_bf16 v23, v43, v24, v23
    v_lshlrev_b32 v24, 16, v163
    s_waitcnt vmcnt(36)
    buffer_load_dwordx4 v[128:131], v9, s[52:55], s81 offen offset:512
    v_dot2_f32_bf16 v16, v44, v163, v16
    v_dot2_f32_bf16 v18, v45, v163, v18
    v_dot2_f32_bf16 v20, v46, v163, v20
    v_dot2_f32_bf16 v22, v47, v163, v22
    v_dot2_f32_bf16 v17, v44, v24, v17
    v_dot2_f32_bf16 v19, v45, v24, v19
    v_dot2_f32_bf16 v21, v46, v24, v21
    v_dot2_f32_bf16 v23, v47, v24, v23
    v_lshlrev_b32 v24, 16, v164
    s_waitcnt vmcnt(36)
    buffer_load_dwordx4 v[132:135], v9, s[52:55], s81 offen offset:640
    v_dot2_f32_bf16 v16, v48, v164, v16
    v_dot2_f32_bf16 v18, v49, v164, v18
    v_dot2_f32_bf16 v20, v50, v164, v20
    v_dot2_f32_bf16 v22, v51, v164, v22
    v_dot2_f32_bf16 v17, v48, v24, v17
    v_dot2_f32_bf16 v19, v49, v24, v19
    v_dot2_f32_bf16 v21, v50, v24, v21
    v_dot2_f32_bf16 v23, v51, v24, v23
    v_lshlrev_b32 v24, 16, v165
    s_waitcnt vmcnt(36)
    buffer_load_dwordx4 v[136:139], v9, s[52:55], s81 offen offset:768
    v_dot2_f32_bf16 v16, v52, v165, v16
    v_dot2_f32_bf16 v18, v53, v165, v18
    v_dot2_f32_bf16 v20, v54, v165, v20
    v_dot2_f32_bf16 v22, v55, v165, v22
    v_dot2_f32_bf16 v17, v52, v24, v17
    v_dot2_f32_bf16 v19, v53, v24, v19
    v_dot2_f32_bf16 v21, v54, v24, v21
    v_dot2_f32_bf16 v23, v55, v24, v23
    v_lshlrev_b32 v24, 16, v166
    s_waitcnt vmcnt(35)
    buffer_load_dwordx4 v[140:143], v9, s[52:55], s81 offen offset:896
    v_dot2_f32_bf16 v16, v56, v166, v16
    v_dot2_f32_bf16 v18, v57, v166, v18
    v_dot2_f32_bf16 v20, v58, v166, v20
    v_dot2_f32_bf16 v22, v59, v166, v22
    v_dot2_f32_bf16 v17, v56, v24, v17
    v_dot2_f32_bf16 v19, v57, v24, v19
    v_dot2_f32_bf16 v21, v58, v24, v21
    v_dot2_f32_bf16 v23, v59, v24, v23
    v_lshlrev_b32 v24, 16, v167
    s_waitcnt vmcnt(35)
    buffer_load_dwordx4 v[144:147], v9, s[52:55], s81 offen offset:1024
    v_dot2_f32_bf16 v16, v60, v167, v16
    v_dot2_f32_bf16 v18, v61, v167, v18
    v_dot2_f32_bf16 v20, v62, v167, v20
    v_dot2_f32_bf16 v22, v63, v167, v22
    v_dot2_f32_bf16 v17, v60, v24, v17
    v_dot2_f32_bf16 v19, v61, v24, v19
    v_dot2_f32_bf16 v21, v62, v24, v21
    v_dot2_f32_bf16 v23, v63, v24, v23
    v_lshlrev_b32 v24, 16, v168
    s_waitcnt vmcnt(32)
    buffer_load_dwordx4 v[148:151], v9, s[52:55], s81 offen offset:1152
    v_dot2_f32_bf16 v16, v64, v168, v16
    v_dot2_f32_bf16 v18, v65, v168, v18
    v_dot2_f32_bf16 v20, v66, v168, v20
    v_dot2_f32_bf16 v22, v67, v168, v22
    v_dot2_f32_bf16 v17, v64, v24, v17
    v_dot2_f32_bf16 v19, v65, v24, v19
    v_dot2_f32_bf16 v21, v66, v24, v21
    v_dot2_f32_bf16 v23, v67, v24, v23
    v_lshlrev_b32 v24, 16, v169
    s_waitcnt vmcnt(32)
    v_dot2_f32_bf16 v16, v68, v169, v16
    v_dot2_f32_bf16 v18, v69, v169, v18
    v_dot2_f32_bf16 v20, v70, v169, v20
    v_dot2_f32_bf16 v22, v71, v169, v22
    v_dot2_f32_bf16 v17, v68, v24, v17
    v_dot2_f32_bf16 v19, v69, v24, v19
    v_dot2_f32_bf16 v21, v70, v24, v21
    v_dot2_f32_bf16 v23, v71, v24, v23
    v_lshlrev_b32 v24, 16, v170
    s_waitcnt vmcnt(28)
    v_dot2_f32_bf16 v16, v72, v170, v16
    v_dot2_f32_bf16 v18, v73, v170, v18
    v_dot2_f32_bf16 v20, v74, v170, v20
    v_dot2_f32_bf16 v22, v75, v170, v22
    v_dot2_f32_bf16 v17, v72, v24, v17
    v_dot2_f32_bf16 v19, v73, v24, v19
    v_dot2_f32_bf16 v21, v74, v24, v21
    v_dot2_f32_bf16 v23, v75, v24, v23
    v_lshlrev_b32 v24, 16, v171
    s_waitcnt vmcnt(27)
    v_dot2_f32_bf16 v16, v76, v171, v16
    v_dot2_f32_bf16 v18, v77, v171, v18
    v_dot2_f32_bf16 v20, v78, v171, v20
    v_dot2_f32_bf16 v22, v79, v171, v22
    v_dot2_f32_bf16 v17, v76, v24, v17
    v_dot2_f32_bf16 v19, v77, v24, v19
    v_dot2_f32_bf16 v21, v78, v24, v21
    v_dot2_f32_bf16 v23, v79, v24, v23
    v_lshlrev_b32 v24, 16, v172
    s_waitcnt vmcnt(23)
    v_dot2_f32_bf16 v16, v80, v172, v16
    v_dot2_f32_bf16 v18, v81, v172, v18
    v_dot2_f32_bf16 v20, v82, v172, v20
    v_dot2_f32_bf16 v22, v83, v172, v22
    v_dot2_f32_bf16 v17, v80, v24, v17
    v_dot2_f32_bf16 v19, v81, v24, v19
    v_dot2_f32_bf16 v21, v82, v24, v21
    v_dot2_f32_bf16 v23, v83, v24, v23
    v_lshlrev_b32 v24, 16, v173
    s_waitcnt vmcnt(22)
    v_dot2_f32_bf16 v16, v84, v173, v16
    v_dot2_f32_bf16 v18, v85, v173, v18
    v_dot2_f32_bf16 v20, v86, v173, v20
    v_dot2_f32_bf16 v22, v87, v173, v22
    v_dot2_f32_bf16 v17, v84, v24, v17
    v_dot2_f32_bf16 v19, v85, v24, v19
    v_dot2_f32_bf16 v21, v86, v24, v21
    v_dot2_f32_bf16 v23, v87, v24, v23
    v_lshlrev_b32 v24, 16, v174
    s_waitcnt vmcnt(18)
    v_dot2_f32_bf16 v16, v88, v174, v16
    v_dot2_f32_bf16 v18, v89, v174, v18
    v_dot2_f32_bf16 v20, v90, v174, v20
    v_dot2_f32_bf16 v22, v91, v174, v22
    v_dot2_f32_bf16 v17, v88, v24, v17
    v_dot2_f32_bf16 v19, v89, v24, v19
    v_dot2_f32_bf16 v21, v90, v24, v21
    v_dot2_f32_bf16 v23, v91, v24, v23
    v_lshlrev_b32 v24, 16, v175
    s_waitcnt vmcnt(17)
    s_waitcnt vmcnt(14)
    s_bfe_u32 s70, s2, 0x30001
    s_lshl_b32 s70, s70, 2
    s_lshr_b32 s71, s2, 6
    s_add_u32 s70, s70, s71
    s_bfe_u32 s71, s2, 0x20004
    s_lshl_b32 s71, s71, 1
    s_and_b32 s69, s2, 1
    s_add_u32 s71, s71, s69
    s_lshl_b32 s70, s70, 7
    s_lshl_b32 s71, s71, 2
    s_add_u32 s70, s70, s71
    s_add_u32 s70, s70, 3162112
    v_lshrrev_b32 v10, 3, v1
    v_lshlrev_b32 v10, 27, v10
    v_lshl_add_u32 v10, v1, 15, v10
    buffer_store_dword v0, v10, s[56:59], s70 offen sc1
    v_dot2_f32_bf16 v16, v92, v175, v16
    v_dot2_f32_bf16 v18, v93, v175, v18
    v_dot2_f32_bf16 v20, v94, v175, v20
    v_dot2_f32_bf16 v22, v95, v175, v22
    v_dot2_f32_bf16 v17, v92, v24, v17
    v_dot2_f32_bf16 v19, v93, v24, v19
    v_dot2_f32_bf16 v21, v94, v24, v21
    v_dot2_f32_bf16 v23, v95, v24, v23
    v_lshlrev_b32 v24, 16, v176
    s_waitcnt vmcnt(14)
    v_dot2_f32_bf16 v16, v96, v176, v16
    v_dot2_f32_bf16 v18, v97, v176, v18
    v_dot2_f32_bf16 v20, v98, v176, v20
    v_dot2_f32_bf16 v22, v99, v176, v22
    v_dot2_f32_bf16 v17, v96, v24, v17
    v_dot2_f32_bf16 v19, v97, v24, v19
    v_dot2_f32_bf16 v21, v98, v24, v21
    v_dot2_f32_bf16 v23, v99, v24, v23
    v_lshlrev_b32 v24, 16, v177
    s_waitcnt vmcnt(13)
    v_dot2_f32_bf16 v16, v100, v177, v16
    v_dot2_f32_bf16 v18, v101, v177, v18
    v_dot2_f32_bf16 v20, v102, v177, v20
    v_dot2_f32_bf16 v22, v103, v177, v22
    v_dot2_f32_bf16 v17, v100, v24, v17
    v_dot2_f32_bf16 v19, v101, v24, v19
    v_dot2_f32_bf16 v21, v102, v24, v21
    v_dot2_f32_bf16 v23, v103, v24, v23
    v_lshlrev_b32 v24, 16, v178
    s_waitcnt vmcnt(12)
    v_dot2_f32_bf16 v16, v104, v178, v16
    v_dot2_f32_bf16 v18, v105, v178, v18
    v_dot2_f32_bf16 v20, v106, v178, v20
    v_dot2_f32_bf16 v22, v107, v178, v22
    v_dot2_f32_bf16 v17, v104, v24, v17
    v_dot2_f32_bf16 v19, v105, v24, v19
    v_dot2_f32_bf16 v21, v106, v24, v21
    v_dot2_f32_bf16 v23, v107, v24, v23
    v_lshlrev_b32 v24, 16, v179
    s_waitcnt vmcnt(11)
    v_dot2_f32_bf16 v16, v108, v179, v16
    v_dot2_f32_bf16 v18, v109, v179, v18
    v_dot2_f32_bf16 v20, v110, v179, v20
    v_dot2_f32_bf16 v22, v111, v179, v22
    v_dot2_f32_bf16 v17, v108, v24, v17
    v_dot2_f32_bf16 v19, v109, v24, v19
    v_dot2_f32_bf16 v21, v110, v24, v21
    v_dot2_f32_bf16 v23, v111, v24, v23
    s_nop 2
    v_permlane32_swap_b32 v16, v20
    v_permlane32_swap_b32 v17, v21
    v_permlane32_swap_b32 v18, v22
    v_permlane32_swap_b32 v19, v23
    v_add_f32 v16, v16, v20
    v_add_f32 v17, v17, v21
    v_add_f32 v18, v18, v22
    v_add_f32 v19, v19, v23
    s_nop 0
    v_permlane16_swap_b32 v16, v18
    v_permlane16_swap_b32 v17, v19
    v_add_f32 v16, v16, v18
    v_add_f32 v17, v17, v19
    v_and_b32 v10, 7, v1
    v_lshlrev_b32 v10, 6, v10
    v_add_f32_dpp v16, v16, v16 row_ror:8 row_mask:0xf bank_mask:0xf
    v_add_f32_dpp v18, v17, v17 row_ror:8 row_mask:0xf bank_mask:0xf
    v_mov_b32 v17, v0
    v_mov_b32 v19, v0
    v_lshl_add_u32 v10, v3, 4, v10
    v_and_b32 v11, 8, v1
    v_lshl_add_u32 v10, v11, 27, v10
    s_mul_i32 s74, s76, 30720
    s_lshl_b32 s72, s77, 9
    s_add_u32 s74, s74, s72
    s_add_u32 s74, s74, 2621440
    buffer_store_dwordx4 v[16:19], v10, s[56:59], s74 offen sc1
    s_mov_b32 s72, 0x3f803f80
    v_mov_b32 v7, 161992
    ds_write_b32 v7, v25
    s_lshl_b32 s38, s5, 9
    s_add_u32 s38, s38, s63
    s_add_u32 s38, s38, 8192
    v_and_b32 v236, 15, v1
    v_min_u32 v236, 14, v236
    v_lshlrev_b32 v236, 2, v236
    v_lshl_add_u32 v236, v3, 7, v236
    s_mov_b32 s72, 0x3f803f80
    buffer_load_dword v238, v236, s[56:59], s38 offen sc1
    s_waitcnt vmcnt(12)
    s_mov_b32 m0, 112640
    s_nop 0
    buffer_load_dwordx4 v240, s[52:55], s101 offen lds
    v_dot2_f32_bf16 v28, v112, s72, 0
    v_dot2_f32_bf16 v29, v112, v112, 0
    v_dot2_f32_bf16 v30, v113, s72, 0
    v_dot2_f32_bf16 v31, v113, v113, 0
    v_dot2_f32_bf16 v28, v114, s72, v28
    v_dot2_f32_bf16 v29, v114, v114, v29
    v_dot2_f32_bf16 v30, v115, s72, v30
    v_dot2_f32_bf16 v31, v115, v115, v31
    s_waitcnt vmcnt(12)
    s_mov_b32 m0, 113664
    s_nop 0
    buffer_load_dwordx4 v241, s[52:55], s101 offen lds
    v_dot2_f32_bf16 v28, v116, s72, v28
    v_dot2_f32_bf16 v29, v116, v116, v29
    v_dot2_f32_bf16 v30, v117, s72, v30
    v_dot2_f32_bf16 v31, v117, v117, v31
    v_dot2_f32_bf16 v28, v118, s72, v28
    v_dot2_f32_bf16 v29, v118, v118, v29
    v_dot2_f32_bf16 v30, v119, s72, v30
    v_dot2_f32_bf16 v31, v119, v119, v31
    s_waitcnt vmcnt(12)
    s_mov_b32 m0, 114688
    s_nop 0
    buffer_load_dwordx4 v242, s[52:55], s101 offen lds
    v_dot2_f32_bf16 v28, v120, s72, v28
    v_dot2_f32_bf16 v29, v120, v120, v29
    v_dot2_f32_bf16 v30, v121, s72, v30
    v_dot2_f32_bf16 v31, v121, v121, v31
    v_dot2_f32_bf16 v28, v122, s72, v28
    v_dot2_f32_bf16 v29, v122, v122, v29
    v_dot2_f32_bf16 v30, v123, s72, v30
    v_dot2_f32_bf16 v31, v123, v123, v31
    s_waitcnt vmcnt(12)
    s_mov_b32 m0, 115712
    s_nop 0
    buffer_load_dwordx4 v243, s[52:55], s101 offen lds
    v_dot2_f32_bf16 v28, v124, s72, v28
    v_dot2_f32_bf16 v29, v124, v124, v29
    v_dot2_f32_bf16 v30, v125, s72, v30
    v_dot2_f32_bf16 v31, v125, v125, v31
    v_dot2_f32_bf16 v28, v126, s72, v28
    v_dot2_f32_bf16 v29, v126, v126, v29
    v_dot2_f32_bf16 v30, v127, s72, v30
    v_dot2_f32_bf16 v31, v127, v127, v31
    s_waitcnt vmcnt(12)
    s_mov_b32 m0, 116736
    s_nop 0
    buffer_load_dwordx4 v244, s[52:55], s101 offen lds
    s_add_u32 s101, s101, 1310720
    v_dot2_f32_bf16 v28, v128, s72, v28
    v_dot2_f32_bf16 v29, v128, v128, v29
    v_dot2_f32_bf16 v30, v129, s72, v30
    v_dot2_f32_bf16 v31, v129, v129, v31
    v_dot2_f32_bf16 v28, v130, s72, v28
    v_dot2_f32_bf16 v29, v130, v130, v29
    v_dot2_f32_bf16 v30, v131, s72, v30
    v_dot2_f32_bf16 v31, v131, v131, v31
    s_waitcnt vmcnt(12)
    s_mov_b32 m0, 117760
    s_nop 0
    buffer_load_dwordx4 v240, s[52:55], s101 offen lds
    v_dot2_f32_bf16 v28, v132, s72, v28
    v_dot2_f32_bf16 v29, v132, v132, v29
    v_dot2_f32_bf16 v30, v133, s72, v30
    v_dot2_f32_bf16 v31, v133, v133, v31
    v_dot2_f32_bf16 v28, v134, s72, v28
    v_dot2_f32_bf16 v29, v134, v134, v29
    v_dot2_f32_bf16 v30, v135, s72, v30
    v_dot2_f32_bf16 v31, v135, v135, v31
    s_waitcnt vmcnt(12)
    s_mov_b32 m0, 118784
    s_nop 0
    buffer_load_dwordx4 v241, s[52:55], s101 offen lds
    v_dot2_f32_bf16 v28, v136, s72, v28
    v_dot2_f32_bf16 v29, v136, v136, v29
    v_dot2_f32_bf16 v30, v137, s72, v30
    v_dot2_f32_bf16 v31, v137, v137, v31
    v_dot2_f32_bf16 v28, v138, s72, v28
    v_dot2_f32_bf16 v29, v138, v138, v29
    v_dot2_f32_bf16 v30, v139, s72, v30
    v_dot2_f32_bf16 v31, v139, v139, v31
    s_waitcnt vmcnt(12)
    s_mov_b32 m0, 119808
    s_nop 0
    buffer_load_dwordx4 v242, s[52:55], s101 offen lds
    v_dot2_f32_bf16 v28, v140, s72, v28
    v_dot2_f32_bf16 v29, v140, v140, v29
    v_dot2_f32_bf16 v30, v141, s72, v30
    v_dot2_f32_bf16 v31, v141, v141, v31
    v_dot2_f32_bf16 v28, v142, s72, v28
    v_dot2_f32_bf16 v29, v142, v142, v29
    v_dot2_f32_bf16 v30, v143, s72, v30
    v_dot2_f32_bf16 v31, v143, v143, v31
    s_waitcnt vmcnt(12)
    s_mov_b32 m0, 120832
    s_nop 0
    buffer_load_dwordx4 v243, s[52:55], s101 offen lds
    v_dot2_f32_bf16 v28, v144, s72, v28
    v_dot2_f32_bf16 v29, v144, v144, v29
    v_dot2_f32_bf16 v30, v145, s72, v30
    v_dot2_f32_bf16 v31, v145, v145, v31
    v_dot2_f32_bf16 v28, v146, s72, v28
    v_dot2_f32_bf16 v29, v146, v146, v29
    v_dot2_f32_bf16 v30, v147, s72, v30
    v_dot2_f32_bf16 v31, v147, v147, v31
    s_waitcnt vmcnt(12)
    s_mov_b32 m0, 121856
    s_nop 0
    buffer_load_dwordx4 v244, s[52:55], s101 offen lds
    v_dot2_f32_bf16 v28, v148, s72, v28
    v_dot2_f32_bf16 v29, v148, v148, v29
    v_dot2_f32_bf16 v30, v149, s72, v30
    v_dot2_f32_bf16 v31, v149, v149, v31
    v_dot2_f32_bf16 v28, v150, s72, v28
    v_dot2_f32_bf16 v29, v150, v150, v29
    v_dot2_f32_bf16 v30, v151, s72, v30
    v_dot2_f32_bf16 v31, v151, v151, v31
    s_nop 2
    v_pk_add_f32 v[28:29], v[28:29], v[30:31]
    s_nop 1
    v_add_f32_dpp v28, v28, v28 quad_perm:[1,0,3,2] row_mask:0xf bank_mask:0xf
    v_add_f32_dpp v29, v29, v29 quad_perm:[1,0,3,2] row_mask:0xf bank_mask:0xf
    s_nop 0
    v_add_f32_dpp v28, v28, v28 quad_perm:[2,3,0,1] row_mask:0xf bank_mask:0xf
    v_add_f32_dpp v29, v29, v29 quad_perm:[2,3,0,1] row_mask:0xf bank_mask:0xf
    s_nop 0
    v_add_f32_dpp v28, v28, v28 row_half_mirror row_mask:0xf bank_mask:0xf
    v_add_f32_dpp v29, v29, v29 row_half_mirror row_mask:0xf bank_mask:0xf
    s_nop 0
    v_mul_f32 v28, 0x3acccccd, v28
    v_mul_f32 v29, 0x3acccccd, v29
    v_fma_f32 v29, -v28, v28, v29
    v_max_f32 v29, 0, v29
    v_add_f32 v29, 0x3727c5ac, v29
    v_rsq_f32 v29, v29
    s_nop 0
    v_mul_f32 v28, v28, v29
    v_sub_f32 v28, 0, v28
    v_swap_b32 v28, v29
    v_and_b32 v10, 7, v1
    v_lshlrev_b32 v10, 27, v10
    v_lshl_add_u32 v10, v1, 1, v10
    s_lshl_b32 s74, s3, 12
    s_lshl_b32 s72, s4, 7
    s_add_u32 s74, s74, s72
    s_add_u32 s74, s74, 3014656
    v_mov_b32 v30, v29
    v_mov_b32 v29, v0
    v_mov_b32 v31, v0
    s_cmp_lg_u32 s6, 1
    s_cbranch_scc1 Lslow_11
    buffer_store_dwordx4 v[28:31], v10, s[56:59], s74 offen
Lback_12:
    s_lshl_b32 s69, s61, 2
    s_add_u32 s69, s69, s5
    s_mul_i32 s67, s69, 61440
    s_add_u32 s67, s67, 10485760
    s_nop 1
    s_lshr_b32 s65, s5, 1
    s_and_b32 s66, s5, 1
    v_and_b32 v6, 15, v1
    s_mul_i32 s72, s3, 327680
    s_lshl_b32 s69, s60, 2
    s_add_u32 s74, s69, s5
    s_mul_i32 s69, s74, 20480
    s_add_u32 s72, s72, s69
    s_mul_i32 s69, s61, 2560
    s_add_u32 s72, s72, s69
    s_lshl_b32 s73, s3, 15
    s_lshl_b32 s69, s74, 11
    s_add_u32 s73, s73, s69
    s_add_u32 s73, s73, 2752512
    s_lshl_b32 s69, s61, 8
    s_add_u32 s77, s73, s69
    s_sub_u32 s69, s77, s72
    v_lshlrev_b32 v9, 7, v1
    v_and_b32 v10, 128, v9
    v_add_u32 v10, s69, v10
    v_cmp_gt_u32 vcc, 0, v1
    s_lshl_b32 s68, s65, 10
    s_and_b32 s69, s60, 1
    v_cndmask_b32 v9, v10, v9, vcc
    buffer_load_dword v229, v9, s[56:59], s72 offen sc1
    s_lshl_b32 s78, s69, 9
    s_add_u32 s68, s68, s78
    s_mul_i32 s75, s69, 640
    s_mul_i32 s69, s61, 80
    s_add_u32 s75, s75, s69
    s_lshl_b32 s75, s75, 7
    s_mul_i32 s69, s3, 327552
    s_add_u32 s75, s75, s69
    s_lshl_b32 s69, s3, 1
    s_lshr_b32 s78, s60, 1
    s_add_u32 s69, s69, s78
    s_lshl_b32 s78, s69, 6
    s_add_u32 s75, s75, s78
    s_add_u32 s75, s75, 4194304
    s_lshl_b32 s69, s69, 2
    s_add_u32 s68, s68, s69
    s_lshl_b32 s69, s66, 1
    s_add_u32 s68, s68, s69
    s_mul_i32 s68, s68, 1280
    s_mul_i32 s69, s61, 160
    s_add_u32 s68, s68, s69
    v_lshrrev_b32 v9, 2, v1
    v_lshlrev_b32 v9, 7, v9
    v_lshl_add_u32 v15, v5, 4, v9
    s_mul_i32 s78, s65, 5120
    s_add_u32 s78, s78, 149184
    s_lshl_b32 s69, s66, 5
    s_add_u32 s78, s78, s69
    v_lshlrev_b32 v9, 6, v4
    v_lshl_add_u32 v9, v5, 3, v9
    v_add_u32 v9, s78, v9
    v_lshl_add_u32 v13, v3, 9, v9
    v_lshl_add_u32 v14, v3, 8, v9
    s_mul_i32 s69, s5, 2560
    s_add_u32 s69, s69, 112640
    v_mul_u32_u24 v9, 160, v6
    v_add_u32 v9, s69, v9
    v_lshl_add_u32 v224, v3, 4, v9
    v_lshl_add_u32 v225, v3, 3, v9
    v_mov_b32 v9, 159424
    v_lshl_add_u32 v226, v3, 5, v9
    v_lshl_add_u32 v227, v3, 4, v9
    s_lshl_b32 s69, s5, 7
    s_add_u32 s69, s69, 161344
    v_lshlrev_b32 v9, 3, v6
    v_add_u32 v228, s69, v9
    v_lshlrev_b32 v9, 4, v6
    v_lshl_add_u32 v9, v3, 2, v9
    v_and_b32 v10, 1, v3
    v_lshl_add_u32 v30, v10, 26, v9
    v_lshrrev_b32 v9, 1, v3
    v_lshlrev_b32 v9, 8, v9
    v_lshl_add_u32 v9, v6, 4, v9
    v_and_b32 v10, 1, v3
    v_lshl_add_u32 v12, v10, 3, v9
    s_lshl_b32 s69, s74, 5
    s_add_u32 s69, s69, s63
    s_add_u32 s79, s69, 1280
    s_lshl_b32 s69, s61, 2
    s_add_u32 s80, s79, s69
    s_add_u32 s81, s80, 512
    s_mul_i32 s39, s5, 4096
    s_lshr_b32 s62, s4, 1
    s_mul_i32 s62, s62, 245760
    s_add_u32 s62, s62, s39
    s_add_u32 s62, s62, 20971520
    s_waitcnt vmcnt(12)
    v_cmp_ne_u32 vcc, s36, v238
    s_cbranch_vccnz Lapoll_13
Lok_14:
    buffer_load_dwordx4 a[0:3], v2, s[56:59], s67 offen offset:0 sc1
    buffer_load_dwordx4 a[4:7], v2, s[56:59], s67 offen offset:1024 sc1
    buffer_load_dwordx4 a[8:11], v2, s[56:59], s67 offen offset:2048 sc1
    buffer_load_dwordx4 a[12:15], v2, s[56:59], s67 offen offset:3072 sc1
    s_add_u32 s67, s67, 4096
    buffer_load_dwordx4 a[16:19], v2, s[56:59], s67 offen offset:0 sc1
    buffer_load_dwordx4 a[20:23], v2, s[56:59], s67 offen offset:1024 sc1
    buffer_load_dwordx4 a[24:27], v2, s[56:59], s67 offen offset:2048 sc1
    buffer_load_dwordx4 a[28:31], v2, s[56:59], s67 offen offset:3072 sc1
    s_add_u32 s67, s67, 4096
    buffer_load_dwordx4 a[32:35], v2, s[56:59], s67 offen offset:0 sc1
    buffer_load_dwordx4 a[36:39], v2, s[56:59], s67 offen offset:1024 sc1
    buffer_load_dwordx4 a[40:43], v2, s[56:59], s67 offen offset:2048 sc1
    buffer_load_dwordx4 a[44:47], v2, s[56:59], s67 offen offset:3072 sc1
    s_add_u32 s67, s67, 4096
    s_waitcnt vmcnt(14)
    s_barrier
    ds_read_b64 v[28:29], v228
    buffer_load_dwordx4 a[48:51], v2, s[56:59], s67 offen offset:0 sc1
    ds_read_b128 v[16:19], v224
    ds_read_b128 v[20:23], v224 offset:64
    ds_read_b64 v[24:25], v225 offset:128
    ds_read_b128 v[52:55], v226 offset:320
    ds_read_b128 v[56:59], v226 offset:336
    ds_read_b128 v[60:63], v226 offset:448
    ds_read_b128 v[64:67], v226 offset:464
    ds_read_b128 v[68:71], v227 offset:576
    ds_read_b128 v[32:35], v226 offset:0
    ds_read_b128 v[36:39], v226 offset:16
    ds_read_b128 v[40:43], v226 offset:128
    ds_read_b128 v[44:47], v226 offset:144
    buffer_load_dwordx4 a[52:55], v2, s[56:59], s67 offen offset:1024 sc1
    ds_read_b128 v[48:51], v227 offset:256
    s_waitcnt lgkmcnt(10)
    v_lshlrev_b32 v152, 16, v16
    v_and_b32 v153, s64, v16
    v_lshlrev_b32 v154, 16, v17
    v_and_b32 v155, s64, v17
    v_lshlrev_b32 v156, 16, v18
    v_and_b32 v157, s64, v18
    v_lshlrev_b32 v158, 16, v19
    v_and_b32 v159, s64, v19
    v_lshlrev_b32 v160, 16, v20
    v_and_b32 v161, s64, v20
    buffer_load_dwordx4 a[56:59], v2, s[56:59], s67 offen offset:2048 sc1
    v_lshlrev_b32 v162, 16, v21
    v_and_b32 v163, s64, v21
    v_lshlrev_b32 v164, 16, v22
    v_and_b32 v165, s64, v22
    v_lshlrev_b32 v166, 16, v23
    v_and_b32 v167, s64, v23
    v_lshlrev_b32 v168, 16, v24
    v_and_b32 v169, s64, v24
    v_lshlrev_b32 v170, 16, v25
    v_and_b32 v171, s64, v25
    ds_read_b128 v[72:75], v226 offset:640
    ds_read_b128 v[76:79], v226 offset:656
    buffer_load_dwordx4 a[60:63], v2, s[56:59], s67 offen offset:3072 sc1
    s_add_u32 s67, s67, 4096
    ds_read_b128 v[80:83], v226 offset:768
    ds_read_b128 v[84:87], v226 offset:784
    ds_read_b128 v[88:91], v227 offset:896
    v_pk_fma_f32 v[172:173], v[152:153], v[28:29], v[28:29] op_sel:[0,0,1] op_sel_hi:[1,0,1]
    v_pk_fma_f32 v[174:175], v[154:155], v[28:29], v[28:29] op_sel:[0,0,1] op_sel_hi:[1,0,1]
    v_pk_fma_f32 v[176:177], v[156:157], v[28:29], v[28:29] op_sel:[0,0,1] op_sel_hi:[1,0,1]
    v_pk_fma_f32 v[178:179], v[158:159], v[28:29], v[28:29] op_sel:[0,0,1] op_sel_hi:[1,0,1]
    v_pk_fma_f32 v[180:181], v[160:161], v[28:29], v[28:29] op_sel:[0,0,1] op_sel_hi:[1,0,1]
    v_pk_fma_f32 v[182:183], v[162:163], v[28:29], v[28:29] op_sel:[0,0,1] op_sel_hi:[1,0,1]
    v_pk_fma_f32 v[184:185], v[164:165], v[28:29], v[28:29] op_sel:[0,0,1] op_sel_hi:[1,0,1]
    v_pk_fma_f32 v[186:187], v[166:167], v[28:29], v[28:29] op_sel:[0,0,1] op_sel_hi:[1,0,1]
    v_pk_fma_f32 v[188:189], v[168:169], v[28:29], v[28:29] op_sel:[0,0,1] op_sel_hi:[1,0,1]
    buffer_load_dwordx4 a[64:67], v2, s[56:59], s67 offen offset:0 sc1
    v_pk_fma_f32 v[190:191], v[170:171], v[28:29], v[28:29] op_sel:[0,0,1] op_sel_hi:[1,0,1]
    s_waitcnt lgkmcnt(5)
    ds_read_b128 v[92:95], v226 offset:960
    ds_read_b128 v[96:99], v226 offset:976
    ds_read_b128 v[100:103], v226 offset:1088
    ds_read_b128 v[104:107], v226 offset:1104
    ds_read_b128 v[108:111], v227 offset:1216
    ds_read_b128 v[112:115], v226 offset:1280
    ds_read_b128 v[116:119], v226 offset:1296
    ds_read_b128 v[120:123], v226 offset:1408
    ds_read_b128 v[124:127], v226 offset:1424
    ds_read_b128 v[128:131], v227 offset:1536
    buffer_load_dwordx4 a[68:71], v2, s[56:59], s67 offen offset:1024 sc1
    v_pk_fma_f32 v[172:173], v[172:173], v[52:53], v[32:33]
    v_pk_fma_f32 v[174:175], v[174:175], v[54:55], v[34:35]
    v_pk_fma_f32 v[176:177], v[176:177], v[56:57], v[36:37]
    v_pk_fma_f32 v[178:179], v[178:179], v[58:59], v[38:39]
    v_pk_fma_f32 v[180:181], v[180:181], v[60:61], v[40:41]
    v_pk_fma_f32 v[182:183], v[182:183], v[62:63], v[42:43]
    v_pk_fma_f32 v[184:185], v[184:185], v[64:65], v[44:45]
    v_pk_fma_f32 v[186:187], v[186:187], v[66:67], v[46:47]
    v_pk_fma_f32 v[188:189], v[188:189], v[68:69], v[48:49]
    v_pk_fma_f32 v[190:191], v[190:191], v[70:71], v[50:51]
    s_waitcnt lgkmcnt(10)
    v_pk_mul_f32 v[172:173], v[172:173], v[72:73]
    buffer_load_dwordx4 a[72:75], v2, s[56:59], s67 offen offset:2048 sc1
    v_pk_mul_f32 v[174:175], v[174:175], v[74:75]
    v_pk_mul_f32 v[176:177], v[176:177], v[76:77]
    v_pk_mul_f32 v[178:179], v[178:179], v[78:79]
    v_pk_mul_f32 v[180:181], v[180:181], v[80:81]
    v_pk_mul_f32 v[182:183], v[182:183], v[82:83]
    v_pk_mul_f32 v[184:185], v[184:185], v[84:85]
    v_pk_mul_f32 v[186:187], v[186:187], v[86:87]
    v_pk_mul_f32 v[188:189], v[188:189], v[88:89]
    v_pk_mul_f32 v[190:191], v[190:191], v[90:91]
    v_lshlrev_b32 v11, 26, v1
    v_and_b32 v9, 7, v1
    v_lshlrev_b32 v9, 2, v9
    buffer_load_dwordx4 a[76:79], v2, s[56:59], s67 offen offset:3072 sc1
    s_add_u32 s67, s67, 4096
    s_waitcnt lgkmcnt(0)
    s_barrier
    ds_read_b64_tr_b16 v[192:193], v13 offset:0
    ds_read_b64_tr_b16 v[194:195], v13 offset:256
    ds_read_b64_tr_b16 v[196:197], v13 offset:2048
    ds_read_b64_tr_b16 v[198:199], v13 offset:2304
    ds_read_b64_tr_b16 v[200:201], v14 offset:4096
    s_waitcnt lgkmcnt(4)
    v_lshlrev_b32 v204, 16, v192
    v_and_b32 v205, s64, v192
    v_lshlrev_b32 v206, 16, v193
    v_and_b32 v207, s64, v193
    v_pk_fma_f32 v[152:153], v[172:173], v[204:205], v[152:153]
    v_pk_fma_f32 v[154:155], v[174:175], v[206:207], v[154:155]
    v_pk_mul_f32 v[150:151], v[152:153], v[152:153]
    v_pk_add_f32 v[148:149], v[152:153], v[154:155]
    v_pk_fma_f32 v[150:151], v[154:155], v[154:155], v[150:151]
    s_waitcnt lgkmcnt(3)
    v_lshlrev_b32 v208, 16, v194
    v_and_b32 v209, s64, v194
    v_lshlrev_b32 v210, 16, v195
    v_and_b32 v211, s64, v195
    v_pk_fma_f32 v[156:157], v[176:177], v[208:209], v[156:157]
    v_pk_fma_f32 v[158:159], v[178:179], v[210:211], v[158:159]
    v_pk_add_f32 v[148:149], v[148:149], v[156:157]
    v_pk_fma_f32 v[150:151], v[156:157], v[156:157], v[150:151]
    v_pk_add_f32 v[148:149], v[148:149], v[158:159]
    v_pk_fma_f32 v[150:151], v[158:159], v[158:159], v[150:151]
    s_waitcnt lgkmcnt(2)
    v_lshlrev_b32 v212, 16, v196
    v_and_b32 v213, s64, v196
    v_lshlrev_b32 v214, 16, v197
    v_and_b32 v215, s64, v197
    v_pk_fma_f32 v[160:161], v[180:181], v[212:213], v[160:161]
    v_pk_fma_f32 v[162:163], v[182:183], v[214:215], v[162:163]
    v_pk_add_f32 v[148:149], v[148:149], v[160:161]
    v_pk_fma_f32 v[150:151], v[160:161], v[160:161], v[150:151]
    v_pk_add_f32 v[148:149], v[148:149], v[162:163]
    v_pk_fma_f32 v[150:151], v[162:163], v[162:163], v[150:151]
    s_waitcnt lgkmcnt(1)
    v_lshlrev_b32 v216, 16, v198
    v_and_b32 v217, s64, v198
    v_lshlrev_b32 v218, 16, v199
    v_and_b32 v219, s64, v199
    v_pk_fma_f32 v[164:165], v[184:185], v[216:217], v[164:165]
    v_pk_fma_f32 v[166:167], v[186:187], v[218:219], v[166:167]
    v_pk_add_f32 v[148:149], v[148:149], v[164:165]
    v_pk_fma_f32 v[150:151], v[164:165], v[164:165], v[150:151]
    v_pk_add_f32 v[148:149], v[148:149], v[166:167]
    v_pk_fma_f32 v[150:151], v[166:167], v[166:167], v[150:151]
    s_waitcnt lgkmcnt(0)
    v_lshlrev_b32 v220, 16, v200
    v_and_b32 v221, s64, v200
    v_lshlrev_b32 v222, 16, v201
    v_and_b32 v223, s64, v201
    v_pk_fma_f32 v[168:169], v[188:189], v[220:221], v[168:169]
    v_pk_fma_f32 v[170:171], v[190:191], v[222:223], v[170:171]
    v_pk_add_f32 v[148:149], v[148:149], v[168:169]
    v_pk_fma_f32 v[150:151], v[168:169], v[168:169], v[150:151]
    v_pk_add_f32 v[148:149], v[148:149], v[170:171]
    v_pk_fma_f32 v[150:151], v[170:171], v[170:171], v[150:151]
    v_add_f32 v148, v148, v149
    v_add_f32 v149, v150, v151
    v_mov_b32 v151, v0
    s_nop 0
    v_permlane32_swap_b32 v148, v149
    v_add_f32 v148, v148, v149
    v_mov_b32 v149, v148
    s_nop 1
    v_permlane16_swap_b32 v148, v149
    v_add_f32 v150, v148, v149
    s_cmp_lg_u32 s6, 1
    s_cbranch_scc1 Lslow_15
    buffer_store_dwordx2 v[150:151], v30, s[56:59], s77 offen
Lback_16:
    v_cvt_pk_bf16_f32 v192, v152, v153
    v_cvt_pk_bf16_f32 v193, v154, v155
    v_cvt_pk_bf16_f32 v194, v156, v157
    v_cvt_pk_bf16_f32 v195, v158, v159
    v_cvt_pk_bf16_f32 v196, v160, v161
    v_cvt_pk_bf16_f32 v197, v162, v163
    v_cvt_pk_bf16_f32 v198, v164, v165
    v_cvt_pk_bf16_f32 v199, v166, v167
    v_cvt_pk_bf16_f32 v200, v168, v169
    v_cvt_pk_bf16_f32 v201, v170, v171
    v_accvgpr_write_b32 a240, v192
    v_accvgpr_write_b32 a241, v193
    v_accvgpr_write_b32 a242, v194
    v_accvgpr_write_b32 a243, v195
    v_accvgpr_write_b32 a244, v196
    v_accvgpr_write_b32 a245, v197
    v_accvgpr_write_b32 a246, v198
    v_accvgpr_write_b32 a247, v199
    v_accvgpr_write_b32 a248, v200
    v_accvgpr_write_b32 a249, v201
    s_and_b32 s15, s4, 1
    s_and_b32 s69, s5, 2
    s_add_u32 s15, s15, s69
    s_lshl_b32 s69, s15, 1
    s_add_u32 s69, s69, s66
    s_mul_i32 s76, s3, 327680
    s_mul_i32 s70, s69, 40960
    s_add_u32 s76, s76, s70
    v_add_u32 v20, 20480, v2
    v_add_u32 v21, 61440, v2
    v_add_u32 v22, 122880, v2
    v_lshlrev_b32 v9, 2, v6
    s_lshl_b32 s69, s69, 6
    s_add_u32 s69, s69, s63
    s_add_u32 s79, s69, 1792
Lst2_17:
    buffer_load_dwordx4 v[136:139], v2, s[56:59], s73 offen sc1
    buffer_load_dwordx4 v[140:143], v2, s[56:59], s73 offen offset:1024 sc1
    s_waitcnt vmcnt(0)
    v_min3_u32 v144, v137, v139, v141
    v_max3_u32 v145, v137, v139, v141
    v_min3_u32 v144, v144, v143, v0
    v_max3_u32 v145, v145, v143, v0
    v_cmp_ne_u32 vcc, v144, v145
    v_add_f32 v148, v136, v140
    v_add_f32 v149, v138, v142
    s_cbranch_vccz Lok_18
    s_sub_u32 s7, s7, 1
    s_cbranch_scc0 Lst2_17
    s_endpgm
Lok_18:
    v_mov_b32 v150, v148
    v_mov_b32 v151, v149
    s_nop 0
    v_permlane32_swap_b32 v148, v150
    v_permlane32_swap_b32 v149, v151
    v_pk_add_f32 v[148:149], v[148:149], v[150:151]
    v_mov_b32 v150, v148
    v_mov_b32 v151, v149
    s_nop 0
    v_permlane16_swap_b32 v148, v150
    v_permlane16_swap_b32 v149, v151
    v_pk_add_f32 v[148:149], v[148:149], v[150:151]
    v_mul_f32 v148, 0x3acccccd, v148
    v_mul_f32 v149, 0x3acccccd, v149
    v_fma_f32 v149, -v148, v148, v149
    v_max_f32 v149, 0, v149
    v_add_f32 v149, 0x3727c5ac, v149
    v_rsq_f32 v149, v149
    s_nop 0
    v_mul_f32 v148, v148, v149
    v_sub_f32 v148, 0, v148
    v_swap_b32 v148, v149
    v_pk_fma_f32 v[172:173], v[152:153], v[148:149], v[148:149] op_sel:[0,0,1] op_sel_hi:[1,0,1]
    v_pk_fma_f32 v[174:175], v[154:155], v[148:149], v[148:149] op_sel:[0,0,1] op_sel_hi:[1,0,1]
    v_pk_fma_f32 v[176:177], v[156:157], v[148:149], v[148:149] op_sel:[0,0,1] op_sel_hi:[1,0,1]
    v_pk_fma_f32 v[178:179], v[158:159], v[148:149], v[148:149] op_sel:[0,0,1] op_sel_hi:[1,0,1]
    v_pk_fma_f32 v[172:173], v[172:173], v[112:113], v[92:93]
    v_pk_fma_f32 v[174:175], v[174:175], v[114:115], v[94:95]
    v_pk_fma_f32 v[176:177], v[176:177], v[116:117], v[96:97]
    v_pk_fma_f32 v[178:179], v[178:179], v[118:119], v[98:99]
    v_cvt_pk_bf16_f32 v192, v172, v173
    v_cvt_pk_bf16_f32 v193, v174, v175
    v_cvt_pk_bf16_f32 v194, v176, v177
    v_cvt_pk_bf16_f32 v195, v178, v179
    s_cmp_lg_u32 s6, 1
    s_cbranch_scc1 Lslow_19
    buffer_store_dwordx4 v[192:195], v2, s[56:59], s72 offen
Lback_20:
    v_pk_fma_f32 v[180:181], v[160:161], v[148:149], v[148:149] op_sel:[0,0,1] op_sel_hi:[1,0,1]
    v_pk_fma_f32 v[182:183], v[162:163], v[148:149], v[148:149] op_sel:[0,0,1] op_sel_hi:[1,0,1]
    v_pk_fma_f32 v[184:185], v[164:165], v[148:149], v[148:149] op_sel:[0,0,1] op_sel_hi:[1,0,1]
    v_pk_fma_f32 v[186:187], v[166:167], v[148:149], v[148:149] op_sel:[0,0,1] op_sel_hi:[1,0,1]
    v_pk_fma_f32 v[180:181], v[180:181], v[120:121], v[100:101]
    v_pk_fma_f32 v[182:183], v[182:183], v[122:123], v[102:103]
    v_pk_fma_f32 v[184:185], v[184:185], v[124:125], v[104:105]
    v_pk_fma_f32 v[186:187], v[186:187], v[126:127], v[106:107]
    v_cvt_pk_bf16_f32 v196, v180, v181
    v_cvt_pk_bf16_f32 v197, v182, v183
    v_cvt_pk_bf16_f32 v198, v184, v185
    v_cvt_pk_bf16_f32 v199, v186, v187
    v_pk_fma_f32 v[188:189], v[168:169], v[148:149], v[148:149] op_sel:[0,0,1] op_sel_hi:[1,0,1]
    v_pk_fma_f32 v[190:191], v[170:171], v[148:149], v[148:149] op_sel:[0,0,1] op_sel_hi:[1,0,1]
    v_pk_fma_f32 v[188:189], v[188:189], v[128:129], v[108:109]
    v_pk_fma_f32 v[190:191], v[190:191], v[130:131], v[110:111]
    v_cvt_pk_bf16_f32 v200, v188, v189
    v_cvt_pk_bf16_f32 v201, v190, v191
    s_cmp_lg_u32 s6, 1
    s_cbranch_scc1 Lslow_21
    buffer_store_dwordx4 v[196:199], v2, s[56:59], s72 offen offset:1024
    buffer_store_dwordx2 v[200:201], v12, s[56:59], s72 offen offset:2048
Lback_22:
    s_waitcnt vmcnt(0)
    s_cmp_lg_u32 s6, 1
    s_cbranch_scc1 Lslow_23
    buffer_store_dword v0, v11, s[56:59], s81 offen
Lback_24:
    s_barrier
    s_lshl_b32 s69, s5, 10
    s_sub_u32 s39, s39, s69
    s_sub_u32 s62, s62, s69
    s_add_u32 s62, s62, 73728
    ds_read_b128 v[32:35], v2 offset:0
    ds_read_b128 v[36:39], v2 offset:6144
    ds_read_b128 v[40:43], v2 offset:1024
    ds_read_b128 v[44:47], v2 offset:7168
    ds_read_b128 v[48:51], v2 offset:2048
    ds_read_b128 v[52:55], v2 offset:8192
    ds_read_b128 v[56:59], v2 offset:3072
    ds_read_b128 v[60:63], v2 offset:9216
Lpoll_25:
    buffer_load_dword v10, v9, s[56:59], s79 offen sc1
    s_waitcnt vmcnt(0)
    v_cmp_ne_u32 vcc, s36, v10
    s_cbranch_vccz Lok_26
    s_sub_u32 s7, s7, 1
    s_cbranch_scc0 Lpoll_25
    s_endpgm
Lok_26:
    buffer_load_dwordx4 v[80:83], v2, s[56:59], s76 offen offset:0 sc1
    buffer_load_dwordx4 v[84:87], v20, s[56:59], s76 offen offset:0 sc1
    buffer_load_dwordx4 v[88:91], v2, s[56:59], s76 offen offset:1024 sc1
    buffer_load_dwordx4 v[92:95], v20, s[56:59], s76 offen offset:1024 sc1
    s_waitcnt lgkmcnt(6)
    s_waitcnt vmcnt(2)
    v_mfma_f32_16x16x32_bf16 v[192:195], v[32:35], v[80:83], 0
    ds_read_b128 v[64:67], v2 offset:4096
    s_mul_i32 s70, s3, 327680
    s_lshr_b32 s71, s4, 1
    v_mfma_f32_16x16x32_bf16 v[196:199], v[32:35], v[84:87], 0
    buffer_load_dwordx4 v[96:99], v2, s[56:59], s76 offen offset:2048 sc1
    s_lshl_b32 s69, s71, 10
    s_add_u32 s69, s69, s70
    s_lshl_b32 s12, s66, 15
    v_mfma_f32_16x16x32_bf16 v[204:207], v[36:39], v[84:87], 0
    ds_read_b128 v[68:71], v2 offset:10240
    s_add_u32 s69, s69, s12
    s_mul_i32 s12, s15, 81920
    v_mfma_f32_16x16x32_bf16 v[200:203], v[36:39], v[80:83], 0
    s_add_u32 s12, s12, s69
    s_add_u32 s75, s12, 4194304
    s_waitcnt lgkmcnt(6)
    v_mfma_f32_16x16x32_bf16 v[208:211], v[40:43], v[80:83], 0
    ds_read_b128 v[72:75], v2 offset:5120
    s_add_u32 s80, s12, 13631488
    s_lshl_b32 s69, s71, 1
    v_mfma_f32_16x16x32_bf16 v[212:215], v[40:43], v[84:87], 0
    s_add_u32 s69, s69, s66
    s_lshl_b32 s69, s69, 2
    s_lshl_b32 s71, s15, 7
    v_mfma_f32_16x16x32_bf16 v[220:223], v[44:47], v[84:87], 0
    ds_read_b128 v[76:79], v2 offset:11264
    s_add_u32 s71, s71, s63
    s_add_u32 s13, s71, 3456
    v_mfma_f32_16x16x32_bf16 v[216:219], v[44:47], v[80:83], 0
    s_add_u32 s69, s69, s71
    s_add_u32 s73, s69, 2304
    s_waitcnt lgkmcnt(6)
    v_mfma_f32_16x16x32_bf16 v[224:227], v[48:51], v[80:83], 0
    ds_read_b128 v[32:35], v2 offset:12288
    s_add_u32 s72, s69, 2944
    s_add_u32 s14, s69, 3456
    v_mfma_f32_16x16x32_bf16 v[228:231], v[48:51], v[84:87], 0
    buffer_load_dwordx4 v[100:103], v20, s[56:59], s76 offen offset:2048 sc1
    s_lshl_b32 s69, s60, 7
    s_lshl_b32 s71, s5, 5
    s_add_u32 s69, s69, s71
    v_mfma_f32_16x16x32_bf16 v[236:239], v[52:55], v[84:87], 0
    ds_read_b128 v[36:39], v2 offset:18432
    s_add_u32 s69, s69, s63
    s_add_u32 s74, s69, 2304
    v_mfma_f32_16x16x32_bf16 v[232:235], v[52:55], v[80:83], 0
    s_add_u32 s38, s69, 2944
    s_mul_i32 s69, s60, 81920
    s_waitcnt lgkmcnt(6)
    v_mfma_f32_16x16x32_bf16 v[240:243], v[56:59], v[80:83], 0
    ds_read_b128 v[40:43], v2 offset:13312
    s_add_u32 s70, s70, s69
    s_lshl_b32 s69, s5, 12
    v_mfma_f32_16x16x32_bf16 v[244:247], v[56:59], v[84:87], 0
    s_add_u32 s70, s70, s69
    v_and_b32 v9, 7, v1
    v_lshlrev_b32 v9, 2, v9
    v_mfma_f32_16x16x32_bf16 v[252:255], v[60:63], v[84:87], 0
    ds_read_b128 v[44:47], v2 offset:19456
    v_and_b32 v28, 31, v1
    v_lshlrev_b32 v28, 2, v28
    v_mfma_f32_16x16x32_bf16 v[248:251], v[60:63], v[80:83], 0
    v_add_u32 v23, 16384, v2
    v_add_u32 v27, 4194304, v2
    s_waitcnt lgkmcnt(6)
    v_mfma_f32_16x16x32_bf16 v[160:163], v[64:67], v[80:83], 0
    ds_read_b128 v[48:51], v2 offset:14336
    v_add_u32 v29, 13631488, v2
    v_lshlrev_b32 v10, 3, v1
    v_mfma_f32_16x16x32_bf16 v[164:167], v[64:67], v[84:87], 0
    buffer_load_dwordx4 v[104:107], v2, s[56:59], s76 offen offset:3072 sc1
    s_add_u32 s69, s5, 1
    s_and_b32 s69, s69, 3
    s_lshl_b32 s71, s69, 14
    v_mfma_f32_16x16x32_bf16 v[172:175], v[68:71], v[84:87], 0
    ds_read_b128 v[52:55], v2 offset:20480
    s_add_u32 s77, s71, s70
    s_mul_i32 s69, s69, 15360
    v_mfma_f32_16x16x32_bf16 v[168:171], v[68:71], v[80:83], 0
    v_add_u32 v16, s69, v10
    s_add_u32 s69, s5, 2
    s_waitcnt lgkmcnt(6)
    v_mfma_f32_16x16x32_bf16 v[176:179], v[72:75], v[80:83], 0
    ds_read_b128 v[56:59], v2 offset:15360
    s_and_b32 s69, s69, 3
    s_lshl_b32 s71, s69, 14
    v_mfma_f32_16x16x32_bf16 v[180:183], v[72:75], v[84:87], 0
    s_add_u32 s78, s71, s70
    s_mul_i32 s69, s69, 15360
    s_add_u32 s69, s69, 5120
    v_mfma_f32_16x16x32_bf16 v[188:191], v[76:79], v[84:87], 0
    ds_read_b128 v[60:63], v2 offset:21504
    v_add_u32 v17, s69, v10
    s_add_u32 s69, s5, 3
    v_mfma_f32_16x16x32_bf16 v[184:187], v[76:79], v[80:83], 0
    s_and_b32 s69, s69, 3
    s_lshl_b32 s71, s69, 14
    s_waitcnt lgkmcnt(6)
    s_waitcnt vmcnt(3)
    v_mfma_f32_16x16x32_bf16 v[192:195], v[32:35], v[88:91], v[192:195]
    ds_read_b128 v[64:67], v2 offset:16384
    s_add_u32 s79, s71, s70
    s_mul_i32 s69, s69, 15360
    v_mfma_f32_16x16x32_bf16 v[196:199], v[32:35], v[92:95], v[196:199]
    buffer_load_dwordx4 v[108:111], v20, s[56:59], s76 offen offset:3072 sc1
    s_add_u32 s76, s76, 4096
    s_add_u32 s69, s69, 10240
    v_add_u32 v18, s69, v10
    s_add_u32 s69, s5, 4
    v_mfma_f32_16x16x32_bf16 v[204:207], v[36:39], v[92:95], v[204:207]
    ds_read_b128 v[68:71], v2 offset:22528
    s_and_b32 s69, s69, 3
    s_lshl_b32 s71, s69, 14
    v_mfma_f32_16x16x32_bf16 v[200:203], v[36:39], v[88:91], v[200:203]
    s_add_u32 s81, s71, s70
    s_mul_i32 s69, s69, 15360
    s_waitcnt lgkmcnt(6)
    v_mfma_f32_16x16x32_bf16 v[208:211], v[40:43], v[88:91], v[208:211]
    ds_read_b128 v[72:75], v2 offset:17408
    v_add_u32 v19, s69, v10
    s_mov_b32 s40, s32
    v_mfma_f32_16x16x32_bf16 v[212:215], v[40:43], v[92:95], v[212:215]
    s_mov_b32 s41, s33
    s_mov_b32 s42, 2621440
    s_mov_b32 s43, 0x20000
    v_mfma_f32_16x16x32_bf16 v[220:223], v[44:47], v[92:95], v[220:223]
    ds_read_b128 v[76:79], v2 offset:23552
    v_and_b32 v8, 7, v6
    v_lshlrev_b32 v8, 6, v8
    v_mfma_f32_16x16x32_bf16 v[216:219], v[44:47], v[88:91], v[216:219]
    v_lshrrev_b32 v7, 3, v6
    v_add_u32 v8, v8, v7
    s_waitcnt lgkmcnt(6)
    v_mfma_f32_16x16x32_bf16 v[224:227], v[48:51], v[88:91], v[224:227]
    ds_read_b128 v[32:35], v2 offset:24576
    v_mul_u32_u24 v8, 1280, v8
    v_lshl_add_u32 v7, v3, 3, v8
    v_mfma_f32_16x16x32_bf16 v[228:231], v[48:51], v[92:95], v[228:231]
    buffer_load_dwordx4 v[112:115], v2, s[56:59], s76 offen offset:0 sc1
    v_lshl_add_u32 v8, v3, 4, v8
    v_mov_b32 v13, 161024
    v_lshl_add_u32 v12, v3, 5, v13
    v_mfma_f32_16x16x32_bf16 v[236:239], v[52:55], v[92:95], v[236:239]
    ds_read_b128 v[36:39], v2 offset:30720
    v_lshl_add_u32 v13, v3, 4, v13
    v_mfma_f32_16x16x32_bf16 v[232:235], v[52:55], v[88:91], v[232:235]
    s_waitcnt lgkmcnt(6)
    v_mfma_f32_16x16x32_bf16 v[240:243], v[56:59], v[88:91], v[240:243]
    ds_read_b128 v[40:43], v2 offset:25600
    v_mfma_f32_16x16x32_bf16 v[244:247], v[56:59], v[92:95], v[244:247]
    v_mfma_f32_16x16x32_bf16 v[252:255], v[60:63], v[92:95], v[252:255]
    ds_read_b128 v[44:47], v2 offset:31744
    v_mfma_f32_16x16x32_bf16 v[248:251], v[60:63], v[88:91], v[248:251]
    s_waitcnt lgkmcnt(6)
    v_mfma_f32_16x16x32_bf16 v[160:163], v[64:67], v[88:91], v[160:163]
    ds_read_b128 v[48:51], v2 offset:26624
    v_mfma_f32_16x16x32_bf16 v[164:167], v[64:67], v[92:95], v[164:167]
    buffer_load_dwordx4 v[116:119], v20, s[56:59], s76 offen offset:0 sc1
    v_mfma_f32_16x16x32_bf16 v[172:175], v[68:71], v[92:95], v[172:175]
    ds_read_b128 v[52:55], v2 offset:32768
    v_mfma_f32_16x16x32_bf16 v[168:171], v[68:71], v[88:91], v[168:171]
    s_waitcnt lgkmcnt(6)
    v_mfma_f32_16x16x32_bf16 v[176:179], v[72:75], v[88:91], v[176:179]
    ds_read_b128 v[56:59], v2 offset:27648
    v_mfma_f32_16x16x32_bf16 v[180:183], v[72:75], v[92:95], v[180:183]
    v_mfma_f32_16x16x32_bf16 v[188:191], v[76:79], v[92:95], v[188:191]
    ds_read_b128 v[60:63], v2 offset:33792
    v_mfma_f32_16x16x32_bf16 v[184:187], v[76:79], v[88:91], v[184:187]
    s_waitcnt lgkmcnt(6)
    s_waitcnt vmcnt(4)
    v_mfma_f32_16x16x32_bf16 v[192:195], v[32:35], v[96:99], v[192:195]
    ds_read_b128 v[64:67], v2 offset:28672
    v_mfma_f32_16x16x32_bf16 v[196:199], v[32:35], v[100:103], v[196:199]
    buffer_load_dwordx4 v[120:123], v2, s[56:59], s76 offen offset:1024 sc1
    v_mfma_f32_16x16x32_bf16 v[204:207], v[36:39], v[100:103], v[204:207]
    ds_read_b128 v[68:71], v2 offset:34816
    v_mfma_f32_16x16x32_bf16 v[200:203], v[36:39], v[96:99], v[200:203]
    s_waitcnt lgkmcnt(6)
    v_mfma_f32_16x16x32_bf16 v[208:211], v[40:43], v[96:99], v[208:211]
    ds_read_b128 v[72:75], v2 offset:29696
    s_add_u32 m0, s39, 73728
    s_nop 0
    buffer_load_dwordx4 v2, s[56:59], s62 offen offset:0 sc1 lds
    v_mfma_f32_16x16x32_bf16 v[212:215], v[40:43], v[100:103], v[212:215]
    v_mfma_f32_16x16x32_bf16 v[220:223], v[44:47], v[100:103], v[220:223]
    ds_read_b128 v[76:79], v2 offset:35840
    v_mfma_f32_16x16x32_bf16 v[216:219], v[44:47], v[96:99], v[216:219]
    buffer_load_dwordx4 v2, s[56:59], s62 offen offset:1024 sc1 lds
    s_waitcnt lgkmcnt(6)
    v_mfma_f32_16x16x32_bf16 v[224:227], v[48:51], v[96:99], v[224:227]
    ds_read_b128 v[32:35], v2 offset:36864
    v_mfma_f32_16x16x32_bf16 v[228:231], v[48:51], v[100:103], v[228:231]
    v_mfma_f32_16x16x32_bf16 v[236:239], v[52:55], v[100:103], v[236:239]
    ds_read_b128 v[36:39], v2 offset:43008
    v_mfma_f32_16x16x32_bf16 v[232:235], v[52:55], v[96:99], v[232:235]
    buffer_load_dwordx4 v[124:127], v20, s[56:59], s76 offen offset:1024 sc1
    s_waitcnt lgkmcnt(6)
    v_mfma_f32_16x16x32_bf16 v[240:243], v[56:59], v[96:99], v[240:243]
    ds_read_b128 v[40:43], v2 offset:37888
    v_mfma_f32_16x16x32_bf16 v[244:247], v[56:59], v[100:103], v[244:247]
    v_mfma_f32_16x16x32_bf16 v[252:255], v[60:63], v[100:103], v[252:255]
    ds_read_b128 v[44:47], v2 offset:44032
    buffer_load_dwordx4 v2, s[56:59], s62 offen offset:2048 sc1 lds
    s_add_u32 s62, s62, 12288
    v_mfma_f32_16x16x32_bf16 v[248:251], v[60:63], v[96:99], v[248:251]
    s_waitcnt lgkmcnt(6)
    v_mfma_f32_16x16x32_bf16 v[160:163], v[64:67], v[96:99], v[160:163]
    ds_read_b128 v[48:51], v2 offset:38912
    v_mfma_f32_16x16x32_bf16 v[164:167], v[64:67], v[100:103], v[164:167]
    v_mfma_f32_16x16x32_bf16 v[172:175], v[68:71], v[100:103], v[172:175]
    ds_read_b128 v[52:55], v2 offset:45056
    s_add_u32 m0, s39, 86016
    s_nop 0
    buffer_load_dwordx4 v2, s[56:59], s62 offen offset:0 sc1 lds
    v_mfma_f32_16x16x32_bf16 v[168:171], v[68:71], v[96:99], v[168:171]
    s_waitcnt lgkmcnt(6)
    v_mfma_f32_16x16x32_bf16 v[176:179], v[72:75], v[96:99], v[176:179]
    ds_read_b128 v[56:59], v2 offset:39936
    v_mfma_f32_16x16x32_bf16 v[180:183], v[72:75], v[100:103], v[180:183]
    buffer_load_dwordx4 a[80:83], v2, s[56:59], s67 offen offset:0 sc1
    v_mfma_f32_16x16x32_bf16 v[188:191], v[76:79], v[100:103], v[188:191]
    ds_read_b128 v[60:63], v2 offset:46080
    v_mfma_f32_16x16x32_bf16 v[184:187], v[76:79], v[96:99], v[184:187]
    s_waitcnt lgkmcnt(6)
    s_waitcnt vmcnt(9)
    v_mfma_f32_16x16x32_bf16 v[192:195], v[32:35], v[104:107], v[192:195]
    ds_read_b128 v[64:67], v2 offset:40960
    v_mfma_f32_16x16x32_bf16 v[196:199], v[32:35], v[108:111], v[196:199]
    buffer_load_dwordx4 v[128:131], v2, s[56:59], s76 offen offset:2048 sc1
    v_mfma_f32_16x16x32_bf16 v[204:207], v[36:39], v[108:111], v[204:207]
    ds_read_b128 v[68:71], v2 offset:47104
    v_mfma_f32_16x16x32_bf16 v[200:203], v[36:39], v[104:107], v[200:203]
    s_waitcnt lgkmcnt(6)
    v_mfma_f32_16x16x32_bf16 v[208:211], v[40:43], v[104:107], v[208:211]
    ds_read_b128 v[72:75], v2 offset:41984
    buffer_load_dwordx4 v2, s[56:59], s62 offen offset:1024 sc1 lds
    v_mfma_f32_16x16x32_bf16 v[212:215], v[40:43], v[108:111], v[212:215]
    v_mfma_f32_16x16x32_bf16 v[220:223], v[44:47], v[108:111], v[220:223]
    ds_read_b128 v[76:79], v2 offset:48128
    v_mfma_f32_16x16x32_bf16 v[216:219], v[44:47], v[104:107], v[216:219]
    buffer_load_dwordx4 v2, s[56:59], s62 offen offset:2048 sc1 lds
    s_add_u32 s62, s62, 12288
    s_waitcnt lgkmcnt(6)
    v_mfma_f32_16x16x32_bf16 v[224:227], v[48:51], v[104:107], v[224:227]
    ds_read_b128 v[32:35], v2 offset:49152
    v_mfma_f32_16x16x32_bf16 v[228:231], v[48:51], v[108:111], v[228:231]
    v_mfma_f32_16x16x32_bf16 v[236:239], v[52:55], v[108:111], v[236:239]
    ds_read_b128 v[36:39], v2 offset:55296
    buffer_load_dwordx4 v[132:135], v20, s[56:59], s76 offen offset:2048 sc1
    v_mfma_f32_16x16x32_bf16 v[232:235], v[52:55], v[104:107], v[232:235]
    s_waitcnt lgkmcnt(6)
    v_mfma_f32_16x16x32_bf16 v[240:243], v[56:59], v[104:107], v[240:243]
    ds_read_b128 v[40:43], v2 offset:50176
    v_mfma_f32_16x16x32_bf16 v[244:247], v[56:59], v[108:111], v[244:247]
    s_add_u32 m0, s39, 98304
    s_nop 0
    buffer_load_dwordx4 v2, s[56:59], s62 offen offset:0 sc1 lds
    v_mfma_f32_16x16x32_bf16 v[252:255], v[60:63], v[108:111], v[252:255]
    ds_read_b128 v[44:47], v2 offset:56320
    v_mfma_f32_16x16x32_bf16 v[248:251], v[60:63], v[104:107], v[248:251]
    s_waitcnt lgkmcnt(6)
    v_mfma_f32_16x16x32_bf16 v[160:163], v[64:67], v[104:107], v[160:163]
    ds_read_b128 v[48:51], v2 offset:51200
    buffer_load_dwordx4 v2, s[56:59], s62 offen offset:1024 sc1 lds
    v_mfma_f32_16x16x32_bf16 v[164:167], v[64:67], v[108:111], v[164:167]
    v_mfma_f32_16x16x32_bf16 v[172:175], v[68:71], v[108:111], v[172:175]
    ds_read_b128 v[52:55], v2 offset:57344
    v_mfma_f32_16x16x32_bf16 v[168:171], v[68:71], v[104:107], v[168:171]
    buffer_load_dwordx4 v[136:139], v2, s[56:59], s76 offen offset:3072 sc1
    s_waitcnt lgkmcnt(6)
    v_mfma_f32_16x16x32_bf16 v[176:179], v[72:75], v[104:107], v[176:179]
    ds_read_b128 v[56:59], v2 offset:52224
    v_mfma_f32_16x16x32_bf16 v[180:183], v[72:75], v[108:111], v[180:183]
    v_mfma_f32_16x16x32_bf16 v[188:191], v[76:79], v[108:111], v[188:191]
    ds_read_b128 v[60:63], v2 offset:58368
    buffer_load_dwordx4 v2, s[56:59], s62 offen offset:2048 sc1 lds
    s_add_u32 s62, s62, 12288
    v_mfma_f32_16x16x32_bf16 v[184:187], v[76:79], v[104:107], v[184:187]
    s_waitcnt lgkmcnt(6)
    s_waitcnt vmcnt(15)
    v_mfma_f32_16x16x32_bf16 v[192:195], v[32:35], v[112:115], v[192:195]
    ds_read_b128 v[64:67], v2 offset:53248
    v_mfma_f32_16x16x32_bf16 v[196:199], v[32:35], v[116:119], v[196:199]
    buffer_load_dwordx4 v[140:143], v20, s[56:59], s76 offen offset:3072 sc1
    s_add_u32 s76, s76, 4096
    v_mfma_f32_16x16x32_bf16 v[204:207], v[36:39], v[116:119], v[204:207]
    ds_read_b128 v[68:71], v2 offset:59392
    v_mfma_f32_16x16x32_bf16 v[200:203], v[36:39], v[112:115], v[200:203]
    s_waitcnt lgkmcnt(6)
    v_mfma_f32_16x16x32_bf16 v[208:211], v[40:43], v[112:115], v[208:211]
    ds_read_b128 v[72:75], v2 offset:54272
    v_mfma_f32_16x16x32_bf16 v[212:215], v[40:43], v[116:119], v[212:215]
    buffer_load_dwordx4 a[84:87], v2, s[56:59], s67 offen offset:1024 sc1
    v_mfma_f32_16x16x32_bf16 v[220:223], v[44:47], v[116:119], v[220:223]
    ds_read_b128 v[76:79], v2 offset:60416
    v_mfma_f32_16x16x32_bf16 v[216:219], v[44:47], v[112:115], v[216:219]
    s_waitcnt lgkmcnt(6)
    v_mfma_f32_16x16x32_bf16 v[224:227], v[48:51], v[112:115], v[224:227]
    ds_read_b128 v[32:35], v21 offset:0
    v_mfma_f32_16x16x32_bf16 v[228:231], v[48:51], v[116:119], v[228:231]
    s_add_u32 m0, s39, 110592
    s_nop 0
    buffer_load_dwordx4 v2, s[56:59], s62 offen offset:0 sc1 lds
    v_mfma_f32_16x16x32_bf16 v[236:239], v[52:55], v[116:119], v[236:239]
    ds_read_b128 v[36:39], v21 offset:6144
    v_mfma_f32_16x16x32_bf16 v[232:235], v[52:55], v[112:115], v[232:235]
    s_waitcnt lgkmcnt(6)
    v_mfma_f32_16x16x32_bf16 v[240:243], v[56:59], v[112:115], v[240:243]
    ds_read_b128 v[40:43], v21 offset:1024
    v_mfma_f32_16x16x32_bf16 v[244:247], v[56:59], v[116:119], v[244:247]
    buffer_load_dwordx4 v[144:147], v2, s[56:59], s76 offen offset:0 sc1
    v_mfma_f32_16x16x32_bf16 v[252:255], v[60:63], v[116:119], v[252:255]
    ds_read_b128 v[44:47], v21 offset:7168
    v_mfma_f32_16x16x32_bf16 v[248:251], v[60:63], v[112:115], v[248:251]
    s_waitcnt lgkmcnt(6)
    v_mfma_f32_16x16x32_bf16 v[160:163], v[64:67], v[112:115], v[160:163]
    ds_read_b128 v[48:51], v21 offset:2048
    v_mfma_f32_16x16x32_bf16 v[164:167], v[64:67], v[116:119], v[164:167]
    buffer_load_dwordx4 v2, s[56:59], s62 offen offset:1024 sc1 lds
    v_mfma_f32_16x16x32_bf16 v[172:175], v[68:71], v[116:119], v[172:175]
    ds_read_b128 v[52:55], v21 offset:8192
    v_mfma_f32_16x16x32_bf16 v[168:171], v[68:71], v[112:115], v[168:171]
    s_waitcnt lgkmcnt(6)
    v_mfma_f32_16x16x32_bf16 v[176:179], v[72:75], v[112:115], v[176:179]
    ds_read_b128 v[56:59], v21 offset:3072
    v_mfma_f32_16x16x32_bf16 v[180:183], v[72:75], v[116:119], v[180:183]
    buffer_load_dwordx4 v2, s[56:59], s62 offen offset:2048 sc1 lds
    s_add_u32 s62, s62, 12288
    v_mfma_f32_16x16x32_bf16 v[188:191], v[76:79], v[116:119], v[188:191]
    ds_read_b128 v[60:63], v21 offset:9216
    v_mfma_f32_16x16x32_bf16 v[184:187], v[76:79], v[112:115], v[184:187]
    s_waitcnt vmcnt(16)
    s_barrier
    s_waitcnt lgkmcnt(6)
    v_mfma_f32_16x16x32_bf16 v[192:195], v[32:35], v[120:123], v[192:195]
    ds_read_b128 v[64:67], v21 offset:4096
    v_mfma_f32_16x16x32_bf16 v[196:199], v[32:35], v[124:127], v[196:199]
    buffer_load_dwordx4 v[148:151], v20, s[56:59], s76 offen offset:0 sc1
    v_mfma_f32_16x16x32_bf16 v[204:207], v[36:39], v[124:127], v[204:207]
    ds_read_b128 v[68:71], v21 offset:10240
    v_mfma_f32_16x16x32_bf16 v[200:203], v[36:39], v[120:123], v[200:203]
    s_waitcnt lgkmcnt(6)
    v_mfma_f32_16x16x32_bf16 v[208:211], v[40:43], v[120:123], v[208:211]
    ds_read_b128 v[72:75], v21 offset:5120
    s_add_u32 m0, s39, 122880
    s_nop 0
    buffer_load_dwordx4 v2, s[56:59], s62 offen offset:0 sc1 lds
    v_mfma_f32_16x16x32_bf16 v[212:215], v[40:43], v[124:127], v[212:215]
    v_mfma_f32_16x16x32_bf16 v[220:223], v[44:47], v[124:127], v[220:223]
    ds_read_b128 v[76:79], v21 offset:11264
    v_mfma_f32_16x16x32_bf16 v[216:219], v[44:47], v[120:123], v[216:219]
    buffer_load_dwordx4 v2, s[56:59], s62 offen offset:1024 sc1 lds
    s_waitcnt lgkmcnt(6)
    v_mfma_f32_16x16x32_bf16 v[224:227], v[48:51], v[120:123], v[224:227]
    ds_read_b128 v[32:35], v21 offset:12288
    v_mfma_f32_16x16x32_bf16 v[228:231], v[48:51], v[124:127], v[228:231]
    v_mfma_f32_16x16x32_bf16 v[236:239], v[52:55], v[124:127], v[236:239]
    ds_read_b128 v[36:39], v21 offset:18432
    buffer_load_dwordx4 v[152:155], v2, s[56:59], s76 offen offset:1024 sc1
    v_mfma_f32_16x16x32_bf16 v[232:235], v[52:55], v[120:123], v[232:235]
    s_waitcnt lgkmcnt(6)
    v_mfma_f32_16x16x32_bf16 v[240:243], v[56:59], v[120:123], v[240:243]
    ds_read_b128 v[40:43], v21 offset:13312
    v_mfma_f32_16x16x32_bf16 v[244:247], v[56:59], v[124:127], v[244:247]
    buffer_load_dwordx4 a[88:91], v2, s[56:59], s67 offen offset:2048 sc1
    v_mfma_f32_16x16x32_bf16 v[252:255], v[60:63], v[124:127], v[252:255]
    ds_read_b128 v[44:47], v21 offset:19456
    v_mfma_f32_16x16x32_bf16 v[248:251], v[60:63], v[120:123], v[248:251]
    s_waitcnt lgkmcnt(6)
    v_mfma_f32_16x16x32_bf16 v[160:163], v[64:67], v[120:123], v[160:163]
    ds_read_b128 v[48:51], v21 offset:14336
    buffer_load_dwordx4 v2, s[56:59], s62 offen offset:2048 sc1 lds
    s_add_u32 s62, s62, 12288
    v_mfma_f32_16x16x32_bf16 v[164:167], v[64:67], v[124:127], v[164:167]
    v_mfma_f32_16x16x32_bf16 v[172:175], v[68:71], v[124:127], v[172:175]
    ds_read_b128 v[52:55], v21 offset:20480
    v_mfma_f32_16x16x32_bf16 v[168:171], v[68:71], v[120:123], v[168:171]
    buffer_load_dwordx4 v[156:159], v20, s[56:59], s76 offen offset:1024 sc1
    s_waitcnt lgkmcnt(6)
    v_mfma_f32_16x16x32_bf16 v[176:179], v[72:75], v[120:123], v[176:179]
    ds_read_b128 v[56:59], v21 offset:15360
    v_mfma_f32_16x16x32_bf16 v[180:183], v[72:75], v[124:127], v[180:183]
    v_mfma_f32_16x16x32_bf16 v[188:191], v[76:79], v[124:127], v[188:191]
    ds_read_b128 v[60:63], v21 offset:21504
    s_add_u32 m0, s39, 135168
    s_nop 0
    buffer_load_dwordx4 v2, s[56:59], s62 offen offset:0 sc1 lds
    v_mfma_f32_16x16x32_bf16 v[184:187], v[76:79], v[120:123], v[184:187]
    s_waitcnt vmcnt(19)
    s_barrier
    s_waitcnt lgkmcnt(6)
    s_waitcnt vmcnt(18)
    v_mfma_f32_16x16x32_bf16 v[192:195], v[32:35], v[128:131], v[192:195]
    ds_read_b128 v[64:67], v21 offset:16384
    v_mfma_f32_16x16x32_bf16 v[196:199], v[32:35], v[132:135], v[196:199]
    buffer_load_dwordx4 v[80:83], v2, s[56:59], s76 offen offset:2048 sc1
    v_mfma_f32_16x16x32_bf16 v[204:207], v[36:39], v[132:135], v[204:207]
    ds_read_b128 v[68:71], v21 offset:22528
    v_mfma_f32_16x16x32_bf16 v[200:203], v[36:39], v[128:131], v[200:203]
    s_waitcnt lgkmcnt(6)
    v_mfma_f32_16x16x32_bf16 v[208:211], v[40:43], v[128:131], v[208:211]
    ds_read_b128 v[72:75], v21 offset:17408
    v_mfma_f32_16x16x32_bf16 v[212:215], v[40:43], v[132:135], v[212:215]
    buffer_load_dwordx4 v2, s[56:59], s62 offen offset:1024 sc1 lds
    v_mfma_f32_16x16x32_bf16 v[220:223], v[44:47], v[132:135], v[220:223]
    ds_read_b128 v[76:79], v21 offset:23552
    v_mfma_f32_16x16x32_bf16 v[216:219], v[44:47], v[128:131], v[216:219]
    s_waitcnt lgkmcnt(6)
    v_mfma_f32_16x16x32_bf16 v[224:227], v[48:51], v[128:131], v[224:227]
    ds_read_b128 v[32:35], v21 offset:24576
    v_mfma_f32_16x16x32_bf16 v[228:231], v[48:51], v[132:135], v[228:231]
    buffer_load_dwordx4 v2, s[56:59], s62 offen offset:2048 sc1 lds
    s_add_u32 s62, s62, 12288
    v_mfma_f32_16x16x32_bf16 v[236:239], v[52:55], v[132:135], v[236:239]
    ds_read_b128 v[36:39], v21 offset:30720
    v_mfma_f32_16x16x32_bf16 v[232:235], v[52:55], v[128:131], v[232:235]
    s_waitcnt lgkmcnt(6)
    v_mfma_f32_16x16x32_bf16 v[240:243], v[56:59], v[128:131], v[240:243]
    ds_read_b128 v[40:43], v21 offset:25600
    v_mfma_f32_16x16x32_bf16 v[244:247], v[56:59], v[132:135], v[244:247]
    buffer_load_dwordx4 v[84:87], v20, s[56:59], s76 offen offset:2048 sc1
    v_mfma_f32_16x16x32_bf16 v[252:255], v[60:63], v[132:135], v[252:255]
    ds_read_b128 v[44:47], v21 offset:31744
    v_mfma_f32_16x16x32_bf16 v[248:251], v[60:63], v[128:131], v[248:251]
    s_waitcnt lgkmcnt(6)
    v_mfma_f32_16x16x32_bf16 v[160:163], v[64:67], v[128:131], v[160:163]
    ds_read_b128 v[48:51], v21 offset:26624
    v_mfma_f32_16x16x32_bf16 v[164:167], v[64:67], v[132:135], v[164:167]
    buffer_load_dwordx4 a[92:95], v2, s[56:59], s67 offen offset:3072 sc1
    s_add_u32 s67, s67, 4096
    v_mfma_f32_16x16x32_bf16 v[172:175], v[68:71], v[132:135], v[172:175]
    ds_read_b128 v[52:55], v21 offset:32768
    v_mfma_f32_16x16x32_bf16 v[168:171], v[68:71], v[128:131], v[168:171]
    s_waitcnt lgkmcnt(6)
    v_mfma_f32_16x16x32_bf16 v[176:179], v[72:75], v[128:131], v[176:179]
    ds_read_b128 v[56:59], v21 offset:27648
    v_mfma_f32_16x16x32_bf16 v[180:183], v[72:75], v[132:135], v[180:183]
    s_add_u32 m0, s39, 0
    s_nop 0
    buffer_load_dwordx4 v2, s[56:59], s62 offen offset:0 sc1 lds
    v_mfma_f32_16x16x32_bf16 v[188:191], v[76:79], v[132:135], v[188:191]
    ds_read_b128 v[60:63], v21 offset:33792
    v_mfma_f32_16x16x32_bf16 v[184:187], v[76:79], v[128:131], v[184:187]
    s_waitcnt vmcnt(20)
    s_barrier
    s_waitcnt lgkmcnt(6)
    s_waitcnt vmcnt(19)
    v_mfma_f32_16x16x32_bf16 v[192:195], v[32:35], v[136:139], v[192:195]
    ds_read_b128 v[64:67], v21 offset:28672
    v_mfma_f32_16x16x32_bf16 v[196:199], v[32:35], v[140:143], v[196:199]
    buffer_load_dwordx4 v[88:91], v2, s[56:59], s76 offen offset:3072 sc1
    v_mfma_f32_16x16x32_bf16 v[204:207], v[36:39], v[140:143], v[204:207]
    ds_read_b128 v[68:71], v21 offset:34816
    v_mfma_f32_16x16x32_bf16 v[200:203], v[36:39], v[136:139], v[200:203]
    s_waitcnt lgkmcnt(6)
    v_mfma_f32_16x16x32_bf16 v[208:211], v[40:43], v[136:139], v[208:211]
    ds_read_b128 v[72:75], v21 offset:29696
    buffer_load_dwordx4 v2, s[56:59], s62 offen offset:1024 sc1 lds
    v_mfma_f32_16x16x32_bf16 v[212:215], v[40:43], v[140:143], v[212:215]
    v_mfma_f32_16x16x32_bf16 v[220:223], v[44:47], v[140:143], v[220:223]
    ds_read_b128 v[76:79], v21 offset:35840
    v_mfma_f32_16x16x32_bf16 v[216:219], v[44:47], v[136:139], v[216:219]
    buffer_load_dwordx4 v2, s[56:59], s62 offen offset:2048 sc1 lds
    s_add_u32 s62, s62, 12288
    s_waitcnt lgkmcnt(6)
    v_mfma_f32_16x16x32_bf16 v[224:227], v[48:51], v[136:139], v[224:227]
    ds_read_b128 v[32:35], v21 offset:36864
    v_mfma_f32_16x16x32_bf16 v[228:231], v[48:51], v[140:143], v[228:231]
    v_mfma_f32_16x16x32_bf16 v[236:239], v[52:55], v[140:143], v[236:239]
    ds_read_b128 v[36:39], v21 offset:43008
    buffer_load_dwordx4 v[92:95], v20, s[56:59], s76 offen offset:3072 sc1
    s_add_u32 s76, s76, 4096
    v_mfma_f32_16x16x32_bf16 v[232:235], v[52:55], v[136:139], v[232:235]
    s_waitcnt lgkmcnt(6)
    v_mfma_f32_16x16x32_bf16 v[240:243], v[56:59], v[136:139], v[240:243]
    ds_read_b128 v[40:43], v21 offset:37888
    v_mfma_f32_16x16x32_bf16 v[244:247], v[56:59], v[140:143], v[244:247]
    s_add_u32 m0, s39, 12288
    s_nop 0
    buffer_load_dwordx4 v2, s[56:59], s62 offen offset:0 sc1 lds
    v_mfma_f32_16x16x32_bf16 v[252:255], v[60:63], v[140:143], v[252:255]
    ds_read_b128 v[44:47], v21 offset:44032
    v_mfma_f32_16x16x32_bf16 v[248:251], v[60:63], v[136:139], v[248:251]
    s_waitcnt lgkmcnt(6)
    v_mfma_f32_16x16x32_bf16 v[160:163], v[64:67], v[136:139], v[160:163]
    ds_read_b128 v[48:51], v21 offset:38912
    buffer_load_dwordx4 v2, s[56:59], s62 offen offset:1024 sc1 lds
    v_mfma_f32_16x16x32_bf16 v[164:167], v[64:67], v[140:143], v[164:167]
    v_mfma_f32_16x16x32_bf16 v[172:175], v[68:71], v[140:143], v[172:175]
    ds_read_b128 v[52:55], v21 offset:45056
    v_mfma_f32_16x16x32_bf16 v[168:171], v[68:71], v[136:139], v[168:171]
    buffer_load_dwordx4 v[96:99], v2, s[56:59], s76 offen offset:0 sc1
    s_waitcnt lgkmcnt(6)
    v_mfma_f32_16x16x32_bf16 v[176:179], v[72:75], v[136:139], v[176:179]
    ds_read_b128 v[56:59], v21 offset:39936
    v_mfma_f32_16x16x32_bf16 v[180:183], v[72:75], v[140:143], v[180:183]
    v_mfma_f32_16x16x32_bf16 v[188:191], v[76:79], v[140:143], v[188:191]
    ds_read_b128 v[60:63], v21 offset:46080
    buffer_load_dwordx4 a[96:99], v2, s[56:59], s67 offen offset:0 sc1
    v_mfma_f32_16x16x32_bf16 v[184:187], v[76:79], v[136:139], v[184:187]
    s_waitcnt vmcnt(22)
    s_barrier
    s_waitcnt lgkmcnt(6)
    s_waitcnt vmcnt(21)
    v_mfma_f32_16x16x32_bf16 v[192:195], v[32:35], v[144:147], v[192:195]
    ds_read_b128 v[64:67], v21 offset:40960
    v_mfma_f32_16x16x32_bf16 v[196:199], v[32:35], v[148:151], v[196:199]
    buffer_load_dwordx4 v[100:103], v20, s[56:59], s76 offen offset:0 sc1
    v_mfma_f32_16x16x32_bf16 v[204:207], v[36:39], v[148:151], v[204:207]
    ds_read_b128 v[68:71], v21 offset:47104
    v_mfma_f32_16x16x32_bf16 v[200:203], v[36:39], v[144:147], v[200:203]
    s_waitcnt lgkmcnt(6)
    v_mfma_f32_16x16x32_bf16 v[208:211], v[40:43], v[144:147], v[208:211]
    ds_read_b128 v[72:75], v21 offset:41984
    buffer_load_dwordx4 v2, s[56:59], s62 offen offset:2048 sc1 lds
    s_add_u32 s62, s62, 12288
    v_mfma_f32_16x16x32_bf16 v[212:215], v[40:43], v[148:151], v[212:215]
    v_mfma_f32_16x16x32_bf16 v[220:223], v[44:47], v[148:151], v[220:223]
    ds_read_b128 v[76:79], v21 offset:48128
    v_mfma_f32_16x16x32_bf16 v[216:219], v[44:47], v[144:147], v[216:219]
    s_add_u32 m0, s39, 24576
    s_nop 0
    buffer_load_dwordx4 v2, s[56:59], s62 offen offset:0 sc1 lds
    s_waitcnt lgkmcnt(6)
    v_mfma_f32_16x16x32_bf16 v[224:227], v[48:51], v[144:147], v[224:227]
    ds_read_b128 v[32:35], v21 offset:49152
    v_mfma_f32_16x16x32_bf16 v[228:231], v[48:51], v[148:151], v[228:231]
    v_mfma_f32_16x16x32_bf16 v[236:239], v[52:55], v[148:151], v[236:239]
    ds_read_b128 v[36:39], v21 offset:55296
    v_mfma_f32_16x16x32_bf16 v[232:235], v[52:55], v[144:147], v[232:235]
    buffer_load_dwordx4 v[104:107], v2, s[56:59], s76 offen offset:1024 sc1
    s_waitcnt lgkmcnt(6)
    v_mfma_f32_16x16x32_bf16 v[240:243], v[56:59], v[144:147], v[240:243]
    ds_read_b128 v[40:43], v21 offset:50176
    v_mfma_f32_16x16x32_bf16 v[244:247], v[56:59], v[148:151], v[244:247]
    v_mfma_f32_16x16x32_bf16 v[252:255], v[60:63], v[148:151], v[252:255]
    ds_read_b128 v[44:47], v21 offset:56320
    buffer_load_dwordx4 v2, s[56:59], s62 offen offset:1024 sc1 lds
    v_mfma_f32_16x16x32_bf16 v[248:251], v[60:63], v[144:147], v[248:251]
    s_waitcnt lgkmcnt(6)
    v_mfma_f32_16x16x32_bf16 v[160:163], v[64:67], v[144:147], v[160:163]
    ds_read_b128 v[48:51], v21 offset:51200
    v_mfma_f32_16x16x32_bf16 v[164:167], v[64:67], v[148:151], v[164:167]
    v_mfma_f32_16x16x32_bf16 v[172:175], v[68:71], v[148:151], v[172:175]
    ds_read_b128 v[52:55], v21 offset:57344
    buffer_load_dwordx4 v2, s[56:59], s62 offen offset:2048 sc1 lds
    s_add_u32 s62, s62, 12288
    v_mfma_f32_16x16x32_bf16 v[168:171], v[68:71], v[144:147], v[168:171]
    s_waitcnt lgkmcnt(6)
    v_mfma_f32_16x16x32_bf16 v[176:179], v[72:75], v[144:147], v[176:179]
    ds_read_b128 v[56:59], v21 offset:52224
    v_mfma_f32_16x16x32_bf16 v[180:183], v[72:75], v[148:151], v[180:183]
    buffer_load_dwordx4 v[108:111], v20, s[56:59], s76 offen offset:1024 sc1
    v_mfma_f32_16x16x32_bf16 v[188:191], v[76:79], v[148:151], v[188:191]
    ds_read_b128 v[60:63], v21 offset:58368
    v_mfma_f32_16x16x32_bf16 v[184:187], v[76:79], v[144:147], v[184:187]
    s_waitcnt vmcnt(23)
    s_barrier
    s_waitcnt lgkmcnt(6)
    s_waitcnt vmcnt(22)
    v_mfma_f32_16x16x32_bf16 v[192:195], v[32:35], v[152:155], v[192:195]
    ds_read_b128 v[64:67], v21 offset:53248
    v_mfma_f32_16x16x32_bf16 v[196:199], v[32:35], v[156:159], v[196:199]
    buffer_load_dwordx4 v[112:115], v2, s[56:59], s76 offen offset:2048 sc1
    v_mfma_f32_16x16x32_bf16 v[204:207], v[36:39], v[156:159], v[204:207]
    ds_read_b128 v[68:71], v21 offset:59392
    v_mfma_f32_16x16x32_bf16 v[200:203], v[36:39], v[152:155], v[200:203]
    s_waitcnt lgkmcnt(6)
    v_mfma_f32_16x16x32_bf16 v[208:211], v[40:43], v[152:155], v[208:211]
    ds_read_b128 v[72:75], v21 offset:54272
    s_add_u32 m0, s39, 36864
    s_nop 0
    buffer_load_dwordx4 v2, s[56:59], s62 offen offset:0 sc1 lds
    v_mfma_f32_16x16x32_bf16 v[212:215], v[40:43], v[156:159], v[212:215]
    v_mfma_f32_16x16x32_bf16 v[220:223], v[44:47], v[156:159], v[220:223]
    ds_read_b128 v[76:79], v21 offset:60416
    v_mfma_f32_16x16x32_bf16 v[216:219], v[44:47], v[152:155], v[216:219]
    buffer_load_dwordx4 a[100:103], v2, s[56:59], s67 offen offset:1024 sc1
    s_waitcnt lgkmcnt(6)
    v_mfma_f32_16x16x32_bf16 v[224:227], v[48:51], v[152:155], v[224:227]
    ds_read_b128 v[32:35], v22 offset:0
    v_mfma_f32_16x16x32_bf16 v[228:231], v[48:51], v[156:159], v[228:231]
    v_mfma_f32_16x16x32_bf16 v[236:239], v[52:55], v[156:159], v[236:239]
    ds_read_b128 v[36:39], v22 offset:6144
    v_mfma_f32_16x16x32_bf16 v[232:235], v[52:55], v[152:155], v[232:235]
    buffer_load_dwordx4 v[116:119], v20, s[56:59], s76 offen offset:2048 sc1
    s_waitcnt lgkmcnt(6)
    v_mfma_f32_16x16x32_bf16 v[240:243], v[56:59], v[152:155], v[240:243]
    ds_read_b128 v[40:43], v22 offset:1024
    v_mfma_f32_16x16x32_bf16 v[244:247], v[56:59], v[156:159], v[244:247]
    v_mfma_f32_16x16x32_bf16 v[252:255], v[60:63], v[156:159], v[252:255]
    ds_read_b128 v[44:47], v22 offset:7168
    buffer_load_dwordx4 v2, s[56:59], s62 offen offset:1024 sc1 lds
    v_mfma_f32_16x16x32_bf16 v[248:251], v[60:63], v[152:155], v[248:251]
    s_waitcnt lgkmcnt(6)
    v_mfma_f32_16x16x32_bf16 v[160:163], v[64:67], v[152:155], v[160:163]
    ds_read_b128 v[48:51], v22 offset:2048
    v_mfma_f32_16x16x32_bf16 v[164:167], v[64:67], v[156:159], v[164:167]
    v_mfma_f32_16x16x32_bf16 v[172:175], v[68:71], v[156:159], v[172:175]
    ds_read_b128 v[52:55], v22 offset:8192
    buffer_load_dwordx4 v2, s[56:59], s62 offen offset:2048 sc1 lds
    s_add_u32 s62, s62, 12288
    v_mfma_f32_16x16x32_bf16 v[168:171], v[68:71], v[152:155], v[168:171]
    s_waitcnt lgkmcnt(6)
    v_mfma_f32_16x16x32_bf16 v[176:179], v[72:75], v[152:155], v[176:179]
    ds_read_b128 v[56:59], v22 offset:3072
    v_mfma_f32_16x16x32_bf16 v[180:183], v[72:75], v[156:159], v[180:183]
    s_add_u32 m0, s39, 49152
    s_nop 0
    buffer_load_dwordx4 v2, s[56:59], s62 offen offset:0 sc1 lds
    v_mfma_f32_16x16x32_bf16 v[188:191], v[76:79], v[156:159], v[188:191]
    ds_read_b128 v[60:63], v22 offset:9216
    v_mfma_f32_16x16x32_bf16 v[184:187], v[76:79], v[152:155], v[184:187]
    s_waitcnt vmcnt(25)
    s_barrier
    s_waitcnt lgkmcnt(6)
    s_waitcnt vmcnt(24)
    v_mfma_f32_16x16x32_bf16 v[192:195], v[32:35], v[80:83], v[192:195]
    ds_read_b128 v[64:67], v22 offset:4096
    v_mfma_f32_16x16x32_bf16 v[196:199], v[32:35], v[84:87], v[196:199]
    buffer_load_dwordx4 v[120:123], v2, s[56:59], s76 offen offset:3072 sc1
    v_mfma_f32_16x16x32_bf16 v[204:207], v[36:39], v[84:87], v[204:207]
    ds_read_b128 v[68:71], v22 offset:10240
    v_mfma_f32_16x16x32_bf16 v[200:203], v[36:39], v[80:83], v[200:203]
    s_waitcnt lgkmcnt(6)
    v_mfma_f32_16x16x32_bf16 v[208:211], v[40:43], v[80:83], v[208:211]
    ds_read_b128 v[72:75], v22 offset:5120
    buffer_load_dwordx4 v2, s[56:59], s62 offen offset:1024 sc1 lds
    v_mfma_f32_16x16x32_bf16 v[212:215], v[40:43], v[84:87], v[212:215]
    v_mfma_f32_16x16x32_bf16 v[220:223], v[44:47], v[84:87], v[220:223]
    ds_read_b128 v[76:79], v22 offset:11264
    v_mfma_f32_16x16x32_bf16 v[216:219], v[44:47], v[80:83], v[216:219]
    buffer_load_dwordx4 a[104:107], v2, s[56:59], s67 offen offset:2048 sc1
    s_waitcnt lgkmcnt(6)
    v_mfma_f32_16x16x32_bf16 v[224:227], v[48:51], v[80:83], v[224:227]
    ds_read_b128 v[32:35], v22 offset:12288
    v_mfma_f32_16x16x32_bf16 v[228:231], v[48:51], v[84:87], v[228:231]
    v_mfma_f32_16x16x32_bf16 v[236:239], v[52:55], v[84:87], v[236:239]
    ds_read_b128 v[36:39], v22 offset:18432
    v_mfma_f32_16x16x32_bf16 v[232:235], v[52:55], v[80:83], v[232:235]
    buffer_load_dwordx4 v[124:127], v20, s[56:59], s76 offen offset:3072 sc1
    s_add_u32 s76, s76, 4096
    s_waitcnt lgkmcnt(6)
    v_mfma_f32_16x16x32_bf16 v[240:243], v[56:59], v[80:83], v[240:243]
    ds_read_b128 v[40:43], v22 offset:13312
    v_mfma_f32_16x16x32_bf16 v[244:247], v[56:59], v[84:87], v[244:247]
    v_mfma_f32_16x16x32_bf16 v[252:255], v[60:63], v[84:87], v[252:255]
    ds_read_b128 v[44:47], v22 offset:19456
    buffer_load_dwordx4 v2, s[56:59], s62 offen offset:2048 sc1 lds
    s_add_u32 s62, s62, 12288
    v_mfma_f32_16x16x32_bf16 v[248:251], v[60:63], v[80:83], v[248:251]
    s_waitcnt lgkmcnt(6)
    v_mfma_f32_16x16x32_bf16 v[160:163], v[64:67], v[80:83], v[160:163]
    ds_read_b128 v[48:51], v22 offset:14336
    v_mfma_f32_16x16x32_bf16 v[164:167], v[64:67], v[84:87], v[164:167]
    v_mfma_f32_16x16x32_bf16 v[172:175], v[68:71], v[84:87], v[172:175]
    ds_read_b128 v[52:55], v22 offset:20480
    s_add_u32 m0, s39, 61440
    s_nop 0
    buffer_load_dwordx4 v2, s[56:59], s62 offen offset:0 sc1 lds
    v_mfma_f32_16x16x32_bf16 v[168:171], v[68:71], v[80:83], v[168:171]
    s_waitcnt lgkmcnt(6)
    v_mfma_f32_16x16x32_bf16 v[176:179], v[72:75], v[80:83], v[176:179]
    ds_read_b128 v[56:59], v22 offset:15360
    v_mfma_f32_16x16x32_bf16 v[180:183], v[72:75], v[84:87], v[180:183]
    buffer_load_dwordx4 v[128:131], v2, s[56:59], s76 offen offset:0 sc1
    v_mfma_f32_16x16x32_bf16 v[188:191], v[76:79], v[84:87], v[188:191]
    ds_read_b128 v[60:63], v22 offset:21504
    v_mfma_f32_16x16x32_bf16 v[184:187], v[76:79], v[80:83], v[184:187]
    s_waitcnt vmcnt(26)
    s_barrier
    s_waitcnt lgkmcnt(6)
    s_waitcnt vmcnt(25)
    v_mfma_f32_16x16x32_bf16 v[192:195], v[32:35], v[88:91], v[192:195]
    ds_read_b128 v[64:67], v22 offset:16384
    v_mfma_f32_16x16x32_bf16 v[196:199], v[32:35], v[92:95], v[196:199]
    buffer_load_dwordx4 v[132:135], v20, s[56:59], s76 offen offset:0 sc1
    v_mfma_f32_16x16x32_bf16 v[204:207], v[36:39], v[92:95], v[204:207]
    ds_read_b128 v[68:71], v22 offset:22528
    v_mfma_f32_16x16x32_bf16 v[200:203], v[36:39], v[88:91], v[200:203]
    s_waitcnt lgkmcnt(6)
    v_mfma_f32_16x16x32_bf16 v[208:211], v[40:43], v[88:91], v[208:211]
    ds_read_b128 v[72:75], v22 offset:17408
    buffer_load_dwordx4 v2, s[56:59], s62 offen offset:1024 sc1 lds
    v_mfma_f32_16x16x32_bf16 v[212:215], v[40:43], v[92:95], v[212:215]
    v_mfma_f32_16x16x32_bf16 v[220:223], v[44:47], v[92:95], v[220:223]
    ds_read_b128 v[76:79], v22 offset:23552
    v_mfma_f32_16x16x32_bf16 v[216:219], v[44:47], v[88:91], v[216:219]
    buffer_load_dwordx4 v2, s[56:59], s62 offen offset:2048 sc1 lds
    s_add_u32 s62, s62, 12288
    s_waitcnt lgkmcnt(6)
    v_mfma_f32_16x16x32_bf16 v[224:227], v[48:51], v[88:91], v[224:227]
    ds_read_b128 v[32:35], v2 offset:0
    v_mfma_f32_16x16x32_bf16 v[228:231], v[48:51], v[92:95], v[228:231]
    v_mfma_f32_16x16x32_bf16 v[236:239], v[52:55], v[92:95], v[236:239]
    ds_read_b128 v[36:39], v2 offset:6144
    v_mfma_f32_16x16x32_bf16 v[232:235], v[52:55], v[88:91], v[232:235]
    buffer_load_dwordx4 v[136:139], v2, s[56:59], s76 offen offset:1024 sc1
    s_waitcnt lgkmcnt(6)
    v_mfma_f32_16x16x32_bf16 v[240:243], v[56:59], v[88:91], v[240:243]
    ds_read_b128 v[40:43], v2 offset:1024
    v_mfma_f32_16x16x32_bf16 v[244:247], v[56:59], v[92:95], v[244:247]
    v_mfma_f32_16x16x32_bf16 v[252:255], v[60:63], v[92:95], v[252:255]
    ds_read_b128 v[44:47], v2 offset:7168
    s_add_u32 m0, s39, 73728
    s_nop 0
    buffer_load_dwordx4 v2, s[56:59], s62 offen offset:0 sc1 lds
    v_mfma_f32_16x16x32_bf16 v[248:251], v[60:63], v[88:91], v[248:251]
    s_waitcnt lgkmcnt(6)
    v_mfma_f32_16x16x32_bf16 v[160:163], v[64:67], v[88:91], v[160:163]
    ds_read_b128 v[48:51], v2 offset:2048
    v_mfma_f32_16x16x32_bf16 v[164:167], v[64:67], v[92:95], v[164:167]
    v_mfma_f32_16x16x32_bf16 v[172:175], v[68:71], v[92:95], v[172:175]
    ds_read_b128 v[52:55], v2 offset:8192
    buffer_load_dwordx4 a[108:111], v2, s[56:59], s67 offen offset:3072 sc1
    s_add_u32 s67, s67, 4096
    v_mfma_f32_16x16x32_bf16 v[168:171], v[68:71], v[88:91], v[168:171]
    s_waitcnt lgkmcnt(6)
    v_mfma_f32_16x16x32_bf16 v[176:179], v[72:75], v[88:91], v[176:179]
    ds_read_b128 v[56:59], v2 offset:3072
    v_mfma_f32_16x16x32_bf16 v[180:183], v[72:75], v[92:95], v[180:183]
    buffer_load_dwordx4 v2, s[56:59], s62 offen offset:1024 sc1 lds
    v_mfma_f32_16x16x32_bf16 v[188:191], v[76:79], v[92:95], v[188:191]
    ds_read_b128 v[60:63], v2 offset:9216
    v_mfma_f32_16x16x32_bf16 v[184:187], v[76:79], v[88:91], v[184:187]
    s_waitcnt vmcnt(22)
    s_barrier
    s_waitcnt lgkmcnt(6)
    v_mfma_f32_16x16x32_bf16 v[192:195], v[32:35], v[96:99], v[192:195]
    ds_read_b128 v[64:67], v2 offset:4096
    v_mfma_f32_16x16x32_bf16 v[196:199], v[32:35], v[100:103], v[196:199]
    buffer_load_dwordx4 v[140:143], v20, s[56:59], s76 offen offset:1024 sc1
    v_mfma_f32_16x16x32_bf16 v[204:207], v[36:39], v[100:103], v[204:207]
    ds_read_b128 v[68:71], v2 offset:10240
    v_mfma_f32_16x16x32_bf16 v[200:203], v[36:39], v[96:99], v[200:203]
    s_waitcnt lgkmcnt(6)
    v_mfma_f32_16x16x32_bf16 v[208:211], v[40:43], v[96:99], v[208:211]
    ds_read_b128 v[72:75], v2 offset:5120
    buffer_load_dwordx4 v2, s[56:59], s62 offen offset:2048 sc1 lds
    s_add_u32 s62, s62, 12288
    v_mfma_f32_16x16x32_bf16 v[212:215], v[40:43], v[100:103], v[212:215]
    v_mfma_f32_16x16x32_bf16 v[220:223], v[44:47], v[100:103], v[220:223]
    ds_read_b128 v[76:79], v2 offset:11264
    v_mfma_f32_16x16x32_bf16 v[216:219], v[44:47], v[96:99], v[216:219]
    s_add_u32 m0, s39, 86016
    s_nop 0
    buffer_load_dwordx4 v2, s[56:59], s62 offen offset:0 sc1 lds
    s_waitcnt lgkmcnt(6)
    v_mfma_f32_16x16x32_bf16 v[224:227], v[48:51], v[96:99], v[224:227]
    ds_read_b128 v[32:35], v2 offset:16384
    v_mfma_f32_16x16x32_bf16 v[228:231], v[48:51], v[100:103], v[228:231]
    v_mfma_f32_16x16x32_bf16 v[236:239], v[52:55], v[100:103], v[236:239]
    ds_read_b128 v[36:39], v2 offset:22528
    v_mfma_f32_16x16x32_bf16 v[232:235], v[52:55], v[96:99], v[232:235]
    buffer_load_dwordx4 v[144:147], v2, s[56:59], s76 offen offset:2048 sc1
    s_waitcnt lgkmcnt(6)
    v_mfma_f32_16x16x32_bf16 v[240:243], v[56:59], v[96:99], v[240:243]
    ds_read_b128 v[40:43], v2 offset:17408
    v_mfma_f32_16x16x32_bf16 v[244:247], v[56:59], v[100:103], v[244:247]
    v_mfma_f32_16x16x32_bf16 v[252:255], v[60:63], v[100:103], v[252:255]
    ds_read_b128 v[44:47], v2 offset:23552
    buffer_load_dwordx4 v2, s[56:59], s62 offen offset:1024 sc1 lds
    v_mfma_f32_16x16x32_bf16 v[248:251], v[60:63], v[96:99], v[248:251]
    s_waitcnt lgkmcnt(6)
    v_mfma_f32_16x16x32_bf16 v[160:163], v[64:67], v[96:99], v[160:163]
    ds_read_b128 v[48:51], v2 offset:28672
    v_mfma_f32_16x16x32_bf16 v[164:167], v[64:67], v[100:103], v[164:167]
    v_mfma_f32_16x16x32_bf16 v[172:175], v[68:71], v[100:103], v[172:175]
    ds_read_b128 v[52:55], v2 offset:34816
    buffer_load_dwordx4 v2, s[56:59], s62 offen offset:2048 sc1 lds
    s_add_u32 s62, s62, 12288
    v_mfma_f32_16x16x32_bf16 v[168:171], v[68:71], v[96:99], v[168:171]
    s_waitcnt lgkmcnt(6)
    v_mfma_f32_16x16x32_bf16 v[176:179], v[72:75], v[96:99], v[176:179]
    ds_read_b128 v[56:59], v2 offset:29696
    v_mfma_f32_16x16x32_bf16 v[180:183], v[72:75], v[100:103], v[180:183]
    buffer_load_dwordx4 v[148:151], v20, s[56:59], s76 offen offset:2048 sc1
    v_mfma_f32_16x16x32_bf16 v[188:191], v[76:79], v[100:103], v[188:191]
    ds_read_b128 v[60:63], v2 offset:35840
    v_mfma_f32_16x16x32_bf16 v[184:187], v[76:79], v[96:99], v[184:187]
    s_waitcnt vmcnt(11)
    s_barrier
    s_waitcnt lgkmcnt(6)
    v_mfma_f32_16x16x32_bf16 v[160:163], v[32:35], v[104:107], v[160:163]
    ds_read_b128 v[64:67], v2 offset:40960
    v_mfma_f32_16x16x32_bf16 v[164:167], v[32:35], v[108:111], v[164:167]
    buffer_load_dwordx4 v[152:155], v2, s[56:59], s76 offen offset:3072 sc1
    v_mfma_f32_16x16x32_bf16 v[172:175], v[36:39], v[108:111], v[172:175]
    ds_read_b128 v[68:71], v2 offset:47104
    v_mfma_f32_16x16x32_bf16 v[168:171], v[36:39], v[104:107], v[168:171]
    s_waitcnt lgkmcnt(6)
    v_mfma_f32_16x16x32_bf16 v[176:179], v[40:43], v[104:107], v[176:179]
    ds_read_b128 v[72:75], v2 offset:41984
    v_mfma_f32_16x16x32_bf16 v[180:183], v[40:43], v[108:111], v[180:183]
    v_mfma_f32_16x16x32_bf16 v[188:191], v[44:47], v[108:111], v[188:191]
    ds_read_b128 v[76:79], v2 offset:48128
    v_mfma_f32_16x16x32_bf16 v[184:187], v[44:47], v[104:107], v[184:187]
    s_waitcnt lgkmcnt(6)
    v_mfma_f32_16x16x32_bf16 v[160:163], v[48:51], v[112:115], v[160:163]
    ds_read_b128 v[32:35], v2 offset:53248
    v_mfma_f32_16x16x32_bf16 v[164:167], v[48:51], v[116:119], v[164:167]
    v_mfma_f32_16x16x32_bf16 v[172:175], v[52:55], v[116:119], v[172:175]
    ds_read_b128 v[36:39], v2 offset:59392
    v_mfma_f32_16x16x32_bf16 v[168:171], v[52:55], v[112:115], v[168:171]
    s_waitcnt lgkmcnt(6)
    v_mfma_f32_16x16x32_bf16 v[176:179], v[56:59], v[112:115], v[176:179]
    ds_read_b128 v[40:43], v2 offset:54272
    v_mfma_f32_16x16x32_bf16 v[180:183], v[56:59], v[116:119], v[180:183]
    buffer_load_dwordx4 v[156:159], v20, s[56:59], s76 offen offset:3072 sc1
    s_add_u32 s76, s76, 4096
    v_mfma_f32_16x16x32_bf16 v[188:191], v[60:63], v[116:119], v[188:191]
    ds_read_b128 v[44:47], v2 offset:60416
    v_mfma_f32_16x16x32_bf16 v[184:187], v[60:63], v[112:115], v[184:187]
    s_waitcnt lgkmcnt(6)
    v_mfma_f32_16x16x32_bf16 v[160:163], v[64:67], v[120:123], v[160:163]
    ds_read_b128 v[48:51], v21 offset:4096
    v_mfma_f32_16x16x32_bf16 v[164:167], v[64:67], v[124:127], v[164:167]
    v_mfma_f32_16x16x32_bf16 v[172:175], v[68:71], v[124:127], v[172:175]
    ds_read_b128 v[52:55], v21 offset:10240
    v_mfma_f32_16x16x32_bf16 v[168:171], v[68:71], v[120:123], v[168:171]
    s_waitcnt lgkmcnt(6)
    v_mfma_f32_16x16x32_bf16 v[176:179], v[72:75], v[120:123], v[176:179]
    ds_read_b128 v[56:59], v21 offset:5120
    v_mfma_f32_16x16x32_bf16 v[180:183], v[72:75], v[124:127], v[180:183]
    v_mfma_f32_16x16x32_bf16 v[188:191], v[76:79], v[124:127], v[188:191]
    ds_read_b128 v[60:63], v21 offset:11264
    v_mfma_f32_16x16x32_bf16 v[184:187], v[76:79], v[120:123], v[184:187]
    s_waitcnt vmcnt(3)
    s_branch L_g1tail
L_join:
    s_barrier
    ds_read_b64 v[28:29], v228
    s_add_u32 m0, s39, 24576
    s_nop 0
    buffer_load_dwordx4 v2, s[56:59], s62 offen offset:0 sc1 lds
    ds_read_b128 v[16:19], v224
    ds_read_b128 v[20:23], v224 offset:64
    ds_read_b64 v[24:25], v225 offset:128
    ds_read_b128 v[52:55], v226 offset:320
    ds_read_b128 v[56:59], v226 offset:336
    ds_read_b128 v[60:63], v226 offset:448
    ds_read_b128 v[64:67], v226 offset:464
    ds_read_b128 v[68:71], v227 offset:576
    ds_read_b128 v[32:35], v226 offset:0
    ds_read_b128 v[36:39], v226 offset:16
    ds_read_b128 v[40:43], v226 offset:128
    ds_read_b128 v[44:47], v226 offset:144
    buffer_load_dwordx4 v2, s[56:59], s62 offen offset:1024 sc1 lds
    ds_read_b128 v[48:51], v227 offset:256
    s_waitcnt lgkmcnt(10)
    v_lshlrev_b32 v152, 16, v16
    v_and_b32 v153, s64, v16
    v_lshlrev_b32 v154, 16, v17
    v_and_b32 v155, s64, v17
    v_lshlrev_b32 v156, 16, v18
    v_and_b32 v157, s64, v18
    v_lshlrev_b32 v158, 16, v19
    v_and_b32 v159, s64, v19
    v_lshlrev_b32 v160, 16, v20
    v_and_b32 v161, s64, v20
    buffer_load_dwordx4 v2, s[56:59], s62 offen offset:2048 sc1 lds
    v_lshlrev_b32 v162, 16, v21
    v_and_b32 v163, s64, v21
    v_lshlrev_b32 v164, 16, v22
    v_and_b32 v165, s64, v22
    v_lshlrev_b32 v166, 16, v23
    v_and_b32 v167, s64, v23
    v_lshlrev_b32 v168, 16, v24
    v_and_b32 v169, s64, v24
    v_lshlrev_b32 v170, 16, v25
    v_and_b32 v171, s64, v25
    ds_read_b128 v[72:75], v226 offset:640
    ds_read_b128 v[76:79], v226 offset:656
    buffer_load_dwordx4 v2, s[56:59], s62 offen offset:3072 sc1 lds
    s_add_u32 s62, s62, 12288
    ds_read_b128 v[80:83], v226 offset:768
    ds_read_b128 v[84:87], v226 offset:784
    ds_read_b128 v[88:91], v227 offset:896
    v_pk_fma_f32 v[172:173], v[152:153], v[28:29], v[28:29] op_sel:[0,0,1] op_sel_hi:[1,0,1]
    v_pk_fma_f32 v[174:175], v[154:155], v[28:29], v[28:29] op_sel:[0,0,1] op_sel_hi:[1,0,1]
    v_pk_fma_f32 v[176:177], v[156:157], v[28:29], v[28:29] op_sel:[0,0,1] op_sel_hi:[1,0,1]
    v_pk_fma_f32 v[178:179], v[158:159], v[28:29], v[28:29] op_sel:[0,0,1] op_sel_hi:[1,0,1]
    v_pk_fma_f32 v[180:181], v[160:161], v[28:29], v[28:29] op_sel:[0,0,1] op_sel_hi:[1,0,1]
    v_pk_fma_f32 v[182:183], v[162:163], v[28:29], v[28:29] op_sel:[0,0,1] op_sel_hi:[1,0,1]
    v_pk_fma_f32 v[184:185], v[164:165], v[28:29], v[28:29] op_sel:[0,0,1] op_sel_hi:[1,0,1]
    v_pk_fma_f32 v[186:187], v[166:167], v[28:29], v[28:29] op_sel:[0,0,1] op_sel_hi:[1,0,1]
    v_pk_fma_f32 v[188:189], v[168:169], v[28:29], v[28:29] op_sel:[0,0,1] op_sel_hi:[1,0,1]
    s_add_u32 m0, s39, 36864
    s_nop 0
    buffer_load_dwordx4 v2, s[56:59], s62 offen offset:0 sc1 lds
    v_pk_fma_f32 v[190:191], v[170:171], v[28:29], v[28:29] op_sel:[0,0,1] op_sel_hi:[1,0,1]
    s_waitcnt lgkmcnt(5)
    ds_read_b128 v[92:95], v226 offset:960
    ds_read_b128 v[96:99], v226 offset:976
    ds_read_b128 v[100:103], v226 offset:1088
    ds_read_b128 v[104:107], v226 offset:1104
    ds_read_b128 v[108:111], v227 offset:1216
    ds_read_b128 v[112:115], v226 offset:1280
    ds_read_b128 v[116:119], v226 offset:1296
    ds_read_b128 v[120:123], v226 offset:1408
    ds_read_b128 v[124:127], v226 offset:1424
    ds_read_b128 v[128:131], v227 offset:1536
    buffer_load_dwordx4 v2, s[56:59], s62 offen offset:1024 sc1 lds
    v_pk_fma_f32 v[172:173], v[172:173], v[52:53], v[32:33]
    v_pk_fma_f32 v[174:175], v[174:175], v[54:55], v[34:35]
    v_pk_fma_f32 v[176:177], v[176:177], v[56:57], v[36:37]
    v_pk_fma_f32 v[178:179], v[178:179], v[58:59], v[38:39]
    v_pk_fma_f32 v[180:181], v[180:181], v[60:61], v[40:41]
    v_pk_fma_f32 v[182:183], v[182:183], v[62:63], v[42:43]
    v_pk_fma_f32 v[184:185], v[184:185], v[64:65], v[44:45]
    v_pk_fma_f32 v[186:187], v[186:187], v[66:67], v[46:47]
    v_pk_fma_f32 v[188:189], v[188:189], v[68:69], v[48:49]
    v_pk_fma_f32 v[190:191], v[190:191], v[70:71], v[50:51]
    s_waitcnt lgkmcnt(10)
    v_pk_mul_f32 v[172:173], v[172:173], v[72:73]
    buffer_load_dwordx4 v2, s[56:59], s62 offen offset:2048 sc1 lds
    v_pk_mul_f32 v[174:175], v[174:175], v[74:75]
    v_pk_mul_f32 v[176:177], v[176:177], v[76:77]
    v_pk_mul_f32 v[178:179], v[178:179], v[78:79]
    v_pk_mul_f32 v[180:181], v[180:181], v[80:81]
    v_pk_mul_f32 v[182:183], v[182:183], v[82:83]
    v_pk_mul_f32 v[184:185], v[184:185], v[84:85]
    v_pk_mul_f32 v[186:187], v[186:187], v[86:87]
    v_pk_mul_f32 v[188:189], v[188:189], v[88:89]
    v_pk_mul_f32 v[190:191], v[190:191], v[90:91]
    v_lshlrev_b32 v11, 26, v1
    v_and_b32 v9, 7, v1
    v_lshlrev_b32 v9, 2, v9
    buffer_load_dwordx4 v2, s[56:59], s62 offen offset:3072 sc1 lds
    s_add_u32 s62, s62, 12288
    s_waitcnt lgkmcnt(0)
    s_waitcnt vmcnt(12)
    s_barrier
    ds_read_b64_tr_b16 v[192:193], v13 offset:0
    ds_read_b64_tr_b16 v[194:195], v13 offset:256
    ds_read_b64_tr_b16 v[196:197], v13 offset:2048
    ds_read_b64_tr_b16 v[198:199], v13 offset:2304
    ds_read_b64_tr_b16 v[200:201], v14 offset:4096
    s_waitcnt lgkmcnt(4)
    v_lshlrev_b32 v204, 16, v192
    v_and_b32 v205, s64, v192
    v_lshlrev_b32 v206, 16, v193
    s_add_u32 m0, s39, 49152
    s_nop 0
    buffer_load_dwordx4 v2, s[56:59], s62 offen offset:0 sc1 lds
    v_and_b32 v207, s64, v193
    v_pk_fma_f32 v[152:153], v[172:173], v[204:205], v[152:153]
    v_pk_fma_f32 v[154:155], v[174:175], v[206:207], v[154:155]
    v_pk_mul_f32 v[150:151], v[152:153], v[152:153]
    v_pk_add_f32 v[148:149], v[152:153], v[154:155]
    v_pk_fma_f32 v[150:151], v[154:155], v[154:155], v[150:151]
    s_waitcnt lgkmcnt(3)
    v_lshlrev_b32 v208, 16, v194
    v_and_b32 v209, s64, v194
    v_lshlrev_b32 v210, 16, v195
    v_and_b32 v211, s64, v195
    v_pk_fma_f32 v[156:157], v[176:177], v[208:209], v[156:157]
    buffer_load_dwordx4 v2, s[56:59], s62 offen offset:1024 sc1 lds
    v_pk_fma_f32 v[158:159], v[178:179], v[210:211], v[158:159]
    v_pk_add_f32 v[148:149], v[148:149], v[156:157]
    v_pk_fma_f32 v[150:151], v[156:157], v[156:157], v[150:151]
    v_pk_add_f32 v[148:149], v[148:149], v[158:159]
    v_pk_fma_f32 v[150:151], v[158:159], v[158:159], v[150:151]
    s_waitcnt lgkmcnt(2)
    v_lshlrev_b32 v212, 16, v196
    v_and_b32 v213, s64, v196
    v_lshlrev_b32 v214, 16, v197
    v_and_b32 v215, s64, v197
    v_pk_fma_f32 v[160:161], v[180:181], v[212:213], v[160:161]
    v_pk_fma_f32 v[162:163], v[182:183], v[214:215], v[162:163]
    buffer_load_dwordx4 v2, s[56:59], s62 offen offset:2048 sc1 lds
    v_pk_add_f32 v[148:149], v[148:149], v[160:161]
    v_pk_fma_f32 v[150:151], v[160:161], v[160:161], v[150:151]
    v_pk_add_f32 v[148:149], v[148:149], v[162:163]
    v_pk_fma_f32 v[150:151], v[162:163], v[162:163], v[150:151]
    s_waitcnt lgkmcnt(1)
    v_lshlrev_b32 v216, 16, v198
    v_and_b32 v217, s64, v198
    v_lshlrev_b32 v218, 16, v199
    v_and_b32 v219, s64, v199
    v_pk_fma_f32 v[164:165], v[184:185], v[216:217], v[164:165]
    v_pk_fma_f32 v[166:167], v[186:187], v[218:219], v[166:167]
    v_pk_add_f32 v[148:149], v[148:149], v[164:165]
    buffer_load_dwordx4 v2, s[56:59], s62 offen offset:3072 sc1 lds
    s_add_u32 s62, s62, 12288
    v_pk_fma_f32 v[150:151], v[164:165], v[164:165], v[150:151]
    v_pk_add_f32 v[148:149], v[148:149], v[166:167]
    v_pk_fma_f32 v[150:151], v[166:167], v[166:167], v[150:151]
    s_waitcnt lgkmcnt(0)
    v_lshlrev_b32 v220, 16, v200
    v_and_b32 v221, s64, v200
    v_lshlrev_b32 v222, 16, v201
    v_and_b32 v223, s64, v201
    v_pk_fma_f32 v[168:169], v[188:189], v[220:221], v[168:169]
    v_pk_fma_f32 v[170:171], v[190:191], v[222:223], v[170:171]
    v_pk_add_f32 v[148:149], v[148:149], v[168:169]
    v_pk_fma_f32 v[150:151], v[168:169], v[168:169], v[150:151]
    s_add_u32 m0, s39, 61440
    s_nop 0
    buffer_load_dwordx4 v2, s[56:59], s62 offen offset:0 sc1 lds
    v_pk_add_f32 v[148:149], v[148:149], v[170:171]
    v_pk_fma_f32 v[150:151], v[170:171], v[170:171], v[150:151]
    v_add_f32 v148, v148, v149
    v_add_f32 v149, v150, v151
    v_mov_b32 v151, v0
    s_nop 0
    v_permlane32_swap_b32 v148, v149
    v_add_f32 v148, v148, v149
    v_mov_b32 v149, v148
    s_nop 1
    v_permlane16_swap_b32 v148, v149
    v_add_f32 v150, v148, v149
    s_cmp_lg_u32 s6, 1
    s_cbranch_scc1 Lslow_27
    buffer_store_dwordx2 v[150:151], v30, s[56:59], s77 offen
Lback_28:
    v_cvt_pk_bf16_f32 v192, v152, v153
    v_cvt_pk_bf16_f32 v193, v154, v155
    v_cvt_pk_bf16_f32 v194, v156, v157
    v_cvt_pk_bf16_f32 v195, v158, v159
    v_cvt_pk_bf16_f32 v196, v160, v161
    v_cvt_pk_bf16_f32 v197, v162, v163
    v_cvt_pk_bf16_f32 v198, v164, v165
    v_cvt_pk_bf16_f32 v199, v166, v167
    buffer_load_dwordx4 v2, s[56:59], s62 offen offset:1024 sc1 lds
    v_cvt_pk_bf16_f32 v200, v168, v169
    v_cvt_pk_bf16_f32 v201, v170, v171
    v_accvgpr_write_b32 a240, v192
    v_accvgpr_write_b32 a241, v193
    v_accvgpr_write_b32 a242, v194
    v_accvgpr_write_b32 a243, v195
    v_accvgpr_write_b32 a244, v196
    v_accvgpr_write_b32 a245, v197
    v_accvgpr_write_b32 a246, v198
    v_accvgpr_write_b32 a247, v199
    v_accvgpr_write_b32 a248, v200
    v_accvgpr_write_b32 a249, v201
    buffer_load_dwordx4 v2, s[56:59], s62 offen offset:2048 sc1 lds
    s_and_b32 s15, s4, 1
    s_and_b32 s69, s5, 2
    s_add_u32 s15, s15, s69
    s_lshl_b32 s69, s15, 1
    s_add_u32 s69, s69, s66
    s_mul_i32 s76, s3, 327680
    s_mul_i32 s70, s69, 40960
    s_add_u32 s76, s76, s70
    v_add_u32 v20, 20480, v2
    v_add_u32 v21, 61440, v2
    v_add_u32 v22, 122880, v2
    v_lshlrev_b32 v9, 2, v6
    buffer_load_dwordx4 v2, s[56:59], s62 offen offset:3072 sc1 lds
    s_add_u32 s62, s62, 12288
    s_lshl_b32 s69, s69, 6
    s_add_u32 s69, s69, s63
    s_add_u32 s79, s69, 1792
Lst2_29:
    buffer_load_dwordx4 v[136:139], v2, s[56:59], s73 offen sc1
    buffer_load_dwordx4 v[140:143], v2, s[56:59], s73 offen offset:1024 sc1
    s_waitcnt vmcnt(0)
    v_min3_u32 v144, v137, v139, v141
    v_max3_u32 v145, v137, v139, v141
    v_min3_u32 v144, v144, v143, v0
    v_max3_u32 v145, v145, v143, v0
    v_cmp_ne_u32 vcc, v144, v145
    v_add_f32 v148, v136, v140
    v_add_f32 v149, v138, v142
    s_cbranch_vccz Lok_30
    s_sub_u32 s7, s7, 1
    s_cbranch_scc0 Lst2_29
    s_endpgm
Lok_30:
    v_mov_b32 v150, v148
    v_mov_b32 v151, v149
    s_nop 0
    v_permlane32_swap_b32 v148, v150
    v_permlane32_swap_b32 v149, v151
    v_pk_add_f32 v[148:149], v[148:149], v[150:151]
    v_mov_b32 v150, v148
    v_mov_b32 v151, v149
    s_nop 0
    v_permlane16_swap_b32 v148, v150
    v_permlane16_swap_b32 v149, v151
    v_pk_add_f32 v[148:149], v[148:149], v[150:151]
    v_mul_f32 v148, 0x3acccccd, v148
    v_mul_f32 v149, 0x3acccccd, v149
    v_fma_f32 v149, -v148, v148, v149
    v_max_f32 v149, 0, v149
    v_add_f32 v149, 0x3727c5ac, v149
    v_rsq_f32 v149, v149
    s_nop 0
    v_mul_f32 v148, v148, v149
    v_sub_f32 v148, 0, v148
    v_swap_b32 v148, v149
    v_pk_fma_f32 v[172:173], v[152:153], v[148:149], v[148:149] op_sel:[0,0,1] op_sel_hi:[1,0,1]
    v_pk_fma_f32 v[174:175], v[154:155], v[148:149], v[148:149] op_sel:[0,0,1] op_sel_hi:[1,0,1]
    v_pk_fma_f32 v[176:177], v[156:157], v[148:149], v[148:149] op_sel:[0,0,1] op_sel_hi:[1,0,1]
    v_pk_fma_f32 v[178:179], v[158:159], v[148:149], v[148:149] op_sel:[0,0,1] op_sel_hi:[1,0,1]
    v_pk_fma_f32 v[172:173], v[172:173], v[112:113], v[92:93]
    v_pk_fma_f32 v[174:175], v[174:175], v[114:115], v[94:95]
    v_pk_fma_f32 v[176:177], v[176:177], v[116:117], v[96:97]
    v_pk_fma_f32 v[178:179], v[178:179], v[118:119], v[98:99]
    v_cvt_pk_bf16_f32 v192, v172, v173
    v_cvt_pk_bf16_f32 v193, v174, v175
    v_cvt_pk_bf16_f32 v194, v176, v177
    v_cvt_pk_bf16_f32 v195, v178, v179
    s_cmp_lg_u32 s6, 1
    s_cbranch_scc1 Lslow_31
    buffer_store_dwordx4 v[192:195], v2, s[56:59], s72 offen
Lback_32:
    v_pk_fma_f32 v[180:181], v[160:161], v[148:149], v[148:149] op_sel:[0,0,1] op_sel_hi:[1,0,1]
    v_pk_fma_f32 v[182:183], v[162:163], v[148:149], v[148:149] op_sel:[0,0,1] op_sel_hi:[1,0,1]
    v_pk_fma_f32 v[184:185], v[164:165], v[148:149], v[148:149] op_sel:[0,0,1] op_sel_hi:[1,0,1]
    v_pk_fma_f32 v[186:187], v[166:167], v[148:149], v[148:149] op_sel:[0,0,1] op_sel_hi:[1,0,1]
    v_pk_fma_f32 v[180:181], v[180:181], v[120:121], v[100:101]
    v_pk_fma_f32 v[182:183], v[182:183], v[122:123], v[102:103]
    v_pk_fma_f32 v[184:185], v[184:185], v[124:125], v[104:105]
    v_pk_fma_f32 v[186:187], v[186:187], v[126:127], v[106:107]
    v_cvt_pk_bf16_f32 v196, v180, v181
    v_cvt_pk_bf16_f32 v197, v182, v183
    v_cvt_pk_bf16_f32 v198, v184, v185
    v_cvt_pk_bf16_f32 v199, v186, v187
    v_pk_fma_f32 v[188:189], v[168:169], v[148:149], v[148:149] op_sel:[0,0,1] op_sel_hi:[1,0,1]
    v_pk_fma_f32 v[190:191], v[170:171], v[148:149], v[148:149] op_sel:[0,0,1] op_sel_hi:[1,0,1]
    v_pk_fma_f32 v[188:189], v[188:189], v[128:129], v[108:109]
    v_pk_fma_f32 v[190:191], v[190:191], v[130:131], v[110:111]
    v_cvt_pk_bf16_f32 v200, v188, v189
    v_cvt_pk_bf16_f32 v201, v190, v191
    s_cmp_lg_u32 s6, 1
    s_cbranch_scc1 Lslow_33
    buffer_store_dwordx4 v[196:199], v2, s[56:59], s72 offen offset:1024
    buffer_store_dwordx2 v[200:201], v12, s[56:59], s72 offen offset:2048
Lback_34:
    s_waitcnt vmcnt(0)
    s_cmp_lg_u32 s6, 1
    s_cbranch_scc1 Lslow_35
    buffer_store_dword v0, v11, s[56:59], s81 offen
Lback_36:
    s_barrier
    s_lshl_b32 s69, s5, 10
    s_sub_u32 s39, s39, s69
    s_sub_u32 s62, s62, s69
    ds_read_b128 v[32:35], v2 offset:0
    ds_read_b128 v[36:39], v2 offset:6144
    ds_read_b128 v[40:43], v2 offset:1024
    ds_read_b128 v[44:47], v2 offset:7168
    ds_read_b128 v[48:51], v2 offset:2048
    ds_read_b128 v[52:55], v2 offset:8192
    ds_read_b128 v[56:59], v2 offset:3072
    ds_read_b128 v[60:63], v2 offset:9216
Lpoll_37:
    buffer_load_dword v10, v9, s[56:59], s79 offen sc1
    s_waitcnt vmcnt(0)
    v_cmp_ne_u32 vcc, s36, v10
    s_cbranch_vccz Lok_38
    s_sub_u32 s7, s7, 1
    s_cbranch_scc0 Lpoll_37
    s_endpgm
Lok_38:
    buffer_load_dwordx4 v[80:83], v2, s[56:59], s76 offen offset:0 sc1
    buffer_load_dwordx4 v[84:87], v20, s[56:59], s76 offen offset:0 sc1
    buffer_load_dwordx4 v[88:91], v2, s[56:59], s76 offen offset:1024 sc1
    buffer_load_dwordx4 v[92:95], v20, s[56:59], s76 offen offset:1024 sc1
    s_waitcnt lgkmcnt(6)
    s_waitcnt vmcnt(2)
    v_mfma_f32_16x16x32_bf16 v[192:195], v[32:35], v[80:83], 0
    ds_read_b128 v[64:67], v2 offset:4096
    s_mul_i32 s70, s3, 327680
    s_lshr_b32 s71, s4, 1
    v_mfma_f32_16x16x32_bf16 v[196:199], v[32:35], v[84:87], 0
    buffer_load_dwordx4 v[96:99], v2, s[56:59], s76 offen offset:2048 sc1
    s_lshl_b32 s69, s71, 10
    s_add_u32 s69, s69, s70
    s_lshl_b32 s12, s66, 15
    v_mfma_f32_16x16x32_bf16 v[204:207], v[36:39], v[84:87], 0
    ds_read_b128 v[68:71], v2 offset:10240
    s_add_u32 s69, s69, s12
    s_mul_i32 s12, s15, 81920
    v_mfma_f32_16x16x32_bf16 v[200:203], v[36:39], v[80:83], 0
    s_add_u32 s12, s12, s69
    s_add_u32 s75, s12, 4194304
    s_waitcnt lgkmcnt(6)
    v_mfma_f32_16x16x32_bf16 v[208:211], v[40:43], v[80:83], 0
    ds_read_b128 v[72:75], v2 offset:5120
    s_add_u32 s80, s12, 13631488
    s_lshl_b32 s69, s71, 1
    v_mfma_f32_16x16x32_bf16 v[212:215], v[40:43], v[84:87], 0
    s_add_u32 s69, s69, s66
    s_lshl_b32 s69, s69, 2
    s_lshl_b32 s71, s15, 7
    v_mfma_f32_16x16x32_bf16 v[220:223], v[44:47], v[84:87], 0
    ds_read_b128 v[76:79], v2 offset:11264
    s_add_u32 s71, s71, s63
    s_add_u32 s13, s71, 3456
    v_mfma_f32_16x16x32_bf16 v[216:219], v[44:47], v[80:83], 0
    s_add_u32 s69, s69, s71
    s_add_u32 s73, s69, 2304
    s_waitcnt lgkmcnt(6)
    v_mfma_f32_16x16x32_bf16 v[224:227], v[48:51], v[80:83], 0
    ds_read_b128 v[32:35], v2 offset:12288
    s_add_u32 s72, s69, 2944
    s_add_u32 s14, s69, 3456
    v_mfma_f32_16x16x32_bf16 v[228:231], v[48:51], v[84:87], 0
    buffer_load_dwordx4 v[100:103], v20, s[56:59], s76 offen offset:2048 sc1
    s_lshl_b32 s69, s60, 7
    s_lshl_b32 s71, s5, 5
    s_add_u32 s69, s69, s71
    v_mfma_f32_16x16x32_bf16 v[236:239], v[52:55], v[84:87], 0
    ds_read_b128 v[36:39], v2 offset:18432
    s_add_u32 s69, s69, s63
    s_add_u32 s74, s69, 2304
    v_mfma_f32_16x16x32_bf16 v[232:235], v[52:55], v[80:83], 0
    s_add_u32 s38, s69, 2944
    s_mul_i32 s69, s60, 81920
    s_waitcnt lgkmcnt(6)
    v_mfma_f32_16x16x32_bf16 v[240:243], v[56:59], v[80:83], 0
    ds_read_b128 v[40:43], v2 offset:13312
    s_add_u32 s70, s70, s69
    s_lshl_b32 s69, s5, 12
    v_mfma_f32_16x16x32_bf16 v[244:247], v[56:59], v[84:87], 0
    s_add_u32 s70, s70, s69
    v_and_b32 v9, 7, v1
    v_lshlrev_b32 v9, 2, v9
    v_mfma_f32_16x16x32_bf16 v[252:255], v[60:63], v[84:87], 0
    ds_read_b128 v[44:47], v2 offset:19456
    v_and_b32 v28, 31, v1
    v_lshlrev_b32 v28, 2, v28
    v_mfma_f32_16x16x32_bf16 v[248:251], v[60:63], v[80:83], 0
    v_add_u32 v23, 16384, v2
    v_add_u32 v27, 4194304, v2
    s_waitcnt lgkmcnt(6)
    v_mfma_f32_16x16x32_bf16 v[160:163], v[64:67], v[80:83], 0
    ds_read_b128 v[48:51], v2 offset:14336
    v_add_u32 v29, 13631488, v2
    v_lshlrev_b32 v10, 3, v1
    v_mfma_f32_16x16x32_bf16 v[164:167], v[64:67], v[84:87], 0
    buffer_load_dwordx4 v[104:107], v2, s[56:59], s76 offen offset:3072 sc1
    s_add_u32 s69, s5, 1
    s_and_b32 s69, s69, 3
    s_lshl_b32 s71, s69, 14
    v_mfma_f32_16x16x32_bf16 v[172:175], v[68:71], v[84:87], 0
    ds_read_b128 v[52:55], v2 offset:20480
    s_add_u32 s77, s71, s70
    s_mul_i32 s69, s69, 15360
    v_mfma_f32_16x16x32_bf16 v[168:171], v[68:71], v[80:83], 0
    v_add_u32 v16, s69, v10
    s_add_u32 s69, s5, 2
    s_waitcnt lgkmcnt(6)
    v_mfma_f32_16x16x32_bf16 v[176:179], v[72:75], v[80:83], 0
    ds_read_b128 v[56:59], v2 offset:15360
    s_and_b32 s69, s69, 3
    s_lshl_b32 s71, s69, 14
    v_mfma_f32_16x16x32_bf16 v[180:183], v[72:75], v[84:87], 0
    s_add_u32 s78, s71, s70
    s_mul_i32 s69, s69, 15360
    s_add_u32 s69, s69, 5120
    v_mfma_f32_16x16x32_bf16 v[188:191], v[76:79], v[84:87], 0
    ds_read_b128 v[60:63], v2 offset:21504
    v_add_u32 v17, s69, v10
    s_add_u32 s69, s5, 3
    v_mfma_f32_16x16x32_bf16 v[184:187], v[76:79], v[80:83], 0
    s_and_b32 s69, s69, 3
    s_lshl_b32 s71, s69, 14
    s_waitcnt lgkmcnt(6)
    s_waitcnt vmcnt(3)
    v_mfma_f32_16x16x32_bf16 v[192:195], v[32:35], v[88:91], v[192:195]
    ds_read_b128 v[64:67], v2 offset:16384
    s_add_u32 s79, s71, s70
    s_mul_i32 s69, s69, 15360
    v_mfma_f32_16x16x32_bf16 v[196:199], v[32:35], v[92:95], v[196:199]
    buffer_load_dwordx4 v[108:111], v20, s[56:59], s76 offen offset:3072 sc1
    s_add_u32 s76, s76, 4096
    s_add_u32 s69, s69, 10240
    v_add_u32 v18, s69, v10
    s_add_u32 s69, s5, 4
    v_mfma_f32_16x16x32_bf16 v[204:207], v[36:39], v[92:95], v[204:207]
    ds_read_b128 v[68:71], v2 offset:22528
    s_and_b32 s69, s69, 3
    s_lshl_b32 s71, s69, 14
    v_mfma_f32_16x16x32_bf16 v[200:203], v[36:39], v[88:91], v[200:203]
    s_add_u32 s81, s71, s70
    s_mul_i32 s69, s69, 15360
    s_waitcnt lgkmcnt(6)
    v_mfma_f32_16x16x32_bf16 v[208:211], v[40:43], v[88:91], v[208:211]
    ds_read_b128 v[72:75], v2 offset:17408
    v_add_u32 v19, s69, v10
    s_mov_b32 s40, s32
    v_mfma_f32_16x16x32_bf16 v[212:215], v[40:43], v[92:95], v[212:215]
    s_mov_b32 s41, s33
    s_mov_b32 s42, 2621440
    s_mov_b32 s43, 0x20000
    v_mfma_f32_16x16x32_bf16 v[220:223], v[44:47], v[92:95], v[220:223]
    ds_read_b128 v[76:79], v2 offset:23552
    v_and_b32 v8, 7, v6
    v_lshlrev_b32 v8, 6, v8
    v_mfma_f32_16x16x32_bf16 v[216:219], v[44:47], v[88:91], v[216:219]
    v_lshrrev_b32 v7, 3, v6
    v_add_u32 v8, v8, v7
    s_waitcnt lgkmcnt(6)
    v_mfma_f32_16x16x32_bf16 v[224:227], v[48:51], v[88:91], v[224:227]
    ds_read_b128 v[32:35], v2 offset:24576
    v_mul_u32_u24 v8, 1280, v8
    v_lshl_add_u32 v7, v3, 3, v8
    v_mfma_f32_16x16x32_bf16 v[228:231], v[48:51], v[92:95], v[228:231]
    buffer_load_dwordx4 v[112:115], v2, s[56:59], s76 offen offset:0 sc1
    v_lshl_add_u32 v8, v3, 4, v8
    v_mov_b32 v13, 161024
    v_lshl_add_u32 v12, v3, 5, v13
    v_mfma_f32_16x16x32_bf16 v[236:239], v[52:55], v[92:95], v[236:239]
    ds_read_b128 v[36:39], v2 offset:30720
    v_lshl_add_u32 v13, v3, 4, v13
    v_mfma_f32_16x16x32_bf16 v[232:235], v[52:55], v[88:91], v[232:235]
    s_waitcnt lgkmcnt(6)
    v_mfma_f32_16x16x32_bf16 v[240:243], v[56:59], v[88:91], v[240:243]
    ds_read_b128 v[40:43], v2 offset:25600
    v_mfma_f32_16x16x32_bf16 v[244:247], v[56:59], v[92:95], v[244:247]
    v_mfma_f32_16x16x32_bf16 v[252:255], v[60:63], v[92:95], v[252:255]
    ds_read_b128 v[44:47], v2 offset:31744
    v_mfma_f32_16x16x32_bf16 v[248:251], v[60:63], v[88:91], v[248:251]
    s_waitcnt lgkmcnt(6)
    v_mfma_f32_16x16x32_bf16 v[160:163], v[64:67], v[88:91], v[160:163]
    ds_read_b128 v[48:51], v2 offset:26624
    v_mfma_f32_16x16x32_bf16 v[164:167], v[64:67], v[92:95], v[164:167]
    buffer_load_dwordx4 v[116:119], v20, s[56:59], s76 offen offset:0 sc1
    v_mfma_f32_16x16x32_bf16 v[172:175], v[68:71], v[92:95], v[172:175]
    ds_read_b128 v[52:55], v2 offset:32768
    v_mfma_f32_16x16x32_bf16 v[168:171], v[68:71], v[88:91], v[168:171]
    s_waitcnt lgkmcnt(6)
    v_mfma_f32_16x16x32_bf16 v[176:179], v[72:75], v[88:91], v[176:179]
    ds_read_b128 v[56:59], v2 offset:27648
    v_mfma_f32_16x16x32_bf16 v[180:183], v[72:75], v[92:95], v[180:183]
    v_mfma_f32_16x16x32_bf16 v[188:191], v[76:79], v[92:95], v[188:191]
    ds_read_b128 v[60:63], v2 offset:33792
    v_mfma_f32_16x16x32_bf16 v[184:187], v[76:79], v[88:91], v[184:187]
    s_waitcnt lgkmcnt(6)
    s_waitcnt vmcnt(4)
    v_mfma_f32_16x16x32_bf16 v[192:195], v[32:35], v[96:99], v[192:195]
    ds_read_b128 v[64:67], v2 offset:28672
    v_mfma_f32_16x16x32_bf16 v[196:199], v[32:35], v[100:103], v[196:199]
    buffer_load_dwordx4 v[120:123], v2, s[56:59], s76 offen offset:1024 sc1
    v_mfma_f32_16x16x32_bf16 v[204:207], v[36:39], v[100:103], v[204:207]
    ds_read_b128 v[68:71], v2 offset:34816
    v_mfma_f32_16x16x32_bf16 v[200:203], v[36:39], v[96:99], v[200:203]
    s_waitcnt lgkmcnt(6)
    v_mfma_f32_16x16x32_bf16 v[208:211], v[40:43], v[96:99], v[208:211]
    ds_read_b128 v[72:75], v2 offset:29696
    v_mfma_f32_16x16x32_bf16 v[212:215], v[40:43], v[100:103], v[212:215]
    s_add_u32 m0, s39, 73728
    s_nop 0
    buffer_load_dwordx4 v2, s[56:59], s62 offen offset:0 sc1 lds
    v_mfma_f32_16x16x32_bf16 v[220:223], v[44:47], v[100:103], v[220:223]
    ds_read_b128 v[76:79], v2 offset:35840
    v_mfma_f32_16x16x32_bf16 v[216:219], v[44:47], v[96:99], v[216:219]
    s_waitcnt lgkmcnt(6)
    v_mfma_f32_16x16x32_bf16 v[224:227], v[48:51], v[96:99], v[224:227]
    ds_read_b128 v[32:35], v2 offset:36864
    v_mfma_f32_16x16x32_bf16 v[228:231], v[48:51], v[100:103], v[228:231]
    buffer_load_dwordx4 v2, s[56:59], s62 offen offset:1024 sc1 lds
    v_mfma_f32_16x16x32_bf16 v[236:239], v[52:55], v[100:103], v[236:239]
    ds_read_b128 v[36:39], v2 offset:43008
    v_mfma_f32_16x16x32_bf16 v[232:235], v[52:55], v[96:99], v[232:235]
    s_waitcnt lgkmcnt(6)
    v_mfma_f32_16x16x32_bf16 v[240:243], v[56:59], v[96:99], v[240:243]
    ds_read_b128 v[40:43], v2 offset:37888
    v_mfma_f32_16x16x32_bf16 v[244:247], v[56:59], v[100:103], v[244:247]
    buffer_load_dwordx4 v[124:127], v20, s[56:59], s76 offen offset:1024 sc1
    v_mfma_f32_16x16x32_bf16 v[252:255], v[60:63], v[100:103], v[252:255]
    ds_read_b128 v[44:47], v2 offset:44032
    v_mfma_f32_16x16x32_bf16 v[248:251], v[60:63], v[96:99], v[248:251]
    s_waitcnt lgkmcnt(6)
    v_mfma_f32_16x16x32_bf16 v[160:163], v[64:67], v[96:99], v[160:163]
    ds_read_b128 v[48:51], v2 offset:38912
    v_mfma_f32_16x16x32_bf16 v[164:167], v[64:67], v[100:103], v[164:167]
    buffer_load_dwordx4 v2, s[56:59], s62 offen offset:2048 sc1 lds
    s_add_u32 s62, s62, 12288
    v_mfma_f32_16x16x32_bf16 v[172:175], v[68:71], v[100:103], v[172:175]
    ds_read_b128 v[52:55], v2 offset:45056
    v_mfma_f32_16x16x32_bf16 v[168:171], v[68:71], v[96:99], v[168:171]
    s_waitcnt lgkmcnt(6)
    v_mfma_f32_16x16x32_bf16 v[176:179], v[72:75], v[96:99], v[176:179]
    ds_read_b128 v[56:59], v2 offset:39936
    v_mfma_f32_16x16x32_bf16 v[180:183], v[72:75], v[100:103], v[180:183]
    s_add_u32 m0, s39, 86016
    s_nop 0
    buffer_load_dwordx4 v2, s[56:59], s62 offen offset:0 sc1 lds
    v_mfma_f32_16x16x32_bf16 v[188:191], v[76:79], v[100:103], v[188:191]
    ds_read_b128 v[60:63], v2 offset:46080
    v_mfma_f32_16x16x32_bf16 v[184:187], v[76:79], v[96:99], v[184:187]
    s_waitcnt lgkmcnt(6)
    s_waitcnt vmcnt(8)
    v_mfma_f32_16x16x32_bf16 v[192:195], v[32:35], v[104:107], v[192:195]
    ds_read_b128 v[64:67], v2 offset:40960
    v_mfma_f32_16x16x32_bf16 v[196:199], v[32:35], v[108:111], v[196:199]
    buffer_load_dwordx4 v[128:131], v2, s[56:59], s76 offen offset:2048 sc1
    v_mfma_f32_16x16x32_bf16 v[204:207], v[36:39], v[108:111], v[204:207]
    ds_read_b128 v[68:71], v2 offset:47104
    v_mfma_f32_16x16x32_bf16 v[200:203], v[36:39], v[104:107], v[200:203]
    s_waitcnt lgkmcnt(6)
    v_mfma_f32_16x16x32_bf16 v[208:211], v[40:43], v[104:107], v[208:211]
    ds_read_b128 v[72:75], v2 offset:41984
    buffer_load_dwordx4 v2, s[56:59], s62 offen offset:1024 sc1 lds
    v_mfma_f32_16x16x32_bf16 v[212:215], v[40:43], v[108:111], v[212:215]
    v_mfma_f32_16x16x32_bf16 v[220:223], v[44:47], v[108:111], v[220:223]
    ds_read_b128 v[76:79], v2 offset:48128
    v_mfma_f32_16x16x32_bf16 v[216:219], v[44:47], v[104:107], v[216:219]
    buffer_load_dwordx4 v2, s[56:59], s62 offen offset:2048 sc1 lds
    s_add_u32 s62, s62, 12288
    s_waitcnt lgkmcnt(6)
    v_mfma_f32_16x16x32_bf16 v[224:227], v[48:51], v[104:107], v[224:227]
    ds_read_b128 v[32:35], v2 offset:49152
    v_mfma_f32_16x16x32_bf16 v[228:231], v[48:51], v[108:111], v[228:231]
    v_mfma_f32_16x16x32_bf16 v[236:239], v[52:55], v[108:111], v[236:239]
    ds_read_b128 v[36:39], v2 offset:55296
    v_mfma_f32_16x16x32_bf16 v[232:235], v[52:55], v[104:107], v[232:235]
    buffer_load_dwordx4 v[132:135], v20, s[56:59], s76 offen offset:2048 sc1
    s_waitcnt lgkmcnt(6)
    v_mfma_f32_16x16x32_bf16 v[240:243], v[56:59], v[104:107], v[240:243]
    ds_read_b128 v[40:43], v2 offset:50176
    v_mfma_f32_16x16x32_bf16 v[244:247], v[56:59], v[108:111], v[244:247]
    v_mfma_f32_16x16x32_bf16 v[252:255], v[60:63], v[108:111], v[252:255]
    ds_read_b128 v[44:47], v2 offset:56320
    s_add_u32 m0, s39, 98304
    s_nop 0
    buffer_load_dwordx4 v2, s[56:59], s62 offen offset:0 sc1 lds
    v_mfma_f32_16x16x32_bf16 v[248:251], v[60:63], v[104:107], v[248:251]
    s_waitcnt lgkmcnt(6)
    v_mfma_f32_16x16x32_bf16 v[160:163], v[64:67], v[104:107], v[160:163]
    ds_read_b128 v[48:51], v2 offset:51200
    v_mfma_f32_16x16x32_bf16 v[164:167], v[64:67], v[108:111], v[164:167]
    v_mfma_f32_16x16x32_bf16 v[172:175], v[68:71], v[108:111], v[172:175]
    ds_read_b128 v[52:55], v2 offset:57344
    buffer_load_dwordx4 v2, s[56:59], s62 offen offset:1024 sc1 lds
    v_mfma_f32_16x16x32_bf16 v[168:171], v[68:71], v[104:107], v[168:171]
    s_waitcnt lgkmcnt(6)
    v_mfma_f32_16x16x32_bf16 v[176:179], v[72:75], v[104:107], v[176:179]
    ds_read_b128 v[56:59], v2 offset:52224
    v_mfma_f32_16x16x32_bf16 v[180:183], v[72:75], v[108:111], v[180:183]
    buffer_load_dwordx4 v[136:139], v2, s[56:59], s76 offen offset:3072 sc1
    v_mfma_f32_16x16x32_bf16 v[188:191], v[76:79], v[108:111], v[188:191]
    ds_read_b128 v[60:63], v2 offset:58368
    v_mfma_f32_16x16x32_bf16 v[184:187], v[76:79], v[104:107], v[184:187]
    s_waitcnt lgkmcnt(6)
    s_waitcnt vmcnt(13)
    v_mfma_f32_16x16x32_bf16 v[192:195], v[32:35], v[112:115], v[192:195]
    ds_read_b128 v[64:67], v2 offset:53248
    v_mfma_f32_16x16x32_bf16 v[196:199], v[32:35], v[116:119], v[196:199]
    buffer_load_dwordx4 v[140:143], v20, s[56:59], s76 offen offset:3072 sc1
    s_add_u32 s76, s76, 4096
    v_mfma_f32_16x16x32_bf16 v[204:207], v[36:39], v[116:119], v[204:207]
    ds_read_b128 v[68:71], v2 offset:59392
    v_mfma_f32_16x16x32_bf16 v[200:203], v[36:39], v[112:115], v[200:203]
    s_waitcnt lgkmcnt(6)
    v_mfma_f32_16x16x32_bf16 v[208:211], v[40:43], v[112:115], v[208:211]
    ds_read_b128 v[72:75], v2 offset:54272
    v_mfma_f32_16x16x32_bf16 v[212:215], v[40:43], v[116:119], v[212:215]
    buffer_load_dwordx4 v2, s[56:59], s62 offen offset:2048 sc1 lds
    s_add_u32 s62, s62, 12288
    v_mfma_f32_16x16x32_bf16 v[220:223], v[44:47], v[116:119], v[220:223]
    ds_read_b128 v[76:79], v2 offset:60416
    v_mfma_f32_16x16x32_bf16 v[216:219], v[44:47], v[112:115], v[216:219]
    s_waitcnt lgkmcnt(6)
    v_mfma_f32_16x16x32_bf16 v[224:227], v[48:51], v[112:115], v[224:227]
    ds_read_b128 v[32:35], v21 offset:0
    v_mfma_f32_16x16x32_bf16 v[228:231], v[48:51], v[116:119], v[228:231]
    s_add_u32 m0, s39, 110592
    s_nop 0
    buffer_load_dwordx4 v2, s[56:59], s62 offen offset:0 sc1 lds
    v_mfma_f32_16x16x32_bf16 v[236:239], v[52:55], v[116:119], v[236:239]
    ds_read_b128 v[36:39], v21 offset:6144
    v_mfma_f32_16x16x32_bf16 v[232:235], v[52:55], v[112:115], v[232:235]
    s_waitcnt lgkmcnt(6)
    v_mfma_f32_16x16x32_bf16 v[240:243], v[56:59], v[112:115], v[240:243]
    ds_read_b128 v[40:43], v21 offset:1024
    v_mfma_f32_16x16x32_bf16 v[244:247], v[56:59], v[116:119], v[244:247]
    buffer_load_dwordx4 v[144:147], v2, s[56:59], s76 offen offset:0 sc1
    v_mfma_f32_16x16x32_bf16 v[252:255], v[60:63], v[116:119], v[252:255]
    ds_read_b128 v[44:47], v21 offset:7168
    v_mfma_f32_16x16x32_bf16 v[248:251], v[60:63], v[112:115], v[248:251]
    s_waitcnt lgkmcnt(6)
    v_mfma_f32_16x16x32_bf16 v[160:163], v[64:67], v[112:115], v[160:163]
    ds_read_b128 v[48:51], v21 offset:2048
    v_mfma_f32_16x16x32_bf16 v[164:167], v[64:67], v[116:119], v[164:167]
    buffer_load_dwordx4 v2, s[56:59], s62 offen offset:1024 sc1 lds
    v_mfma_f32_16x16x32_bf16 v[172:175], v[68:71], v[116:119], v[172:175]
    ds_read_b128 v[52:55], v21 offset:8192
    v_mfma_f32_16x16x32_bf16 v[168:171], v[68:71], v[112:115], v[168:171]
    s_waitcnt lgkmcnt(6)
    v_mfma_f32_16x16x32_bf16 v[176:179], v[72:75], v[112:115], v[176:179]
    ds_read_b128 v[56:59], v21 offset:3072
    v_mfma_f32_16x16x32_bf16 v[180:183], v[72:75], v[116:119], v[180:183]
    buffer_load_dwordx4 v2, s[56:59], s62 offen offset:2048 sc1 lds
    s_add_u32 s62, s62, 12288
    v_mfma_f32_16x16x32_bf16 v[188:191], v[76:79], v[116:119], v[188:191]
    ds_read_b128 v[60:63], v21 offset:9216
    v_mfma_f32_16x16x32_bf16 v[184:187], v[76:79], v[112:115], v[184:187]
    s_waitcnt vmcnt(14)
    s_barrier
    s_waitcnt lgkmcnt(6)
    v_mfma_f32_16x16x32_bf16 v[192:195], v[32:35], v[120:123], v[192:195]
    ds_read_b128 v[64:67], v21 offset:4096
    v_mfma_f32_16x16x32_bf16 v[196:199], v[32:35], v[124:127], v[196:199]
    buffer_load_dwordx4 v[148:151], v20, s[56:59], s76 offen offset:0 sc1
    v_mfma_f32_16x16x32_bf16 v[204:207], v[36:39], v[124:127], v[204:207]
    ds_read_b128 v[68:71], v21 offset:10240
    v_mfma_f32_16x16x32_bf16 v[200:203], v[36:39], v[120:123], v[200:203]
    s_waitcnt lgkmcnt(6)
    v_mfma_f32_16x16x32_bf16 v[208:211], v[40:43], v[120:123], v[208:211]
    ds_read_b128 v[72:75], v21 offset:5120
    s_add_u32 m0, s39, 122880
    s_nop 0
    buffer_load_dwordx4 v2, s[56:59], s62 offen offset:0 sc1 lds
    v_mfma_f32_16x16x32_bf16 v[212:215], v[40:43], v[124:127], v[212:215]
    v_mfma_f32_16x16x32_bf16 v[220:223], v[44:47], v[124:127], v[220:223]
    ds_read_b128 v[76:79], v21 offset:11264
    v_mfma_f32_16x16x32_bf16 v[216:219], v[44:47], v[120:123], v[216:219]
    buffer_load_dwordx4 v2, s[56:59], s62 offen offset:1024 sc1 lds
    s_waitcnt lgkmcnt(6)
    v_mfma_f32_16x16x32_bf16 v[224:227], v[48:51], v[120:123], v[224:227]
    ds_read_b128 v[32:35], v21 offset:12288
    v_mfma_f32_16x16x32_bf16 v[228:231], v[48:51], v[124:127], v[228:231]
    v_mfma_f32_16x16x32_bf16 v[236:239], v[52:55], v[124:127], v[236:239]
    ds_read_b128 v[36:39], v21 offset:18432
    v_mfma_f32_16x16x32_bf16 v[232:235], v[52:55], v[120:123], v[232:235]
    buffer_load_dwordx4 v[152:155], v2, s[56:59], s76 offen offset:1024 sc1
    s_waitcnt lgkmcnt(6)
    v_mfma_f32_16x16x32_bf16 v[240:243], v[56:59], v[120:123], v[240:243]
    ds_read_b128 v[40:43], v21 offset:13312
    v_mfma_f32_16x16x32_bf16 v[244:247], v[56:59], v[124:127], v[244:247]
    v_mfma_f32_16x16x32_bf16 v[252:255], v[60:63], v[124:127], v[252:255]
    ds_read_b128 v[44:47], v21 offset:19456
    buffer_load_dwordx4 v2, s[56:59], s62 offen offset:2048 sc1 lds
    s_add_u32 s62, s62, 12288
    v_mfma_f32_16x16x32_bf16 v[248:251], v[60:63], v[120:123], v[248:251]
    s_waitcnt lgkmcnt(6)
    v_mfma_f32_16x16x32_bf16 v[160:163], v[64:67], v[120:123], v[160:163]
    ds_read_b128 v[48:51], v21 offset:14336
    v_mfma_f32_16x16x32_bf16 v[164:167], v[64:67], v[124:127], v[164:167]
    v_mfma_f32_16x16x32_bf16 v[172:175], v[68:71], v[124:127], v[172:175]
    ds_read_b128 v[52:55], v21 offset:20480
    s_add_u32 m0, s39, 135168
    s_nop 0
    buffer_load_dwordx4 v2, s[56:59], s62 offen offset:0 sc1 lds
    v_mfma_f32_16x16x32_bf16 v[168:171], v[68:71], v[120:123], v[168:171]
    s_waitcnt lgkmcnt(6)
    v_mfma_f32_16x16x32_bf16 v[176:179], v[72:75], v[120:123], v[176:179]
    ds_read_b128 v[56:59], v21 offset:15360
    v_mfma_f32_16x16x32_bf16 v[180:183], v[72:75], v[124:127], v[180:183]
    buffer_load_dwordx4 v[156:159], v20, s[56:59], s76 offen offset:1024 sc1
    v_mfma_f32_16x16x32_bf16 v[188:191], v[76:79], v[124:127], v[188:191]
    ds_read_b128 v[60:63], v21 offset:21504
    v_mfma_f32_16x16x32_bf16 v[184:187], v[76:79], v[120:123], v[184:187]
    s_waitcnt vmcnt(17)
    s_barrier
    s_waitcnt lgkmcnt(6)
    s_waitcnt vmcnt(16)
    v_mfma_f32_16x16x32_bf16 v[192:195], v[32:35], v[128:131], v[192:195]
    ds_read_b128 v[64:67], v21 offset:16384
    v_mfma_f32_16x16x32_bf16 v[196:199], v[32:35], v[132:135], v[196:199]
    buffer_load_dwordx4 v[80:83], v2, s[56:59], s76 offen offset:2048 sc1
    v_mfma_f32_16x16x32_bf16 v[204:207], v[36:39], v[132:135], v[204:207]
    ds_read_b128 v[68:71], v21 offset:22528
    v_mfma_f32_16x16x32_bf16 v[200:203], v[36:39], v[128:131], v[200:203]
    s_waitcnt lgkmcnt(6)
    v_mfma_f32_16x16x32_bf16 v[208:211], v[40:43], v[128:131], v[208:211]
    ds_read_b128 v[72:75], v21 offset:17408
    v_mfma_f32_16x16x32_bf16 v[212:215], v[40:43], v[132:135], v[212:215]
    buffer_load_dwordx4 v2, s[56:59], s62 offen offset:1024 sc1 lds
    v_mfma_f32_16x16x32_bf16 v[220:223], v[44:47], v[132:135], v[220:223]
    ds_read_b128 v[76:79], v21 offset:23552
    v_mfma_f32_16x16x32_bf16 v[216:219], v[44:47], v[128:131], v[216:219]
    s_waitcnt lgkmcnt(6)
    v_mfma_f32_16x16x32_bf16 v[224:227], v[48:51], v[128:131], v[224:227]
    ds_read_b128 v[32:35], v21 offset:24576
    v_mfma_f32_16x16x32_bf16 v[228:231], v[48:51], v[132:135], v[228:231]
    buffer_load_dwordx4 v2, s[56:59], s62 offen offset:2048 sc1 lds
    s_add_u32 s62, s62, 12288
    v_mfma_f32_16x16x32_bf16 v[236:239], v[52:55], v[132:135], v[236:239]
    ds_read_b128 v[36:39], v21 offset:30720
    v_mfma_f32_16x16x32_bf16 v[232:235], v[52:55], v[128:131], v[232:235]
    s_waitcnt lgkmcnt(6)
    v_mfma_f32_16x16x32_bf16 v[240:243], v[56:59], v[128:131], v[240:243]
    ds_read_b128 v[40:43], v21 offset:25600
    v_mfma_f32_16x16x32_bf16 v[244:247], v[56:59], v[132:135], v[244:247]
    buffer_load_dwordx4 v[84:87], v20, s[56:59], s76 offen offset:2048 sc1
    v_mfma_f32_16x16x32_bf16 v[252:255], v[60:63], v[132:135], v[252:255]
    ds_read_b128 v[44:47], v21 offset:31744
    v_mfma_f32_16x16x32_bf16 v[248:251], v[60:63], v[128:131], v[248:251]
    s_waitcnt lgkmcnt(6)
    v_mfma_f32_16x16x32_bf16 v[160:163], v[64:67], v[128:131], v[160:163]
    ds_read_b128 v[48:51], v21 offset:26624
    v_mfma_f32_16x16x32_bf16 v[164:167], v[64:67], v[132:135], v[164:167]
    s_add_u32 m0, s39, 0
    s_nop 0
    buffer_load_dwordx4 v2, s[56:59], s62 offen offset:0 sc1 lds
    v_mfma_f32_16x16x32_bf16 v[172:175], v[68:71], v[132:135], v[172:175]
    ds_read_b128 v[52:55], v21 offset:32768
    v_mfma_f32_16x16x32_bf16 v[168:171], v[68:71], v[128:131], v[168:171]
    s_waitcnt lgkmcnt(6)
    v_mfma_f32_16x16x32_bf16 v[176:179], v[72:75], v[128:131], v[176:179]
    ds_read_b128 v[56:59], v21 offset:27648
    v_mfma_f32_16x16x32_bf16 v[180:183], v[72:75], v[132:135], v[180:183]
    buffer_load_dwordx4 v2, s[56:59], s62 offen offset:1024 sc1 lds
    v_mfma_f32_16x16x32_bf16 v[188:191], v[76:79], v[132:135], v[188:191]
    ds_read_b128 v[60:63], v21 offset:33792
    v_mfma_f32_16x16x32_bf16 v[184:187], v[76:79], v[128:131], v[184:187]
    s_waitcnt vmcnt(17)
    s_barrier
    s_waitcnt lgkmcnt(6)
    v_mfma_f32_16x16x32_bf16 v[192:195], v[32:35], v[136:139], v[192:195]
    ds_read_b128 v[64:67], v21 offset:28672
    v_mfma_f32_16x16x32_bf16 v[196:199], v[32:35], v[140:143], v[196:199]
    buffer_load_dwordx4 v[88:91], v2, s[56:59], s76 offen offset:3072 sc1
    v_mfma_f32_16x16x32_bf16 v[204:207], v[36:39], v[140:143], v[204:207]
    ds_read_b128 v[68:71], v21 offset:34816
    v_mfma_f32_16x16x32_bf16 v[200:203], v[36:39], v[136:139], v[200:203]
    s_waitcnt lgkmcnt(6)
    v_mfma_f32_16x16x32_bf16 v[208:211], v[40:43], v[136:139], v[208:211]
    ds_read_b128 v[72:75], v21 offset:29696
    v_mfma_f32_16x16x32_bf16 v[212:215], v[40:43], v[140:143], v[212:215]
    buffer_load_dwordx4 v2, s[56:59], s62 offen offset:2048 sc1 lds
    s_add_u32 s62, s62, 12288
    v_mfma_f32_16x16x32_bf16 v[220:223], v[44:47], v[140:143], v[220:223]
    ds_read_b128 v[76:79], v21 offset:35840
    v_mfma_f32_16x16x32_bf16 v[216:219], v[44:47], v[136:139], v[216:219]
    s_waitcnt lgkmcnt(6)
    v_mfma_f32_16x16x32_bf16 v[224:227], v[48:51], v[136:139], v[224:227]
    ds_read_b128 v[32:35], v21 offset:36864
    v_mfma_f32_16x16x32_bf16 v[228:231], v[48:51], v[140:143], v[228:231]
    s_add_u32 m0, s39, 12288
    s_nop 0
    buffer_load_dwordx4 v2, s[56:59], s62 offen offset:0 sc1 lds
    v_mfma_f32_16x16x32_bf16 v[236:239], v[52:55], v[140:143], v[236:239]
    ds_read_b128 v[36:39], v21 offset:43008
    v_mfma_f32_16x16x32_bf16 v[232:235], v[52:55], v[136:139], v[232:235]
    s_waitcnt lgkmcnt(6)
    v_mfma_f32_16x16x32_bf16 v[240:243], v[56:59], v[136:139], v[240:243]
    ds_read_b128 v[40:43], v21 offset:37888
    v_mfma_f32_16x16x32_bf16 v[244:247], v[56:59], v[140:143], v[244:247]
    buffer_load_dwordx4 v[92:95], v20, s[56:59], s76 offen offset:3072 sc1
    s_add_u32 s76, s76, 4096
    v_mfma_f32_16x16x32_bf16 v[252:255], v[60:63], v[140:143], v[252:255]
    ds_read_b128 v[44:47], v21 offset:44032
    v_mfma_f32_16x16x32_bf16 v[248:251], v[60:63], v[136:139], v[248:251]
    s_waitcnt lgkmcnt(6)
    v_mfma_f32_16x16x32_bf16 v[160:163], v[64:67], v[136:139], v[160:163]
    ds_read_b128 v[48:51], v21 offset:38912
    v_mfma_f32_16x16x32_bf16 v[164:167], v[64:67], v[140:143], v[164:167]
    buffer_load_dwordx4 v2, s[56:59], s62 offen offset:1024 sc1 lds
    v_mfma_f32_16x16x32_bf16 v[172:175], v[68:71], v[140:143], v[172:175]
    ds_read_b128 v[52:55], v21 offset:45056
    v_mfma_f32_16x16x32_bf16 v[168:171], v[68:71], v[136:139], v[168:171]
    s_waitcnt lgkmcnt(6)
    v_mfma_f32_16x16x32_bf16 v[176:179], v[72:75], v[136:139], v[176:179]
    ds_read_b128 v[56:59], v21 offset:39936
    v_mfma_f32_16x16x32_bf16 v[180:183], v[72:75], v[140:143], v[180:183]
    buffer_load_dwordx4 v[96:99], v2, s[56:59], s76 offen offset:0 sc1
    v_mfma_f32_16x16x32_bf16 v[188:191], v[76:79], v[140:143], v[188:191]
    ds_read_b128 v[60:63], v21 offset:46080
    v_mfma_f32_16x16x32_bf16 v[184:187], v[76:79], v[136:139], v[184:187]
    s_waitcnt vmcnt(19)
    s_barrier
    s_waitcnt lgkmcnt(6)
    s_waitcnt vmcnt(18)
    v_mfma_f32_16x16x32_bf16 v[192:195], v[32:35], v[144:147], v[192:195]
    ds_read_b128 v[64:67], v21 offset:40960
    v_mfma_f32_16x16x32_bf16 v[196:199], v[32:35], v[148:151], v[196:199]
    buffer_load_dwordx4 v[100:103], v20, s[56:59], s76 offen offset:0 sc1
    v_mfma_f32_16x16x32_bf16 v[204:207], v[36:39], v[148:151], v[204:207]
    ds_read_b128 v[68:71], v21 offset:47104
    v_mfma_f32_16x16x32_bf16 v[200:203], v[36:39], v[144:147], v[200:203]
    s_waitcnt lgkmcnt(6)
    v_mfma_f32_16x16x32_bf16 v[208:211], v[40:43], v[144:147], v[208:211]
    ds_read_b128 v[72:75], v21 offset:41984
    buffer_load_dwordx4 v2, s[56:59], s62 offen offset:2048 sc1 lds
    s_add_u32 s62, s62, 12288
    v_mfma_f32_16x16x32_bf16 v[212:215], v[40:43], v[148:151], v[212:215]
    v_mfma_f32_16x16x32_bf16 v[220:223], v[44:47], v[148:151], v[220:223]
    ds_read_b128 v[76:79], v21 offset:48128
    v_mfma_f32_16x16x32_bf16 v[216:219], v[44:47], v[144:147], v[216:219]
    s_add_u32 m0, s39, 24576
    s_nop 0
    buffer_load_dwordx4 v2, s[56:59], s62 offen offset:0 sc1 lds
    s_waitcnt lgkmcnt(6)
    v_mfma_f32_16x16x32_bf16 v[224:227], v[48:51], v[144:147], v[224:227]
    ds_read_b128 v[32:35], v21 offset:49152
    v_mfma_f32_16x16x32_bf16 v[228:231], v[48:51], v[148:151], v[228:231]
    v_mfma_f32_16x16x32_bf16 v[236:239], v[52:55], v[148:151], v[236:239]
    ds_read_b128 v[36:39], v21 offset:55296
    v_mfma_f32_16x16x32_bf16 v[232:235], v[52:55], v[144:147], v[232:235]
    buffer_load_dwordx4 v[104:107], v2, s[56:59], s76 offen offset:1024 sc1
    s_waitcnt lgkmcnt(6)
    v_mfma_f32_16x16x32_bf16 v[240:243], v[56:59], v[144:147], v[240:243]
    ds_read_b128 v[40:43], v21 offset:50176
    v_mfma_f32_16x16x32_bf16 v[244:247], v[56:59], v[148:151], v[244:247]
    v_mfma_f32_16x16x32_bf16 v[252:255], v[60:63], v[148:151], v[252:255]
    ds_read_b128 v[44:47], v21 offset:56320
    buffer_load_dwordx4 v2, s[56:59], s62 offen offset:1024 sc1 lds
    v_mfma_f32_16x16x32_bf16 v[248:251], v[60:63], v[144:147], v[248:251]
    s_waitcnt lgkmcnt(6)
    v_mfma_f32_16x16x32_bf16 v[160:163], v[64:67], v[144:147], v[160:163]
    ds_read_b128 v[48:51], v21 offset:51200
    v_mfma_f32_16x16x32_bf16 v[164:167], v[64:67], v[148:151], v[164:167]
    v_mfma_f32_16x16x32_bf16 v[172:175], v[68:71], v[148:151], v[172:175]
    ds_read_b128 v[52:55], v21 offset:57344
    buffer_load_dwordx4 v2, s[56:59], s62 offen offset:2048 sc1 lds
    s_add_u32 s62, s62, 12288
    v_mfma_f32_16x16x32_bf16 v[168:171], v[68:71], v[144:147], v[168:171]
    s_waitcnt lgkmcnt(6)
    v_mfma_f32_16x16x32_bf16 v[176:179], v[72:75], v[144:147], v[176:179]
    ds_read_b128 v[56:59], v21 offset:52224
    v_mfma_f32_16x16x32_bf16 v[180:183], v[72:75], v[148:151], v[180:183]
    buffer_load_dwordx4 v[108:111], v20, s[56:59], s76 offen offset:1024 sc1
    v_mfma_f32_16x16x32_bf16 v[188:191], v[76:79], v[148:151], v[188:191]
    ds_read_b128 v[60:63], v21 offset:58368
    v_mfma_f32_16x16x32_bf16 v[184:187], v[76:79], v[144:147], v[184:187]
    s_waitcnt vmcnt(21)
    s_barrier
    s_waitcnt lgkmcnt(6)
    s_waitcnt vmcnt(19)
    v_mfma_f32_16x16x32_bf16 v[192:195], v[32:35], v[152:155], v[192:195]
    ds_read_b128 v[64:67], v21 offset:53248
    v_mfma_f32_16x16x32_bf16 v[196:199], v[32:35], v[156:159], v[196:199]
    buffer_load_dwordx4 v[112:115], v2, s[56:59], s76 offen offset:2048 sc1
    v_mfma_f32_16x16x32_bf16 v[204:207], v[36:39], v[156:159], v[204:207]
    ds_read_b128 v[68:71], v21 offset:59392
    v_mfma_f32_16x16x32_bf16 v[200:203], v[36:39], v[152:155], v[200:203]
    s_waitcnt lgkmcnt(6)
    v_mfma_f32_16x16x32_bf16 v[208:211], v[40:43], v[152:155], v[208:211]
    ds_read_b128 v[72:75], v21 offset:54272
    v_mfma_f32_16x16x32_bf16 v[212:215], v[40:43], v[156:159], v[212:215]
    s_add_u32 m0, s39, 36864
    s_nop 0
    buffer_load_dwordx4 v2, s[56:59], s62 offen offset:0 sc1 lds
    v_mfma_f32_16x16x32_bf16 v[220:223], v[44:47], v[156:159], v[220:223]
    ds_read_b128 v[76:79], v21 offset:60416
    v_mfma_f32_16x16x32_bf16 v[216:219], v[44:47], v[152:155], v[216:219]
    s_waitcnt lgkmcnt(6)
    v_mfma_f32_16x16x32_bf16 v[224:227], v[48:51], v[152:155], v[224:227]
    ds_read_b128 v[32:35], v22 offset:0
    v_mfma_f32_16x16x32_bf16 v[228:231], v[48:51], v[156:159], v[228:231]
    buffer_load_dwordx4 v2, s[56:59], s62 offen offset:1024 sc1 lds
    v_mfma_f32_16x16x32_bf16 v[236:239], v[52:55], v[156:159], v[236:239]
    ds_read_b128 v[36:39], v22 offset:6144
    v_mfma_f32_16x16x32_bf16 v[232:235], v[52:55], v[152:155], v[232:235]
    s_waitcnt lgkmcnt(6)
    v_mfma_f32_16x16x32_bf16 v[240:243], v[56:59], v[152:155], v[240:243]
    ds_read_b128 v[40:43], v22 offset:1024
    v_mfma_f32_16x16x32_bf16 v[244:247], v[56:59], v[156:159], v[244:247]
    buffer_load_dwordx4 v[116:119], v20, s[56:59], s76 offen offset:2048 sc1
    v_mfma_f32_16x16x32_bf16 v[252:255], v[60:63], v[156:159], v[252:255]
    ds_read_b128 v[44:47], v22 offset:7168
    v_mfma_f32_16x16x32_bf16 v[248:251], v[60:63], v[152:155], v[248:251]
    s_waitcnt lgkmcnt(6)
    v_mfma_f32_16x16x32_bf16 v[160:163], v[64:67], v[152:155], v[160:163]
    ds_read_b128 v[48:51], v22 offset:2048
    v_mfma_f32_16x16x32_bf16 v[164:167], v[64:67], v[156:159], v[164:167]
    buffer_load_dwordx4 v2, s[56:59], s62 offen offset:2048 sc1 lds
    s_add_u32 s62, s62, 12288
    v_mfma_f32_16x16x32_bf16 v[172:175], v[68:71], v[156:159], v[172:175]
    ds_read_b128 v[52:55], v22 offset:8192
    v_mfma_f32_16x16x32_bf16 v[168:171], v[68:71], v[152:155], v[168:171]
    s_waitcnt lgkmcnt(6)
    v_mfma_f32_16x16x32_bf16 v[176:179], v[72:75], v[152:155], v[176:179]
    ds_read_b128 v[56:59], v22 offset:3072
    v_mfma_f32_16x16x32_bf16 v[180:183], v[72:75], v[156:159], v[180:183]
    s_add_u32 m0, s39, 49152
    s_nop 0
    buffer_load_dwordx4 v2, s[56:59], s62 offen offset:0 sc1 lds
    v_mfma_f32_16x16x32_bf16 v[188:191], v[76:79], v[156:159], v[188:191]
    ds_read_b128 v[60:63], v22 offset:9216
    v_mfma_f32_16x16x32_bf16 v[184:187], v[76:79], v[152:155], v[184:187]
    s_waitcnt vmcnt(22)
    s_barrier
    s_waitcnt lgkmcnt(6)
    s_waitcnt vmcnt(21)
    v_mfma_f32_16x16x32_bf16 v[192:195], v[32:35], v[80:83], v[192:195]
    ds_read_b128 v[64:67], v22 offset:4096
    v_mfma_f32_16x16x32_bf16 v[196:199], v[32:35], v[84:87], v[196:199]
    buffer_load_dwordx4 v[120:123], v2, s[56:59], s76 offen offset:3072 sc1
    v_mfma_f32_16x16x32_bf16 v[204:207], v[36:39], v[84:87], v[204:207]
    ds_read_b128 v[68:71], v22 offset:10240
    v_mfma_f32_16x16x32_bf16 v[200:203], v[36:39], v[80:83], v[200:203]
    s_waitcnt lgkmcnt(6)
    v_mfma_f32_16x16x32_bf16 v[208:211], v[40:43], v[80:83], v[208:211]
    ds_read_b128 v[72:75], v22 offset:5120
    buffer_load_dwordx4 v2, s[56:59], s62 offen offset:1024 sc1 lds
    v_mfma_f32_16x16x32_bf16 v[212:215], v[40:43], v[84:87], v[212:215]
    v_mfma_f32_16x16x32_bf16 v[220:223], v[44:47], v[84:87], v[220:223]
    ds_read_b128 v[76:79], v22 offset:11264
    v_mfma_f32_16x16x32_bf16 v[216:219], v[44:47], v[80:83], v[216:219]
    buffer_load_dwordx4 v2, s[56:59], s62 offen offset:2048 sc1 lds
    s_add_u32 s62, s62, 12288
    s_waitcnt lgkmcnt(6)
    v_mfma_f32_16x16x32_bf16 v[224:227], v[48:51], v[80:83], v[224:227]
    ds_read_b128 v[32:35], v22 offset:12288
    v_mfma_f32_16x16x32_bf16 v[228:231], v[48:51], v[84:87], v[228:231]
    v_mfma_f32_16x16x32_bf16 v[236:239], v[52:55], v[84:87], v[236:239]
    ds_read_b128 v[36:39], v22 offset:18432
    v_mfma_f32_16x16x32_bf16 v[232:235], v[52:55], v[80:83], v[232:235]
    buffer_load_dwordx4 v[124:127], v20, s[56:59], s76 offen offset:3072 sc1
    s_add_u32 s76, s76, 4096
    s_waitcnt lgkmcnt(6)
    v_mfma_f32_16x16x32_bf16 v[240:243], v[56:59], v[80:83], v[240:243]
    ds_read_b128 v[40:43], v22 offset:13312
    v_mfma_f32_16x16x32_bf16 v[244:247], v[56:59], v[84:87], v[244:247]
    v_mfma_f32_16x16x32_bf16 v[252:255], v[60:63], v[84:87], v[252:255]
    ds_read_b128 v[44:47], v22 offset:19456
    s_add_u32 m0, s39, 61440
    s_nop 0
    buffer_load_dwordx4 v2, s[56:59], s62 offen offset:0 sc1 lds
    v_mfma_f32_16x16x32_bf16 v[248:251], v[60:63], v[80:83], v[248:251]
    s_waitcnt lgkmcnt(6)
    v_mfma_f32_16x16x32_bf16 v[160:163], v[64:67], v[80:83], v[160:163]
    ds_read_b128 v[48:51], v22 offset:14336
    v_mfma_f32_16x16x32_bf16 v[164:167], v[64:67], v[84:87], v[164:167]
    v_mfma_f32_16x16x32_bf16 v[172:175], v[68:71], v[84:87], v[172:175]
    ds_read_b128 v[52:55], v22 offset:20480
    buffer_load_dwordx4 v2, s[56:59], s62 offen offset:1024 sc1 lds
    v_mfma_f32_16x16x32_bf16 v[168:171], v[68:71], v[80:83], v[168:171]
    s_waitcnt lgkmcnt(6)
    v_mfma_f32_16x16x32_bf16 v[176:179], v[72:75], v[80:83], v[176:179]
    ds_read_b128 v[56:59], v22 offset:15360
    v_mfma_f32_16x16x32_bf16 v[180:183], v[72:75], v[84:87], v[180:183]
    buffer_load_dwordx4 v[128:131], v2, s[56:59], s76 offen offset:0 sc1
    v_mfma_f32_16x16x32_bf16 v[188:191], v[76:79], v[84:87], v[188:191]
    ds_read_b128 v[60:63], v22 offset:21504
    v_mfma_f32_16x16x32_bf16 v[184:187], v[76:79], v[80:83], v[184:187]
    s_waitcnt vmcnt(24)
    s_barrier
    s_waitcnt lgkmcnt(6)
    s_waitcnt vmcnt(22)
    v_mfma_f32_16x16x32_bf16 v[192:195], v[32:35], v[88:91], v[192:195]
    ds_read_b128 v[64:67], v22 offset:16384
    v_mfma_f32_16x16x32_bf16 v[196:199], v[32:35], v[92:95], v[196:199]
    buffer_load_dwordx4 v[132:135], v20, s[56:59], s76 offen offset:0 sc1
    v_mfma_f32_16x16x32_bf16 v[204:207], v[36:39], v[92:95], v[204:207]
    ds_read_b128 v[68:71], v22 offset:22528
    v_mfma_f32_16x16x32_bf16 v[200:203], v[36:39], v[88:91], v[200:203]
    s_waitcnt lgkmcnt(6)
    v_mfma_f32_16x16x32_bf16 v[208:211], v[40:43], v[88:91], v[208:211]
    ds_read_b128 v[72:75], v22 offset:17408
    v_mfma_f32_16x16x32_bf16 v[212:215], v[40:43], v[92:95], v[212:215]
    buffer_load_dwordx4 v2, s[56:59], s62 offen offset:2048 sc1 lds
    s_add_u32 s62, s62, 12288
    v_mfma_f32_16x16x32_bf16 v[220:223], v[44:47], v[92:95], v[220:223]
    ds_read_b128 v[76:79], v22 offset:23552
    v_mfma_f32_16x16x32_bf16 v[216:219], v[44:47], v[88:91], v[216:219]
    s_waitcnt lgkmcnt(6)
    v_mfma_f32_16x16x32_bf16 v[224:227], v[48:51], v[88:91], v[224:227]
    ds_read_b128 v[32:35], v2 offset:0
    v_mfma_f32_16x16x32_bf16 v[228:231], v[48:51], v[92:95], v[228:231]
    s_add_u32 m0, s39, 73728
    s_nop 0
    buffer_load_dwordx4 v2, s[56:59], s62 offen offset:0 sc1 lds
    v_mfma_f32_16x16x32_bf16 v[236:239], v[52:55], v[92:95], v[236:239]
    ds_read_b128 v[36:39], v2 offset:6144
    v_mfma_f32_16x16x32_bf16 v[232:235], v[52:55], v[88:91], v[232:235]
    s_waitcnt lgkmcnt(6)
    v_mfma_f32_16x16x32_bf16 v[240:243], v[56:59], v[88:91], v[240:243]
    ds_read_b128 v[40:43], v2 offset:1024
    v_mfma_f32_16x16x32_bf16 v[244:247], v[56:59], v[92:95], v[244:247]
    buffer_load_dwordx4 v[136:139], v2, s[56:59], s76 offen offset:1024 sc1
    v_mfma_f32_16x16x32_bf16 v[252:255], v[60:63], v[92:95], v[252:255]
    ds_read_b128 v[44:47], v2 offset:7168
    v_mfma_f32_16x16x32_bf16 v[248:251], v[60:63], v[88:91], v[248:251]
    s_waitcnt lgkmcnt(6)
    v_mfma_f32_16x16x32_bf16 v[160:163], v[64:67], v[88:91], v[160:163]
    ds_read_b128 v[48:51], v2 offset:2048
    v_mfma_f32_16x16x32_bf16 v[164:167], v[64:67], v[92:95], v[164:167]
    buffer_load_dwordx4 v2, s[56:59], s62 offen offset:1024 sc1 lds
    v_mfma_f32_16x16x32_bf16 v[172:175], v[68:71], v[92:95], v[172:175]
    ds_read_b128 v[52:55], v2 offset:8192
    v_mfma_f32_16x16x32_bf16 v[168:171], v[68:71], v[88:91], v[168:171]
    s_waitcnt lgkmcnt(6)
    v_mfma_f32_16x16x32_bf16 v[176:179], v[72:75], v[88:91], v[176:179]
    ds_read_b128 v[56:59], v2 offset:3072
    v_mfma_f32_16x16x32_bf16 v[180:183], v[72:75], v[92:95], v[180:183]
    buffer_load_dwordx4 v2, s[56:59], s62 offen offset:2048 sc1 lds
    s_add_u32 s62, s62, 12288
    v_mfma_f32_16x16x32_bf16 v[188:191], v[76:79], v[92:95], v[188:191]
    ds_read_b128 v[60:63], v2 offset:9216
    v_mfma_f32_16x16x32_bf16 v[184:187], v[76:79], v[88:91], v[184:187]
    s_waitcnt vmcnt(20)
    s_barrier
    s_waitcnt lgkmcnt(6)
    v_mfma_f32_16x16x32_bf16 v[192:195], v[32:35], v[96:99], v[192:195]
    ds_read_b128 v[64:67], v2 offset:4096
    v_mfma_f32_16x16x32_bf16 v[196:199], v[32:35], v[100:103], v[196:199]
    buffer_load_dwordx4 v[140:143], v20, s[56:59], s76 offen offset:1024 sc1
    v_mfma_f32_16x16x32_bf16 v[204:207], v[36:39], v[100:103], v[204:207]
    ds_read_b128 v[68:71], v2 offset:10240
    v_mfma_f32_16x16x32_bf16 v[200:203], v[36:39], v[96:99], v[200:203]
    s_waitcnt lgkmcnt(6)
    v_mfma_f32_16x16x32_bf16 v[208:211], v[40:43], v[96:99], v[208:211]
    ds_read_b128 v[72:75], v2 offset:5120
    v_mfma_f32_16x16x32_bf16 v[212:215], v[40:43], v[100:103], v[212:215]
    s_add_u32 m0, s39, 86016
    s_nop 0
    buffer_load_dwordx4 v2, s[56:59], s62 offen offset:0 sc1 lds
    v_mfma_f32_16x16x32_bf16 v[220:223], v[44:47], v[100:103], v[220:223]
    ds_read_b128 v[76:79], v2 offset:11264
    v_mfma_f32_16x16x32_bf16 v[216:219], v[44:47], v[96:99], v[216:219]
    s_waitcnt lgkmcnt(6)
    v_mfma_f32_16x16x32_bf16 v[224:227], v[48:51], v[96:99], v[224:227]
    ds_read_b128 v[32:35], v2 offset:16384
    v_mfma_f32_16x16x32_bf16 v[228:231], v[48:51], v[100:103], v[228:231]
    buffer_load_dwordx4 v2, s[56:59], s62 offen offset:1024 sc1 lds
    v_mfma_f32_16x16x32_bf16 v[236:239], v[52:55], v[100:103], v[236:239]
    ds_read_b128 v[36:39], v2 offset:22528
    v_mfma_f32_16x16x32_bf16 v[232:235], v[52:55], v[96:99], v[232:235]
    s_waitcnt lgkmcnt(6)
    v_mfma_f32_16x16x32_bf16 v[240:243], v[56:59], v[96:99], v[240:243]
    ds_read_b128 v[40:43], v2 offset:17408
    v_mfma_f32_16x16x32_bf16 v[244:247], v[56:59], v[100:103], v[244:247]
    buffer_load_dwordx4 v[144:147], v2, s[56:59], s76 offen offset:2048 sc1
    v_mfma_f32_16x16x32_bf16 v[252:255], v[60:63], v[100:103], v[252:255]
    ds_read_b128 v[44:47], v2 offset:23552
    v_mfma_f32_16x16x32_bf16 v[248:251], v[60:63], v[96:99], v[248:251]
    s_waitcnt lgkmcnt(6)
    v_mfma_f32_16x16x32_bf16 v[160:163], v[64:67], v[96:99], v[160:163]
    ds_read_b128 v[48:51], v2 offset:28672
    v_mfma_f32_16x16x32_bf16 v[164:167], v[64:67], v[100:103], v[164:167]
    buffer_load_dwordx4 v2, s[56:59], s62 offen offset:2048 sc1 lds
    s_add_u32 s62, s62, 12288
    v_mfma_f32_16x16x32_bf16 v[172:175], v[68:71], v[100:103], v[172:175]
    ds_read_b128 v[52:55], v2 offset:34816
    v_mfma_f32_16x16x32_bf16 v[168:171], v[68:71], v[96:99], v[168:171]
    s_waitcnt lgkmcnt(6)
    v_mfma_f32_16x16x32_bf16 v[176:179], v[72:75], v[96:99], v[176:179]
    ds_read_b128 v[56:59], v2 offset:29696
    v_mfma_f32_16x16x32_bf16 v[180:183], v[72:75], v[100:103], v[180:183]
    buffer_load_dwordx4 v[148:151], v20, s[56:59], s76 offen offset:2048 sc1
    v_mfma_f32_16x16x32_bf16 v[188:191], v[76:79], v[100:103], v[188:191]
    ds_read_b128 v[60:63], v2 offset:35840
    v_mfma_f32_16x16x32_bf16 v[184:187], v[76:79], v[96:99], v[184:187]
    s_waitcnt vmcnt(10)
    s_barrier
    s_waitcnt lgkmcnt(6)
    v_mfma_f32_16x16x32_bf16 v[160:163], v[32:35], v[104:107], v[160:163]
    ds_read_b128 v[64:67], v2 offset:40960
    v_mfma_f32_16x16x32_bf16 v[164:167], v[32:35], v[108:111], v[164:167]
    buffer_load_dwordx4 v[152:155], v2, s[56:59], s76 offen offset:3072 sc1
    v_mfma_f32_16x16x32_bf16 v[172:175], v[36:39], v[108:111], v[172:175]
    ds_read_b128 v[68:71], v2 offset:47104
    v_mfma_f32_16x16x32_bf16 v[168:171], v[36:39], v[104:107], v[168:171]
    s_waitcnt lgkmcnt(6)
    v_mfma_f32_16x16x32_bf16 v[176:179], v[40:43], v[104:107], v[176:179]
    ds_read_b128 v[72:75], v2 offset:41984
    v_mfma_f32_16x16x32_bf16 v[180:183], v[40:43], v[108:111], v[180:183]
    v_mfma_f32_16x16x32_bf16 v[188:191], v[44:47], v[108:111], v[188:191]
    ds_read_b128 v[76:79], v2 offset:48128
    v_mfma_f32_16x16x32_bf16 v[184:187], v[44:47], v[104:107], v[184:187]
    s_waitcnt lgkmcnt(6)
    v_mfma_f32_16x16x32_bf16 v[160:163], v[48:51], v[112:115], v[160:163]
    ds_read_b128 v[32:35], v2 offset:53248
    v_mfma_f32_16x16x32_bf16 v[164:167], v[48:51], v[116:119], v[164:167]
    v_mfma_f32_16x16x32_bf16 v[172:175], v[52:55], v[116:119], v[172:175]
    ds_read_b128 v[36:39], v2 offset:59392
    v_mfma_f32_16x16x32_bf16 v[168:171], v[52:55], v[112:115], v[168:171]
    s_waitcnt lgkmcnt(6)
    v_mfma_f32_16x16x32_bf16 v[176:179], v[56:59], v[112:115], v[176:179]
    ds_read_b128 v[40:43], v2 offset:54272
    v_mfma_f32_16x16x32_bf16 v[180:183], v[56:59], v[116:119], v[180:183]
    buffer_load_dwordx4 v[156:159], v20, s[56:59], s76 offen offset:3072 sc1
    s_add_u32 s76, s76, 4096
    v_mfma_f32_16x16x32_bf16 v[188:191], v[60:63], v[116:119], v[188:191]
    ds_read_b128 v[44:47], v2 offset:60416
    v_mfma_f32_16x16x32_bf16 v[184:187], v[60:63], v[112:115], v[184:187]
    s_waitcnt lgkmcnt(6)
    v_mfma_f32_16x16x32_bf16 v[160:163], v[64:67], v[120:123], v[160:163]
    ds_read_b128 v[48:51], v21 offset:4096
    v_mfma_f32_16x16x32_bf16 v[164:167], v[64:67], v[124:127], v[164:167]
    v_mfma_f32_16x16x32_bf16 v[172:175], v[68:71], v[124:127], v[172:175]
    ds_read_b128 v[52:55], v21 offset:10240
    v_mfma_f32_16x16x32_bf16 v[168:171], v[68:71], v[120:123], v[168:171]
    s_waitcnt lgkmcnt(6)
    v_mfma_f32_16x16x32_bf16 v[176:179], v[72:75], v[120:123], v[176:179]
    ds_read_b128 v[56:59], v21 offset:5120
    v_mfma_f32_16x16x32_bf16 v[180:183], v[72:75], v[124:127], v[180:183]
    v_mfma_f32_16x16x32_bf16 v[188:191], v[76:79], v[124:127], v[188:191]
    ds_read_b128 v[60:63], v21 offset:11264
    v_mfma_f32_16x16x32_bf16 v[184:187], v[76:79], v[120:123], v[184:187]
    s_waitcnt vmcnt(3)
L_g1tail:
    s_barrier
    s_waitcnt lgkmcnt(6)
    v_mfma_f32_16x16x32_bf16 v[160:163], v[32:35], v[128:131], v[160:163]
    ds_read_b128 v[64:67], v21 offset:16384
    v_mfma_f32_16x16x32_bf16 v[164:167], v[32:35], v[132:135], v[164:167]
    buffer_load_dwordx4 a[112:115], v2, s[56:59], s67 offen offset:0 sc1
    v_mfma_f32_16x16x32_bf16 v[172:175], v[36:39], v[132:135], v[172:175]
    ds_read_b128 v[68:71], v21 offset:22528
    v_mfma_f32_16x16x32_bf16 v[168:171], v[36:39], v[128:131], v[168:171]
    s_waitcnt lgkmcnt(6)
    v_mfma_f32_16x16x32_bf16 v[176:179], v[40:43], v[128:131], v[176:179]
    ds_read_b128 v[72:75], v21 offset:17408
    v_mfma_f32_16x16x32_bf16 v[180:183], v[40:43], v[132:135], v[180:183]
    buffer_load_dwordx4 a[116:119], v2, s[56:59], s67 offen offset:1024 sc1
    v_mfma_f32_16x16x32_bf16 v[188:191], v[44:47], v[132:135], v[188:191]
    ds_read_b128 v[76:79], v21 offset:23552
    v_mfma_f32_16x16x32_bf16 v[184:187], v[44:47], v[128:131], v[184:187]
    s_waitcnt lgkmcnt(6)
    v_mfma_f32_16x16x32_bf16 v[160:163], v[48:51], v[136:139], v[160:163]
    ds_read_b128 v[32:35], v21 offset:28672
    v_mfma_f32_16x16x32_bf16 v[164:167], v[48:51], v[140:143], v[164:167]
    buffer_load_dwordx4 a[120:123], v2, s[56:59], s67 offen offset:2048 sc1
    v_mfma_f32_16x16x32_bf16 v[172:175], v[52:55], v[140:143], v[172:175]
    ds_read_b128 v[36:39], v21 offset:34816
    v_mfma_f32_16x16x32_bf16 v[168:171], v[52:55], v[136:139], v[168:171]
    s_waitcnt lgkmcnt(6)
    v_mfma_f32_16x16x32_bf16 v[176:179], v[56:59], v[136:139], v[176:179]
    ds_read_b128 v[40:43], v21 offset:29696
    v_mfma_f32_16x16x32_bf16 v[180:183], v[56:59], v[140:143], v[180:183]
    buffer_load_dwordx4 a[124:127], v2, s[56:59], s67 offen offset:3072 sc1
    s_add_u32 s67, s67, 4096
    v_mfma_f32_16x16x32_bf16 v[188:191], v[60:63], v[140:143], v[188:191]
    ds_read_b128 v[44:47], v21 offset:35840
    v_mfma_f32_16x16x32_bf16 v[184:187], v[60:63], v[136:139], v[184:187]
    s_waitcnt lgkmcnt(6)
    s_waitcnt vmcnt(6)
    v_mfma_f32_16x16x32_bf16 v[160:163], v[64:67], v[144:147], v[160:163]
    ds_read_b128 v[48:51], v2 offset:12288
    v_mfma_f32_16x16x32_bf16 v[164:167], v[64:67], v[148:151], v[164:167]
    buffer_load_dwordx4 a[128:131], v2, s[56:59], s67 offen offset:0 sc1
    v_mfma_f32_16x16x32_bf16 v[172:175], v[68:71], v[148:151], v[172:175]
    ds_read_b128 v[52:55], v2 offset:18432
    v_mfma_f32_16x16x32_bf16 v[168:171], v[68:71], v[144:147], v[168:171]
    s_waitcnt lgkmcnt(6)
    v_mfma_f32_16x16x32_bf16 v[176:179], v[72:75], v[144:147], v[176:179]
    ds_read_b128 v[56:59], v2 offset:13312
    v_mfma_f32_16x16x32_bf16 v[180:183], v[72:75], v[148:151], v[180:183]
    buffer_load_dwordx4 a[132:135], v2, s[56:59], s67 offen offset:1024 sc1
    v_mfma_f32_16x16x32_bf16 v[188:191], v[76:79], v[148:151], v[188:191]
    ds_read_b128 v[60:63], v2 offset:19456
    v_mfma_f32_16x16x32_bf16 v[184:187], v[76:79], v[144:147], v[184:187]
    s_waitcnt lgkmcnt(6)
    s_waitcnt vmcnt(6)
    v_mfma_f32_16x16x32_bf16 v[160:163], v[32:35], v[152:155], v[160:163]
    ds_read_b128 v[64:67], v2 offset:14336
    s_cmp_lg_u32 s6, 1
    s_cbranch_scc1 Lslow_39
    buffer_store_dword v0, v11, s[56:59], s14 offen
Lback_40:
    v_mfma_f32_16x16x32_bf16 v[164:167], v[32:35], v[156:159], v[164:167]
    buffer_load_dwordx4 a[136:139], v2, s[56:59], s67 offen offset:2048 sc1
    v_mfma_f32_16x16x32_bf16 v[172:175], v[36:39], v[156:159], v[172:175]
    ds_read_b128 v[68:71], v2 offset:20480
    v_mfma_f32_16x16x32_bf16 v[168:171], v[36:39], v[152:155], v[168:171]
    s_waitcnt lgkmcnt(6)
    v_mfma_f32_16x16x32_bf16 v[176:179], v[40:43], v[152:155], v[176:179]
    ds_read_b128 v[72:75], v2 offset:15360
    v_mfma_f32_16x16x32_bf16 v[180:183], v[40:43], v[156:159], v[180:183]
    buffer_load_dwordx4 a[140:143], v2, s[56:59], s67 offen offset:3072 sc1
    s_add_u32 s67, s67, 4096
    v_mfma_f32_16x16x32_bf16 v[188:191], v[44:47], v[156:159], v[188:191]
    ds_read_b128 v[76:79], v2 offset:21504
    v_mfma_f32_16x16x32_bf16 v[184:187], v[44:47], v[152:155], v[184:187]
    s_waitcnt lgkmcnt(6)
    v_mfma_f32_16x16x32_bf16 v[192:195], v[48:51], v[104:107], v[192:195]
    ds_read_b128 v[32:35], v2 offset:24576
    v_mfma_f32_16x16x32_bf16 v[196:199], v[48:51], v[108:111], v[196:199]
    buffer_load_dwordx4 a[144:147], v2, s[56:59], s67 offen offset:0 sc1
    v_max_f32 v160, 0, v160
    v_max_f32 v161, 0, v161
    v_mfma_f32_16x16x32_bf16 v[204:207], v[52:55], v[108:111], v[204:207]
    ds_read_b128 v[36:39], v2 offset:30720
    v_max_f32 v162, 0, v162
    v_mfma_f32_16x16x32_bf16 v[200:203], v[52:55], v[104:107], v[200:203]
    v_max_f32 v163, 0, v163
    s_waitcnt lgkmcnt(6)
    v_mfma_f32_16x16x32_bf16 v[208:211], v[56:59], v[104:107], v[208:211]
    ds_read_b128 v[40:43], v2 offset:25600
    v_mul_f32 v168, v160, v168
    v_mfma_f32_16x16x32_bf16 v[212:215], v[56:59], v[108:111], v[212:215]
    buffer_load_dwordx4 a[148:151], v2, s[56:59], s67 offen offset:1024 sc1
    v_mul_f32 v169, v161, v169
    v_mul_f32 v170, v162, v170
    v_mfma_f32_16x16x32_bf16 v[220:223], v[60:63], v[108:111], v[220:223]
    ds_read_b128 v[44:47], v2 offset:31744
    v_mul_f32 v171, v163, v171
    v_mfma_f32_16x16x32_bf16 v[216:219], v[60:63], v[104:107], v[216:219]
    v_cvt_pk_bf16_f32 v160, v168, v169
    s_waitcnt lgkmcnt(6)
    v_mfma_f32_16x16x32_bf16 v[224:227], v[64:67], v[104:107], v[224:227]
    ds_read_b128 v[48:51], v2 offset:26624
    v_cvt_pk_bf16_f32 v161, v170, v171
    v_mfma_f32_16x16x32_bf16 v[228:231], v[64:67], v[108:111], v[228:231]
    buffer_load_dwordx4 a[152:155], v2, s[56:59], s67 offen offset:2048 sc1
    v_max_f32 v176, 0, v176
    v_max_f32 v177, 0, v177
    v_mfma_f32_16x16x32_bf16 v[236:239], v[68:71], v[108:111], v[236:239]
    ds_read_b128 v[52:55], v2 offset:32768
    v_max_f32 v178, 0, v178
    v_mfma_f32_16x16x32_bf16 v[232:235], v[68:71], v[104:107], v[232:235]
    v_max_f32 v179, 0, v179
    s_waitcnt lgkmcnt(6)
    v_mfma_f32_16x16x32_bf16 v[240:243], v[72:75], v[104:107], v[240:243]
    ds_read_b128 v[56:59], v2 offset:27648
    v_mul_f32 v184, v176, v184
    v_mfma_f32_16x16x32_bf16 v[244:247], v[72:75], v[108:111], v[244:247]
    buffer_load_dwordx4 a[156:159], v2, s[56:59], s67 offen offset:3072 sc1
    s_add_u32 s67, s67, 4096
    v_mul_f32 v185, v177, v185
    v_mul_f32 v186, v178, v186
    v_mfma_f32_16x16x32_bf16 v[252:255], v[76:79], v[108:111], v[252:255]
    ds_read_b128 v[60:63], v2 offset:33792
    v_mul_f32 v187, v179, v187
    v_mfma_f32_16x16x32_bf16 v[248:251], v[76:79], v[104:107], v[248:251]
    v_cvt_pk_bf16_f32 v162, v184, v185
    s_waitcnt lgkmcnt(6)
    v_mfma_f32_16x16x32_bf16 v[192:195], v[32:35], v[112:115], v[192:195]
    ds_read_b128 v[64:67], v2 offset:36864
    v_cvt_pk_bf16_f32 v163, v186, v187
    v_mfma_f32_16x16x32_bf16 v[196:199], v[32:35], v[116:119], v[196:199]
    buffer_load_dwordx4 a[160:163], v2, s[56:59], s67 offen offset:0 sc1
    s_cmp_lg_u32 s6, 1
    s_cbranch_scc1 Lslow_41
    buffer_store_dwordx4 v[160:163], v2, s[56:59], s75 offen sc1
Lback_42:
    v_max_f32 v164, 0, v164
    v_mfma_f32_16x16x32_bf16 v[204:207], v[36:39], v[116:119], v[204:207]
    ds_read_b128 v[68:71], v2 offset:43008
    v_max_f32 v165, 0, v165
    v_mfma_f32_16x16x32_bf16 v[200:203], v[36:39], v[112:115], v[200:203]
    v_max_f32 v166, 0, v166
    s_waitcnt lgkmcnt(6)
    v_mfma_f32_16x16x32_bf16 v[208:211], v[40:43], v[112:115], v[208:211]
    ds_read_b128 v[72:75], v2 offset:37888
    v_max_f32 v167, 0, v167
    v_mfma_f32_16x16x32_bf16 v[212:215], v[40:43], v[116:119], v[212:215]
    buffer_load_dwordx4 a[164:167], v2, s[56:59], s67 offen offset:1024 sc1
    v_mul_f32 v172, v164, v172
    v_mul_f32 v173, v165, v173
    v_mfma_f32_16x16x32_bf16 v[220:223], v[44:47], v[116:119], v[220:223]
    ds_read_b128 v[76:79], v2 offset:44032
    v_mul_f32 v174, v166, v174
    v_mfma_f32_16x16x32_bf16 v[216:219], v[44:47], v[112:115], v[216:219]
    v_mul_f32 v175, v167, v175
    s_waitcnt lgkmcnt(6)
    v_mfma_f32_16x16x32_bf16 v[224:227], v[48:51], v[112:115], v[224:227]
    ds_read_b128 v[32:35], v2 offset:38912
    v_cvt_pk_bf16_f32 v164, v172, v173
    v_mfma_f32_16x16x32_bf16 v[228:231], v[48:51], v[116:119], v[228:231]
    v_cvt_pk_bf16_f32 v165, v174, v175
    v_max_f32 v180, 0, v180
    v_mfma_f32_16x16x32_bf16 v[236:239], v[52:55], v[116:119], v[236:239]
    ds_read_b128 v[36:39], v2 offset:45056
    buffer_load_dwordx4 a[168:171], v2, s[56:59], s67 offen offset:2048 sc1
    v_max_f32 v181, 0, v181
    v_mfma_f32_16x16x32_bf16 v[232:235], v[52:55], v[112:115], v[232:235]
    v_max_f32 v182, 0, v182
    s_waitcnt lgkmcnt(6)
    v_mfma_f32_16x16x32_bf16 v[240:243], v[56:59], v[112:115], v[240:243]
    ds_read_b128 v[40:43], v2 offset:39936
    v_max_f32 v183, 0, v183
    v_mfma_f32_16x16x32_bf16 v[244:247], v[56:59], v[116:119], v[244:247]
    v_mul_f32 v188, v180, v188
    v_mul_f32 v189, v181, v189
    v_mfma_f32_16x16x32_bf16 v[252:255], v[60:63], v[116:119], v[252:255]
    ds_read_b128 v[44:47], v2 offset:46080
    v_mul_f32 v190, v182, v190
    v_mfma_f32_16x16x32_bf16 v[248:251], v[60:63], v[112:115], v[248:251]
    buffer_load_dwordx4 a[172:175], v2, s[56:59], s67 offen offset:3072 sc1
    s_add_u32 s67, s67, 4096
    v_mul_f32 v191, v183, v191
    s_waitcnt lgkmcnt(6)
    v_mfma_f32_16x16x32_bf16 v[192:195], v[64:67], v[120:123], v[192:195]
    ds_read_b128 v[48:51], v2 offset:49152
    v_cvt_pk_bf16_f32 v166, v188, v189
    v_mfma_f32_16x16x32_bf16 v[196:199], v[64:67], v[124:127], v[196:199]
    v_cvt_pk_bf16_f32 v167, v190, v191
    s_cmp_lg_u32 s6, 1
    s_cbranch_scc1 Lslow_43
    buffer_store_dwordx4 v[164:167], v23, s[56:59], s75 offen sc1
Lback_44:
    v_mfma_f32_16x16x32_bf16 v[204:207], v[68:71], v[124:127], v[204:207]
    ds_read_b128 v[52:55], v2 offset:55296
    v_mfma_f32_16x16x32_bf16 v[200:203], v[68:71], v[120:123], v[200:203]
    s_waitcnt lgkmcnt(6)
    v_mfma_f32_16x16x32_bf16 v[208:211], v[72:75], v[120:123], v[208:211]
    ds_read_b128 v[56:59], v2 offset:50176
    buffer_load_dwordx4 a[176:179], v2, s[56:59], s67 offen offset:0 sc1
    v_mfma_f32_16x16x32_bf16 v[212:215], v[72:75], v[124:127], v[212:215]
    v_mfma_f32_16x16x32_bf16 v[220:223], v[76:79], v[124:127], v[220:223]
    ds_read_b128 v[60:63], v2 offset:56320
    v_mfma_f32_16x16x32_bf16 v[216:219], v[76:79], v[120:123], v[216:219]
    s_waitcnt lgkmcnt(6)
    v_mfma_f32_16x16x32_bf16 v[224:227], v[32:35], v[120:123], v[224:227]
    ds_read_b128 v[64:67], v2 offset:51200
    v_mfma_f32_16x16x32_bf16 v[228:231], v[32:35], v[124:127], v[228:231]
    buffer_load_dwordx4 a[180:183], v2, s[56:59], s67 offen offset:1024 sc1
    v_mfma_f32_16x16x32_bf16 v[236:239], v[36:39], v[124:127], v[236:239]
    ds_read_b128 v[68:71], v2 offset:57344
    v_mfma_f32_16x16x32_bf16 v[232:235], v[36:39], v[120:123], v[232:235]
    s_waitcnt lgkmcnt(6)
    v_mfma_f32_16x16x32_bf16 v[240:243], v[40:43], v[120:123], v[240:243]
    ds_read_b128 v[72:75], v2 offset:52224
    v_mfma_f32_16x16x32_bf16 v[244:247], v[40:43], v[124:127], v[244:247]
    buffer_load_dwordx4 a[184:187], v2, s[56:59], s67 offen offset:2048 sc1
    v_mfma_f32_16x16x32_bf16 v[252:255], v[44:47], v[124:127], v[252:255]
    ds_read_b128 v[76:79], v2 offset:58368
    v_mfma_f32_16x16x32_bf16 v[248:251], v[44:47], v[120:123], v[248:251]
    s_waitcnt lgkmcnt(6)
    v_mfma_f32_16x16x32_bf16 v[192:195], v[48:51], v[128:131], v[192:195]
    ds_read_b128 v[32:35], v21 offset:0
    v_mfma_f32_16x16x32_bf16 v[196:199], v[48:51], v[132:135], v[196:199]
    v_mfma_f32_16x16x32_bf16 v[204:207], v[52:55], v[132:135], v[204:207]
    ds_read_b128 v[36:39], v21 offset:6144
    buffer_load_dwordx4 a[188:191], v2, s[56:59], s67 offen offset:3072 sc1
    s_add_u32 s67, s67, 4096
    v_mfma_f32_16x16x32_bf16 v[200:203], v[52:55], v[128:131], v[200:203]
    s_waitcnt lgkmcnt(6)
    v_mfma_f32_16x16x32_bf16 v[208:211], v[56:59], v[128:131], v[208:211]
    ds_read_b128 v[40:43], v21 offset:1024
    v_mfma_f32_16x16x32_bf16 v[212:215], v[56:59], v[132:135], v[212:215]
    v_mfma_f32_16x16x32_bf16 v[220:223], v[60:63], v[132:135], v[220:223]
    ds_read_b128 v[44:47], v21 offset:7168
    v_mfma_f32_16x16x32_bf16 v[216:219], v[60:63], v[128:131], v[216:219]
    buffer_load_dwordx4 a[192:195], v2, s[56:59], s67 offen offset:0 sc1
    s_waitcnt lgkmcnt(6)
    v_mfma_f32_16x16x32_bf16 v[224:227], v[64:67], v[128:131], v[224:227]
    ds_read_b128 v[48:51], v21 offset:2048
    v_mfma_f32_16x16x32_bf16 v[228:231], v[64:67], v[132:135], v[228:231]
    v_mfma_f32_16x16x32_bf16 v[236:239], v[68:71], v[132:135], v[236:239]
    ds_read_b128 v[52:55], v21 offset:8192
    v_mfma_f32_16x16x32_bf16 v[232:235], v[68:71], v[128:131], v[232:235]
    s_waitcnt lgkmcnt(6)
    v_mfma_f32_16x16x32_bf16 v[240:243], v[72:75], v[128:131], v[240:243]
    ds_read_b128 v[56:59], v21 offset:3072
    buffer_load_dwordx4 a[196:199], v2, s[56:59], s67 offen offset:1024 sc1
    v_mfma_f32_16x16x32_bf16 v[244:247], v[72:75], v[132:135], v[244:247]
    v_mfma_f32_16x16x32_bf16 v[252:255], v[76:79], v[132:135], v[252:255]
    ds_read_b128 v[60:63], v21 offset:9216
    v_mfma_f32_16x16x32_bf16 v[248:251], v[76:79], v[128:131], v[248:251]
    s_waitcnt lgkmcnt(6)
    v_mfma_f32_16x16x32_bf16 v[192:195], v[32:35], v[136:139], v[192:195]
    ds_read_b128 v[64:67], v21 offset:12288
    v_mfma_f32_16x16x32_bf16 v[196:199], v[32:35], v[140:143], v[196:199]
    buffer_load_dwordx4 a[200:203], v2, s[56:59], s67 offen offset:2048 sc1
    v_mfma_f32_16x16x32_bf16 v[204:207], v[36:39], v[140:143], v[204:207]
    ds_read_b128 v[68:71], v21 offset:18432
    v_mfma_f32_16x16x32_bf16 v[200:203], v[36:39], v[136:139], v[200:203]
    s_waitcnt lgkmcnt(6)
    v_mfma_f32_16x16x32_bf16 v[208:211], v[40:43], v[136:139], v[208:211]
    ds_read_b128 v[72:75], v21 offset:13312
    v_mfma_f32_16x16x32_bf16 v[212:215], v[40:43], v[140:143], v[212:215]
    buffer_load_dwordx4 a[204:207], v2, s[56:59], s67 offen offset:3072 sc1
    s_add_u32 s67, s67, 4096
    v_mfma_f32_16x16x32_bf16 v[220:223], v[44:47], v[140:143], v[220:223]
    ds_read_b128 v[76:79], v21 offset:19456
    v_mfma_f32_16x16x32_bf16 v[216:219], v[44:47], v[136:139], v[216:219]
    s_waitcnt lgkmcnt(6)
    v_mfma_f32_16x16x32_bf16 v[224:227], v[48:51], v[136:139], v[224:227]
    ds_read_b128 v[32:35], v21 offset:14336
    buffer_load_dword v25, v28, s[56:59], s13 offen sc1
    v_mfma_f32_16x16x32_bf16 v[228:231], v[48:51], v[140:143], v[228:231]
    v_mfma_f32_16x16x32_bf16 v[236:239], v[52:55], v[140:143], v[236:239]
    ds_read_b128 v[36:39], v21 offset:20480
    buffer_load_dwordx4 a[208:211], v2, s[56:59], s67 offen offset:0 sc1
    v_mfma_f32_16x16x32_bf16 v[232:235], v[52:55], v[136:139], v[232:235]
    s_waitcnt lgkmcnt(6)
    v_mfma_f32_16x16x32_bf16 v[240:243], v[56:59], v[136:139], v[240:243]
    ds_read_b128 v[40:43], v21 offset:15360
    v_mfma_f32_16x16x32_bf16 v[244:247], v[56:59], v[140:143], v[244:247]
    v_mfma_f32_16x16x32_bf16 v[252:255], v[60:63], v[140:143], v[252:255]
    ds_read_b128 v[44:47], v21 offset:21504
    v_mfma_f32_16x16x32_bf16 v[248:251], v[60:63], v[136:139], v[248:251]
    buffer_load_dwordx4 a[212:215], v2, s[56:59], s67 offen offset:1024 sc1
    s_waitcnt lgkmcnt(6)
    v_mfma_f32_16x16x32_bf16 v[192:195], v[64:67], v[144:147], v[192:195]
    ds_read_b128 v[48:51], v21 offset:24576
    v_mfma_f32_16x16x32_bf16 v[196:199], v[64:67], v[148:151], v[196:199]
    v_mfma_f32_16x16x32_bf16 v[204:207], v[68:71], v[148:151], v[204:207]
    ds_read_b128 v[52:55], v21 offset:30720
    v_mfma_f32_16x16x32_bf16 v[200:203], v[68:71], v[144:147], v[200:203]
    s_waitcnt vmcnt(11)
    s_cmp_lg_u32 s6, 1
    s_cbranch_scc1 Lslow_45
    buffer_store_dword v0, v11, s[56:59], s73 offen
Lback_46:
    s_waitcnt lgkmcnt(6)
    v_mfma_f32_16x16x32_bf16 v[208:211], v[72:75], v[144:147], v[208:211]
    ds_read_b128 v[56:59], v21 offset:25600
    buffer_load_dwordx4 a[216:219], v2, s[56:59], s67 offen offset:2048 sc1
    v_mfma_f32_16x16x32_bf16 v[212:215], v[72:75], v[148:151], v[212:215]
    v_mfma_f32_16x16x32_bf16 v[220:223], v[76:79], v[148:151], v[220:223]
    ds_read_b128 v[60:63], v21 offset:31744
    v_mfma_f32_16x16x32_bf16 v[216:219], v[76:79], v[144:147], v[216:219]
    s_waitcnt lgkmcnt(6)
    v_mfma_f32_16x16x32_bf16 v[224:227], v[32:35], v[144:147], v[224:227]
    ds_read_b128 v[64:67], v21 offset:26624
    v_mfma_f32_16x16x32_bf16 v[228:231], v[32:35], v[148:151], v[228:231]
    buffer_load_dwordx4 a[220:223], v2, s[56:59], s67 offen offset:3072 sc1
    s_add_u32 s67, s67, 4096
    v_mfma_f32_16x16x32_bf16 v[236:239], v[36:39], v[148:151], v[236:239]
    ds_read_b128 v[68:71], v21 offset:32768
    v_mfma_f32_16x16x32_bf16 v[232:235], v[36:39], v[144:147], v[232:235]
    s_waitcnt lgkmcnt(6)
    v_mfma_f32_16x16x32_bf16 v[240:243], v[40:43], v[144:147], v[240:243]
    ds_read_b128 v[72:75], v21 offset:27648
    v_mfma_f32_16x16x32_bf16 v[244:247], v[40:43], v[148:151], v[244:247]
    buffer_load_dwordx4 a[224:227], v2, s[56:59], s67 offen offset:0 sc1
    v_mfma_f32_16x16x32_bf16 v[252:255], v[44:47], v[148:151], v[252:255]
    ds_read_b128 v[76:79], v21 offset:33792
    v_mfma_f32_16x16x32_bf16 v[248:251], v[44:47], v[144:147], v[248:251]
    s_waitcnt lgkmcnt(6)
    v_mfma_f32_16x16x32_bf16 v[192:195], v[48:51], v[152:155], v[192:195]
    v_mfma_f32_16x16x32_bf16 v[196:199], v[48:51], v[156:159], v[196:199]
    v_mfma_f32_16x16x32_bf16 v[204:207], v[52:55], v[156:159], v[204:207]
    buffer_load_dwordx4 a[228:231], v2, s[56:59], s67 offen offset:1024 sc1
    v_mfma_f32_16x16x32_bf16 v[200:203], v[52:55], v[152:155], v[200:203]
    s_waitcnt lgkmcnt(4)
    v_mfma_f32_16x16x32_bf16 v[208:211], v[56:59], v[152:155], v[208:211]
    v_mfma_f32_16x16x32_bf16 v[212:215], v[56:59], v[156:159], v[212:215]
    v_mfma_f32_16x16x32_bf16 v[220:223], v[60:63], v[156:159], v[220:223]
    v_mfma_f32_16x16x32_bf16 v[216:219], v[60:63], v[152:155], v[216:219]
    buffer_load_dwordx4 a[232:235], v2, s[56:59], s67 offen offset:2048 sc1
    s_waitcnt lgkmcnt(2)
    v_mfma_f32_16x16x32_bf16 v[224:227], v[64:67], v[152:155], v[224:227]
    v_mfma_f32_16x16x32_bf16 v[228:231], v[64:67], v[156:159], v[228:231]
    v_mfma_f32_16x16x32_bf16 v[236:239], v[68:71], v[156:159], v[236:239]
    v_mfma_f32_16x16x32_bf16 v[232:235], v[68:71], v[152:155], v[232:235]
    s_waitcnt lgkmcnt(0)
    v_mfma_f32_16x16x32_bf16 v[240:243], v[72:75], v[152:155], v[240:243]
    buffer_load_dwordx4 a[236:239], v2, s[56:59], s67 offen offset:3072 sc1
    s_add_u32 s67, s67, 4096
    v_mfma_f32_16x16x32_bf16 v[244:247], v[72:75], v[156:159], v[244:247]
    v_mfma_f32_16x16x32_bf16 v[252:255], v[76:79], v[156:159], v[252:255]
    v_mfma_f32_16x16x32_bf16 v[248:251], v[76:79], v[152:155], v[248:251]
    buffer_load_dword v24, v9, s[56:59], s74 offen sc1
    v_max_f32 v192, 0, v192
    v_max_f32 v193, 0, v193
    v_max_f32 v194, 0, v194
    v_max_f32 v195, 0, v195
    v_pk_mul_f32 v[200:201], v[192:193], v[200:201]
    v_pk_mul_f32 v[202:203], v[194:195], v[202:203]
    v_cvt_pk_bf16_f32 v192, v200, v201
    v_cvt_pk_bf16_f32 v193, v202, v203
    v_max_f32 v208, 0, v208
    v_max_f32 v209, 0, v209
    v_max_f32 v210, 0, v210
    v_max_f32 v211, 0, v211
    v_pk_mul_f32 v[216:217], v[208:209], v[216:217]
    v_pk_mul_f32 v[218:219], v[210:211], v[218:219]
    v_cvt_pk_bf16_f32 v194, v216, v217
    v_cvt_pk_bf16_f32 v195, v218, v219
    s_cmp_lg_u32 s6, 1
    s_cbranch_scc1 Lslow_47
    buffer_store_dwordx4 v[192:195], v2, s[56:59], s80 offen sc1
Lback_48:
    v_max_f32 v196, 0, v196
    v_max_f32 v197, 0, v197
    v_max_f32 v198, 0, v198
    v_max_f32 v199, 0, v199
    v_pk_mul_f32 v[204:205], v[196:197], v[204:205]
    v_pk_mul_f32 v[206:207], v[198:199], v[206:207]
    v_cvt_pk_bf16_f32 v196, v204, v205
    v_cvt_pk_bf16_f32 v197, v206, v207
    v_max_f32 v212, 0, v212
    v_max_f32 v213, 0, v213
    v_max_f32 v214, 0, v214
    v_max_f32 v215, 0, v215
    v_pk_mul_f32 v[220:221], v[212:213], v[220:221]
    v_pk_mul_f32 v[222:223], v[214:215], v[222:223]
    v_cvt_pk_bf16_f32 v198, v220, v221
    v_cvt_pk_bf16_f32 v199, v222, v223
    s_cmp_lg_u32 s6, 1
    s_cbranch_scc1 Lslow_49
    buffer_store_dwordx4 v[196:199], v23, s[56:59], s80 offen sc1
Lback_50:
    v_max_f32 v224, 0, v224
    v_max_f32 v225, 0, v225
    v_max_f32 v226, 0, v226
    v_max_f32 v227, 0, v227
    v_pk_mul_f32 v[232:233], v[224:225], v[232:233]
    v_pk_mul_f32 v[234:235], v[226:227], v[234:235]
    v_cvt_pk_bf16_f32 v224, v232, v233
    v_cvt_pk_bf16_f32 v225, v234, v235
    v_max_f32 v240, 0, v240
    v_max_f32 v241, 0, v241
    v_max_f32 v242, 0, v242
    v_max_f32 v243, 0, v243
    v_pk_mul_f32 v[248:249], v[240:241], v[248:249]
    v_pk_mul_f32 v[250:251], v[242:243], v[250:251]
    v_cvt_pk_bf16_f32 v226, v248, v249
    v_cvt_pk_bf16_f32 v227, v250, v251
    s_waitcnt vmcnt(12)
    v_cmp_ne_u32 vcc, s36, v25
    s_cbranch_vccnz Lapoll_51
Lok_52:
    s_cmp_lg_u32 s6, 1
    s_cbranch_scc1 Lslow_53
    buffer_store_dwordx4 v[224:227], v2, s[56:59], s12 offen
Lback_54:
    v_max_f32 v228, 0, v228
    v_max_f32 v229, 0, v229
    v_max_f32 v230, 0, v230
    v_max_f32 v231, 0, v231
    v_pk_mul_f32 v[236:237], v[228:229], v[236:237]
    v_pk_mul_f32 v[238:239], v[230:231], v[238:239]
    v_cvt_pk_bf16_f32 v228, v236, v237
    v_cvt_pk_bf16_f32 v229, v238, v239
    v_max_f32 v244, 0, v244
    v_max_f32 v245, 0, v245
    v_max_f32 v246, 0, v246
    v_max_f32 v247, 0, v247
    v_pk_mul_f32 v[252:253], v[244:245], v[252:253]
    v_pk_mul_f32 v[254:255], v[246:247], v[254:255]
    v_cvt_pk_bf16_f32 v230, v252, v253
    v_cvt_pk_bf16_f32 v231, v254, v255
    s_cmp_lg_u32 s6, 1
    s_cbranch_scc1 Lslow_55
    buffer_store_dwordx4 v[228:231], v23, s[56:59], s12 offen
Lback_56:
    s_waitcnt vmcnt(4)
    v_cmp_ne_u32 vcc, s36, v24
    s_cbranch_vccnz Lapoll_57
Lok_58:
    buffer_load_dwordx4 v[80:83], v27, s[56:59], s77 offen offset:0 sc1
    buffer_load_dwordx4 v[84:87], v27, s[56:59], s77 offen offset:1024 sc1
    buffer_load_dwordx4 v[88:91], v27, s[56:59], s77 offen offset:2048 sc1
    buffer_load_dwordx4 v[92:95], v27, s[56:59], s77 offen offset:3072 sc1
    buffer_load_dwordx4 v[96:99], v27, s[56:59], s78 offen offset:0 sc1
    buffer_load_dwordx4 v[100:103], v27, s[56:59], s78 offen offset:1024 sc1
L_g1done:
    s_waitcnt vmcnt(6)
    s_cmp_lg_u32 s6, 1
    s_cbranch_scc1 Lslow_59
    buffer_store_dword v0, v11, s[56:59], s72 offen
Lback_60:
    s_waitcnt vmcnt(6)
    v_mfma_f32_16x16x32_bf16 v[32:35], a[0:3], v[80:83], 0
    buffer_load_dwordx4 v[104:107], v27, s[56:59], s78 offen offset:2048 sc1
    v_mfma_f32_16x16x32_bf16 v[36:39], a[4:7], v[80:83], 0
    v_mfma_f32_16x16x32_bf16 v[40:43], a[8:11], v[80:83], 0
    buffer_load_dwordx4 v[108:111], v27, s[56:59], s78 offen offset:3072 sc1
    v_mfma_f32_16x16x32_bf16 v[44:47], a[12:15], v[80:83], 0
    v_mfma_f32_16x16x32_bf16 v[48:51], a[16:19], v[80:83], 0
    s_waitcnt vmcnt(7)
    v_mfma_f32_16x16x32_bf16 v[32:35], a[20:23], v[84:87], v[32:35]
    buffer_load_dwordx4 v[112:115], v27, s[56:59], s79 offen offset:0 sc1
    v_mfma_f32_16x16x32_bf16 v[36:39], a[24:27], v[84:87], v[36:39]
    v_mfma_f32_16x16x32_bf16 v[40:43], a[28:31], v[84:87], v[40:43]
    buffer_load_dwordx4 v[116:119], v27, s[56:59], s79 offen offset:1024 sc1
    v_mfma_f32_16x16x32_bf16 v[44:47], a[32:35], v[84:87], v[44:47]
    v_mfma_f32_16x16x32_bf16 v[48:51], a[36:39], v[84:87], v[48:51]
    s_waitcnt vmcnt(8)
    v_mfma_f32_16x16x32_bf16 v[32:35], a[40:43], v[88:91], v[32:35]
    buffer_load_dwordx4 v[120:123], v27, s[56:59], s79 offen offset:2048 sc1
    v_mfma_f32_16x16x32_bf16 v[36:39], a[44:47], v[88:91], v[36:39]
    v_mfma_f32_16x16x32_bf16 v[40:43], a[48:51], v[88:91], v[40:43]
    buffer_load_dwordx4 v[124:127], v27, s[56:59], s79 offen offset:3072 sc1
    v_mfma_f32_16x16x32_bf16 v[44:47], a[52:55], v[88:91], v[44:47]
    v_mfma_f32_16x16x32_bf16 v[48:51], a[56:59], v[88:91], v[48:51]
    s_waitcnt vmcnt(9)
    v_mfma_f32_16x16x32_bf16 v[32:35], a[60:63], v[92:95], v[32:35]
    buffer_load_dwordx4 v[128:131], v27, s[56:59], s81 offen offset:0 sc1
    v_mfma_f32_16x16x32_bf16 v[36:39], a[64:67], v[92:95], v[36:39]
    v_mfma_f32_16x16x32_bf16 v[40:43], a[68:71], v[92:95], v[40:43]
    buffer_load_dwordx4 v[132:135], v27, s[56:59], s81 offen offset:1024 sc1
    v_mfma_f32_16x16x32_bf16 v[44:47], a[72:75], v[92:95], v[44:47]
    v_mfma_f32_16x16x32_bf16 v[48:51], a[76:79], v[92:95], v[48:51]
    s_waitcnt vmcnt(10)
    v_mfma_f32_16x16x32_bf16 v[52:55], a[0:3], v[96:99], 0
    buffer_load_dwordx4 v[136:139], v27, s[56:59], s81 offen offset:2048 sc1
    v_mfma_f32_16x16x32_bf16 v[56:59], a[4:7], v[96:99], 0
    v_mfma_f32_16x16x32_bf16 v[60:63], a[8:11], v[96:99], 0
    buffer_load_dwordx4 v[140:143], v27, s[56:59], s81 offen offset:3072 sc1
    v_mfma_f32_16x16x32_bf16 v[64:67], a[12:15], v[96:99], 0
    v_mfma_f32_16x16x32_bf16 v[68:71], a[16:19], v[96:99], 0
    buffer_load_dword v24, v9, s[56:59], s38 offen sc1
    s_waitcnt vmcnt(12)
    v_mfma_f32_16x16x32_bf16 v[52:55], a[20:23], v[100:103], v[52:55]
    v_mfma_f32_16x16x32_bf16 v[56:59], a[24:27], v[100:103], v[56:59]
    v_mfma_f32_16x16x32_bf16 v[60:63], a[28:31], v[100:103], v[60:63]
    v_mfma_f32_16x16x32_bf16 v[64:67], a[32:35], v[100:103], v[64:67]
    v_mfma_f32_16x16x32_bf16 v[68:71], a[36:39], v[100:103], v[68:71]
    s_waitcnt vmcnt(10)
    v_mfma_f32_16x16x32_bf16 v[52:55], a[40:43], v[104:107], v[52:55]
    v_mfma_f32_16x16x32_bf16 v[56:59], a[44:47], v[104:107], v[56:59]
    v_mfma_f32_16x16x32_bf16 v[60:63], a[48:51], v[104:107], v[60:63]
    v_mfma_f32_16x16x32_bf16 v[64:67], a[52:55], v[104:107], v[64:67]
    v_mfma_f32_16x16x32_bf16 v[68:71], a[56:59], v[104:107], v[68:71]
    s_waitcnt vmcnt(9)
    v_mfma_f32_16x16x32_bf16 v[52:55], a[60:63], v[108:111], v[52:55]
    v_mfma_f32_16x16x32_bf16 v[56:59], a[64:67], v[108:111], v[56:59]
    v_mfma_f32_16x16x32_bf16 v[60:63], a[68:71], v[108:111], v[60:63]
    v_mfma_f32_16x16x32_bf16 v[64:67], a[72:75], v[108:111], v[64:67]
    v_mfma_f32_16x16x32_bf16 v[68:71], a[76:79], v[108:111], v[68:71]
    s_waitcnt vmcnt(8)
    v_mfma_f32_16x16x32_bf16 v[72:75], a[0:3], v[112:115], 0
    v_mfma_f32_16x16x32_bf16 v[76:79], a[4:7], v[112:115], 0
    v_mfma_f32_16x16x32_bf16 v[160:163], a[8:11], v[112:115], 0
    v_mfma_f32_16x16x32_bf16 v[164:167], a[12:15], v[112:115], 0
    v_mfma_f32_16x16x32_bf16 v[168:171], a[16:19], v[112:115], 0
    s_waitcnt vmcnt(0)
    v_cmp_ne_u32 vcc, s36, v24
    s_cbranch_vccnz Lapoll_61
Lok_62:
    v_mfma_f32_16x16x32_bf16 v[72:75], a[20:23], v[116:119], v[72:75]
    buffer_load_dwordx4 v[144:147], v29, s[56:59], s77 offen offset:0 sc1
    v_mfma_f32_16x16x32_bf16 v[76:79], a[24:27], v[116:119], v[76:79]
    v_mfma_f32_16x16x32_bf16 v[160:163], a[28:31], v[116:119], v[160:163]
    buffer_load_dwordx4 v[148:151], v2, s[56:59], s77 offen offset:0 sc1
    v_mfma_f32_16x16x32_bf16 v[164:167], a[32:35], v[116:119], v[164:167]
    v_mfma_f32_16x16x32_bf16 v[168:171], a[36:39], v[116:119], v[168:171]
    v_mfma_f32_16x16x32_bf16 v[72:75], a[40:43], v[120:123], v[72:75]
    buffer_load_dwordx4 v[152:155], v29, s[56:59], s77 offen offset:1024 sc1
    v_mfma_f32_16x16x32_bf16 v[76:79], a[44:47], v[120:123], v[76:79]
    v_mfma_f32_16x16x32_bf16 v[160:163], a[48:51], v[120:123], v[160:163]
    buffer_load_dwordx4 v[156:159], v2, s[56:59], s77 offen offset:1024 sc1
    v_mfma_f32_16x16x32_bf16 v[164:167], a[52:55], v[120:123], v[164:167]
    v_mfma_f32_16x16x32_bf16 v[168:171], a[56:59], v[120:123], v[168:171]
    v_mfma_f32_16x16x32_bf16 v[72:75], a[60:63], v[124:127], v[72:75]
    buffer_load_dwordx4 v[192:195], v29, s[56:59], s77 offen offset:2048 sc1
    v_mfma_f32_16x16x32_bf16 v[76:79], a[64:67], v[124:127], v[76:79]
    v_mfma_f32_16x16x32_bf16 v[160:163], a[68:71], v[124:127], v[160:163]
    buffer_load_dwordx4 v[196:199], v2, s[56:59], s77 offen offset:2048 sc1
    v_mfma_f32_16x16x32_bf16 v[164:167], a[72:75], v[124:127], v[164:167]
    v_mfma_f32_16x16x32_bf16 v[168:171], a[76:79], v[124:127], v[168:171]
    v_mfma_f32_16x16x32_bf16 v[172:175], a[0:3], v[128:131], 0
    buffer_load_dwordx4 v[200:203], v29, s[56:59], s77 offen offset:3072 sc1
    v_mfma_f32_16x16x32_bf16 v[176:179], a[4:7], v[128:131], 0
    v_mfma_f32_16x16x32_bf16 v[180:183], a[8:11], v[128:131], 0
    buffer_load_dwordx4 v[204:207], v2, s[56:59], s77 offen offset:3072 sc1
    v_mfma_f32_16x16x32_bf16 v[184:187], a[12:15], v[128:131], 0
    v_mfma_f32_16x16x32_bf16 v[188:191], a[16:19], v[128:131], 0
    v_mfma_f32_16x16x32_bf16 v[172:175], a[20:23], v[132:135], v[172:175]
    buffer_load_dwordx4 v[208:211], v29, s[56:59], s78 offen offset:0 sc1
    v_mfma_f32_16x16x32_bf16 v[176:179], a[24:27], v[132:135], v[176:179]
    v_mfma_f32_16x16x32_bf16 v[180:183], a[28:31], v[132:135], v[180:183]
    buffer_load_dwordx4 v[212:215], v2, s[56:59], s78 offen offset:0 sc1
    v_mfma_f32_16x16x32_bf16 v[184:187], a[32:35], v[132:135], v[184:187]
    v_mfma_f32_16x16x32_bf16 v[188:191], a[36:39], v[132:135], v[188:191]
    v_mfma_f32_16x16x32_bf16 v[172:175], a[40:43], v[136:139], v[172:175]
    buffer_load_dwordx4 v[216:219], v29, s[56:59], s78 offen offset:1024 sc1
    v_mfma_f32_16x16x32_bf16 v[176:179], a[44:47], v[136:139], v[176:179]
    v_mfma_f32_16x16x32_bf16 v[180:183], a[48:51], v[136:139], v[180:183]
    buffer_load_dwordx4 v[220:223], v2, s[56:59], s78 offen offset:1024 sc1
    v_mfma_f32_16x16x32_bf16 v[184:187], a[52:55], v[136:139], v[184:187]
    v_mfma_f32_16x16x32_bf16 v[188:191], a[56:59], v[136:139], v[188:191]
    v_mfma_f32_16x16x32_bf16 v[172:175], a[60:63], v[140:143], v[172:175]
    buffer_load_dwordx4 v[224:227], v29, s[56:59], s78 offen offset:2048 sc1
    v_mfma_f32_16x16x32_bf16 v[176:179], a[64:67], v[140:143], v[176:179]
    v_mfma_f32_16x16x32_bf16 v[180:183], a[68:71], v[140:143], v[180:183]
    v_mfma_f32_16x16x32_bf16 v[184:187], a[72:75], v[140:143], v[184:187]
    v_mfma_f32_16x16x32_bf16 v[188:191], a[76:79], v[140:143], v[188:191]
    s_waitcnt vmcnt(12)
    v_mfma_f32_16x16x32_bf16 v[32:35], a[80:83], v[144:147], v[32:35]
    buffer_load_dwordx4 v[228:231], v2, s[56:59], s78 offen offset:2048 sc1
    v_mfma_f32_16x16x32_bf16 v[36:39], a[84:87], v[144:147], v[36:39]
    v_mfma_f32_16x16x32_bf16 v[40:43], a[88:91], v[144:147], v[40:43]
    v_mfma_f32_16x16x32_bf16 v[44:47], a[92:95], v[144:147], v[44:47]
    v_mfma_f32_16x16x32_bf16 v[48:51], a[96:99], v[144:147], v[48:51]
    s_waitcnt vmcnt(12)
    v_mfma_f32_16x16x32_bf16 v[32:35], a[100:103], v[148:151], v[32:35]
    buffer_load_dwordx4 v[232:235], v29, s[56:59], s78 offen offset:3072 sc1
    v_mfma_f32_16x16x32_bf16 v[36:39], a[104:107], v[148:151], v[36:39]
    v_mfma_f32_16x16x32_bf16 v[40:43], a[108:111], v[148:151], v[40:43]
    v_mfma_f32_16x16x32_bf16 v[44:47], a[112:115], v[148:151], v[44:47]
    v_mfma_f32_16x16x32_bf16 v[48:51], a[116:119], v[148:151], v[48:51]
    s_waitcnt vmcnt(12)
    v_mfma_f32_16x16x32_bf16 v[32:35], a[120:123], v[152:155], v[32:35]
    buffer_load_dwordx4 v[236:239], v2, s[56:59], s78 offen offset:3072 sc1
    v_mfma_f32_16x16x32_bf16 v[36:39], a[124:127], v[152:155], v[36:39]
    v_mfma_f32_16x16x32_bf16 v[40:43], a[128:131], v[152:155], v[40:43]
    v_mfma_f32_16x16x32_bf16 v[44:47], a[132:135], v[152:155], v[44:47]
    v_mfma_f32_16x16x32_bf16 v[48:51], a[136:139], v[152:155], v[48:51]
    s_waitcnt vmcnt(12)
    v_mfma_f32_16x16x32_bf16 v[32:35], a[140:143], v[156:159], v[32:35]
    buffer_load_dwordx4 v[240:243], v29, s[56:59], s79 offen offset:0 sc1
    v_mfma_f32_16x16x32_bf16 v[36:39], a[144:147], v[156:159], v[36:39]
    v_mfma_f32_16x16x32_bf16 v[40:43], a[148:151], v[156:159], v[40:43]
    v_mfma_f32_16x16x32_bf16 v[44:47], a[152:155], v[156:159], v[44:47]
    v_mfma_f32_16x16x32_bf16 v[48:51], a[156:159], v[156:159], v[48:51]
    s_barrier
    s_waitcnt vmcnt(12)
    v_mfma_f32_16x16x32_bf16 v[32:35], a[160:163], v[192:195], v[32:35]
    buffer_load_dwordx4 v[244:247], v2, s[56:59], s79 offen offset:0 sc1
    v_mfma_f32_16x16x32_bf16 v[36:39], a[164:167], v[192:195], v[36:39]
    v_mfma_f32_16x16x32_bf16 v[40:43], a[168:171], v[192:195], v[40:43]
    v_mfma_f32_16x16x32_bf16 v[44:47], a[172:175], v[192:195], v[44:47]
    v_mfma_f32_16x16x32_bf16 v[48:51], a[176:179], v[192:195], v[48:51]
    s_waitcnt vmcnt(12)
    v_mfma_f32_16x16x32_bf16 v[32:35], a[180:183], v[196:199], v[32:35]
    buffer_load_dwordx4 v[248:251], v29, s[56:59], s79 offen offset:1024 sc1
    v_mfma_f32_16x16x32_bf16 v[36:39], a[184:187], v[196:199], v[36:39]
    v_mfma_f32_16x16x32_bf16 v[40:43], a[188:191], v[196:199], v[40:43]
    v_mfma_f32_16x16x32_bf16 v[44:47], a[192:195], v[196:199], v[44:47]
    v_mfma_f32_16x16x32_bf16 v[48:51], a[196:199], v[196:199], v[48:51]
    s_waitcnt vmcnt(12)
    v_mfma_f32_16x16x32_bf16 v[32:35], a[200:203], v[200:203], v[32:35]
    buffer_load_dwordx4 v[252:255], v2, s[56:59], s79 offen offset:1024 sc1
    v_mfma_f32_16x16x32_bf16 v[36:39], a[204:207], v[200:203], v[36:39]
    v_mfma_f32_16x16x32_bf16 v[40:43], a[208:211], v[200:203], v[40:43]
    v_mfma_f32_16x16x32_bf16 v[44:47], a[212:215], v[200:203], v[44:47]
    v_mfma_f32_16x16x32_bf16 v[48:51], a[216:219], v[200:203], v[48:51]
    s_waitcnt vmcnt(12)
    v_mfma_f32_16x16x32_bf16 v[32:35], a[220:223], v[204:207], v[32:35]
    buffer_load_dwordx4 v[80:83], v29, s[56:59], s79 offen offset:2048 sc1
    v_mfma_f32_16x16x32_bf16 v[36:39], a[224:227], v[204:207], v[36:39]
    v_mfma_f32_16x16x32_bf16 v[40:43], a[228:231], v[204:207], v[40:43]
    v_mfma_f32_16x16x32_bf16 v[44:47], a[232:235], v[204:207], v[44:47]
    v_mfma_f32_16x16x32_bf16 v[48:51], a[236:239], v[204:207], v[48:51]
    s_waitcnt vmcnt(12)
    v_mfma_f32_16x16x32_bf16 v[52:55], a[80:83], v[208:211], v[52:55]
    buffer_load_dwordx4 v[84:87], v2, s[56:59], s79 offen offset:2048 sc1
    v_mfma_f32_16x16x32_bf16 v[56:59], a[84:87], v[208:211], v[56:59]
    v_mfma_f32_16x16x32_bf16 v[60:63], a[88:91], v[208:211], v[60:63]
    v_mfma_f32_16x16x32_bf16 v[64:67], a[92:95], v[208:211], v[64:67]
    v_mfma_f32_16x16x32_bf16 v[68:71], a[96:99], v[208:211], v[68:71]
    ds_write_b32 v16, v32 offset:0
    s_waitcnt vmcnt(12)
    v_mfma_f32_16x16x32_bf16 v[52:55], a[100:103], v[212:215], v[52:55]
    buffer_load_dwordx4 v[88:91], v29, s[56:59], s79 offen offset:3072 sc1
    ds_write_b32 v16, v33 offset:4
    v_mfma_f32_16x16x32_bf16 v[56:59], a[104:107], v[212:215], v[56:59]
    ds_write_b32 v16, v34 offset:512
    v_mfma_f32_16x16x32_bf16 v[60:63], a[108:111], v[212:215], v[60:63]
    ds_write_b32 v16, v35 offset:516
    v_mfma_f32_16x16x32_bf16 v[64:67], a[112:115], v[212:215], v[64:67]
    ds_write_b32 v16, v36 offset:1024
    v_mfma_f32_16x16x32_bf16 v[68:71], a[116:119], v[212:215], v[68:71]
    ds_write_b32 v16, v37 offset:1028
    s_waitcnt vmcnt(12)
    v_mfma_f32_16x16x32_bf16 v[52:55], a[120:123], v[216:219], v[52:55]
    buffer_load_dwordx4 v[92:95], v2, s[56:59], s79 offen offset:3072 sc1
    ds_write_b32 v16, v38 offset:1536
    v_mfma_f32_16x16x32_bf16 v[56:59], a[124:127], v[216:219], v[56:59]
    ds_write_b32 v16, v39 offset:1540
    v_mfma_f32_16x16x32_bf16 v[60:63], a[128:131], v[216:219], v[60:63]
    ds_write_b32 v16, v40 offset:2048
    v_mfma_f32_16x16x32_bf16 v[64:67], a[132:135], v[216:219], v[64:67]
    ds_write_b32 v16, v41 offset:2052
    v_mfma_f32_16x16x32_bf16 v[68:71], a[136:139], v[216:219], v[68:71]
    ds_write_b32 v16, v42 offset:2560
    s_waitcnt vmcnt(12)
    v_mfma_f32_16x16x32_bf16 v[52:55], a[140:143], v[220:223], v[52:55]
    buffer_load_dwordx4 v[96:99], v29, s[56:59], s81 offen offset:0 sc1
    ds_write_b32 v16, v43 offset:2564
    v_mfma_f32_16x16x32_bf16 v[56:59], a[144:147], v[220:223], v[56:59]
    ds_write_b32 v16, v44 offset:3072
    v_mfma_f32_16x16x32_bf16 v[60:63], a[148:151], v[220:223], v[60:63]
    ds_write_b32 v16, v45 offset:3076
    v_mfma_f32_16x16x32_bf16 v[64:67], a[152:155], v[220:223], v[64:67]
    ds_write_b32 v16, v46 offset:3584
    v_mfma_f32_16x16x32_bf16 v[68:71], a[156:159], v[220:223], v[68:71]
    ds_write_b32 v16, v47 offset:3588
    s_waitcnt vmcnt(12)
    v_mfma_f32_16x16x32_bf16 v[52:55], a[160:163], v[224:227], v[52:55]
    buffer_load_dwordx4 v[100:103], v2, s[56:59], s81 offen offset:0 sc1
    ds_write_b32 v16, v48 offset:4096
    v_mfma_f32_16x16x32_bf16 v[56:59], a[164:167], v[224:227], v[56:59]
    ds_write_b32 v16, v49 offset:4100
    v_mfma_f32_16x16x32_bf16 v[60:63], a[168:171], v[224:227], v[60:63]
    ds_write_b32 v16, v50 offset:4608
    v_mfma_f32_16x16x32_bf16 v[64:67], a[172:175], v[224:227], v[64:67]
    ds_write_b32 v16, v51 offset:4612
    v_mfma_f32_16x16x32_bf16 v[68:71], a[176:179], v[224:227], v[68:71]
    s_waitcnt vmcnt(12)
    v_mfma_f32_16x16x32_bf16 v[52:55], a[180:183], v[228:231], v[52:55]
    buffer_load_dwordx4 v[104:107], v29, s[56:59], s81 offen offset:1024 sc1
    v_mfma_f32_16x16x32_bf16 v[56:59], a[184:187], v[228:231], v[56:59]
    v_mfma_f32_16x16x32_bf16 v[60:63], a[188:191], v[228:231], v[60:63]
    v_mfma_f32_16x16x32_bf16 v[64:67], a[192:195], v[228:231], v[64:67]
    v_mfma_f32_16x16x32_bf16 v[68:71], a[196:199], v[228:231], v[68:71]
    s_waitcnt vmcnt(12)
    v_mfma_f32_16x16x32_bf16 v[52:55], a[200:203], v[232:235], v[52:55]
    buffer_load_dwordx4 v[108:111], v2, s[56:59], s81 offen offset:1024 sc1
    v_mfma_f32_16x16x32_bf16 v[56:59], a[204:207], v[232:235], v[56:59]
    v_mfma_f32_16x16x32_bf16 v[60:63], a[208:211], v[232:235], v[60:63]
    v_mfma_f32_16x16x32_bf16 v[64:67], a[212:215], v[232:235], v[64:67]
    v_mfma_f32_16x16x32_bf16 v[68:71], a[216:219], v[232:235], v[68:71]
    s_waitcnt vmcnt(12)
    v_mfma_f32_16x16x32_bf16 v[52:55], a[220:223], v[236:239], v[52:55]
    buffer_load_dwordx4 v[112:115], v29, s[56:59], s81 offen offset:2048 sc1
    v_mfma_f32_16x16x32_bf16 v[56:59], a[224:227], v[236:239], v[56:59]
    v_mfma_f32_16x16x32_bf16 v[60:63], a[228:231], v[236:239], v[60:63]
    v_mfma_f32_16x16x32_bf16 v[64:67], a[232:235], v[236:239], v[64:67]
    v_mfma_f32_16x16x32_bf16 v[68:71], a[236:239], v[236:239], v[68:71]
    s_waitcnt vmcnt(12)
    v_mfma_f32_16x16x32_bf16 v[72:75], a[80:83], v[240:243], v[72:75]
    buffer_load_dwordx4 v[116:119], v2, s[56:59], s81 offen offset:2048 sc1
    v_mfma_f32_16x16x32_bf16 v[76:79], a[84:87], v[240:243], v[76:79]
    v_mfma_f32_16x16x32_bf16 v[160:163], a[88:91], v[240:243], v[160:163]
    v_mfma_f32_16x16x32_bf16 v[164:167], a[92:95], v[240:243], v[164:167]
    v_mfma_f32_16x16x32_bf16 v[168:171], a[96:99], v[240:243], v[168:171]
    ds_write_b32 v17, v52 offset:0
    s_waitcnt vmcnt(12)
    v_mfma_f32_16x16x32_bf16 v[72:75], a[100:103], v[244:247], v[72:75]
    buffer_load_dwordx4 v[120:123], v29, s[56:59], s81 offen offset:3072 sc1
    ds_write_b32 v17, v53 offset:4
    v_mfma_f32_16x16x32_bf16 v[76:79], a[104:107], v[244:247], v[76:79]
    ds_write_b32 v17, v54 offset:512
    v_mfma_f32_16x16x32_bf16 v[160:163], a[108:111], v[244:247], v[160:163]
    ds_write_b32 v17, v55 offset:516
    v_mfma_f32_16x16x32_bf16 v[164:167], a[112:115], v[244:247], v[164:167]
    ds_write_b32 v17, v56 offset:1024
    v_mfma_f32_16x16x32_bf16 v[168:171], a[116:119], v[244:247], v[168:171]
    ds_write_b32 v17, v57 offset:1028
    s_waitcnt vmcnt(12)
    v_mfma_f32_16x16x32_bf16 v[72:75], a[120:123], v[248:251], v[72:75]
    buffer_load_dwordx4 v[124:127], v2, s[56:59], s81 offen offset:3072 sc1
    ds_write_b32 v17, v58 offset:1536
    v_mfma_f32_16x16x32_bf16 v[76:79], a[124:127], v[248:251], v[76:79]
    ds_write_b32 v17, v59 offset:1540
    v_mfma_f32_16x16x32_bf16 v[160:163], a[128:131], v[248:251], v[160:163]
    ds_write_b32 v17, v60 offset:2048
    v_mfma_f32_16x16x32_bf16 v[164:167], a[132:135], v[248:251], v[164:167]
    ds_write_b32 v17, v61 offset:2052
    v_mfma_f32_16x16x32_bf16 v[168:171], a[136:139], v[248:251], v[168:171]
    ds_write_b32 v17, v62 offset:2560
    s_waitcnt vmcnt(12)
    v_mfma_f32_16x16x32_bf16 v[72:75], a[140:143], v[252:255], v[72:75]
    ds_write_b32 v17, v63 offset:2564
    v_mfma_f32_16x16x32_bf16 v[76:79], a[144:147], v[252:255], v[76:79]
    ds_write_b32 v17, v64 offset:3072
    v_mfma_f32_16x16x32_bf16 v[160:163], a[148:151], v[252:255], v[160:163]
    ds_write_b32 v17, v65 offset:3076
    v_mfma_f32_16x16x32_bf16 v[164:167], a[152:155], v[252:255], v[164:167]
    ds_write_b32 v17, v66 offset:3584
    v_mfma_f32_16x16x32_bf16 v[168:171], a[156:159], v[252:255], v[168:171]
    ds_write_b32 v17, v67 offset:3588
    s_lshl_b32 s69, s4, 2
    s_add_u32 s69, s69, s5
    s_and_b32 s69, s69, 127
    s_cmp_eq_u32 s69, 0
    s_cbranch_scc1 L_wb
    buffer_load_dword v10, v9, s[56:59], s74 offen
L_wbback:
    s_waitcnt vmcnt(12)
    v_mfma_f32_16x16x32_bf16 v[72:75], a[160:163], v[80:83], v[72:75]
    ds_write_b32 v17, v68 offset:4096
    v_mfma_f32_16x16x32_bf16 v[76:79], a[164:167], v[80:83], v[76:79]
    ds_write_b32 v17, v69 offset:4100
    v_mfma_f32_16x16x32_bf16 v[160:163], a[168:171], v[80:83], v[160:163]
    ds_write_b32 v17, v70 offset:4608
    v_mfma_f32_16x16x32_bf16 v[164:167], a[172:175], v[80:83], v[164:167]
    ds_write_b32 v17, v71 offset:4612
    v_mfma_f32_16x16x32_bf16 v[168:171], a[176:179], v[80:83], v[168:171]
    v_accvgpr_read_b32 v128, a240
    s_waitcnt vmcnt(11)
    v_mfma_f32_16x16x32_bf16 v[72:75], a[180:183], v[84:87], v[72:75]
    v_accvgpr_read_b32 v129, a241
    v_mfma_f32_16x16x32_bf16 v[76:79], a[184:187], v[84:87], v[76:79]
    v_accvgpr_read_b32 v130, a242
    v_mfma_f32_16x16x32_bf16 v[160:163], a[188:191], v[84:87], v[160:163]
    v_accvgpr_read_b32 v131, a243
    v_mfma_f32_16x16x32_bf16 v[164:167], a[192:195], v[84:87], v[164:167]
    v_accvgpr_read_b32 v132, a244
    v_mfma_f32_16x16x32_bf16 v[168:171], a[196:199], v[84:87], v[168:171]
    v_accvgpr_read_b32 v133, a245
    s_waitcnt vmcnt(10)
    v_mfma_f32_16x16x32_bf16 v[72:75], a[200:203], v[88:91], v[72:75]
    v_accvgpr_read_b32 v134, a246
    v_mfma_f32_16x16x32_bf16 v[76:79], a[204:207], v[88:91], v[76:79]
    v_accvgpr_read_b32 v135, a247
    v_mfma_f32_16x16x32_bf16 v[160:163], a[208:211], v[88:91], v[160:163]
    v_accvgpr_read_b32 v136, a248
    v_mfma_f32_16x16x32_bf16 v[164:167], a[212:215], v[88:91], v[164:167]
    v_accvgpr_read_b32 v137, a249
    v_mfma_f32_16x16x32_bf16 v[168:171], a[216:219], v[88:91], v[168:171]
    ds_read_b128 v[140:143], v12 offset:0
    s_waitcnt vmcnt(9)
    v_mfma_f32_16x16x32_bf16 v[72:75], a[220:223], v[92:95], v[72:75]
    ds_read_b128 v[144:147], v12 offset:16
    v_mfma_f32_16x16x32_bf16 v[76:79], a[224:227], v[92:95], v[76:79]
    ds_read_b128 v[148:151], v12 offset:128
    v_mfma_f32_16x16x32_bf16 v[160:163], a[228:231], v[92:95], v[160:163]
    ds_read_b128 v[152:155], v12 offset:144
    v_mfma_f32_16x16x32_bf16 v[164:167], a[232:235], v[92:95], v[164:167]
    ds_read_b128 v[156:159], v13 offset:256
    v_mfma_f32_16x16x32_bf16 v[168:171], a[236:239], v[92:95], v[168:171]
    s_waitcnt vmcnt(8)
    v_mfma_f32_16x16x32_bf16 v[172:175], a[80:83], v[96:99], v[172:175]
    v_lshlrev_b32 v32, 16, v128
    v_mfma_f32_16x16x32_bf16 v[176:179], a[84:87], v[96:99], v[176:179]
    v_and_b32 v33, s64, v128
    v_mfma_f32_16x16x32_bf16 v[180:183], a[88:91], v[96:99], v[180:183]
    v_lshlrev_b32 v34, 16, v129
    v_mfma_f32_16x16x32_bf16 v[184:187], a[92:95], v[96:99], v[184:187]
    v_and_b32 v35, s64, v129
    v_mfma_f32_16x16x32_bf16 v[188:191], a[96:99], v[96:99], v[188:191]
    ds_write_b32 v18, v72 offset:0
    v_lshlrev_b32 v36, 16, v130
    s_waitcnt vmcnt(7)
    v_mfma_f32_16x16x32_bf16 v[172:175], a[100:103], v[100:103], v[172:175]
    ds_write_b32 v18, v73 offset:4
    v_and_b32 v37, s64, v130
    v_mfma_f32_16x16x32_bf16 v[176:179], a[104:107], v[100:103], v[176:179]
    ds_write_b32 v18, v74 offset:512
    v_lshlrev_b32 v38, 16, v131
    v_mfma_f32_16x16x32_bf16 v[180:183], a[108:111], v[100:103], v[180:183]
    ds_write_b32 v18, v75 offset:516
    v_and_b32 v39, s64, v131
    v_mfma_f32_16x16x32_bf16 v[184:187], a[112:115], v[100:103], v[184:187]
    ds_write_b32 v18, v76 offset:1024
    v_lshlrev_b32 v40, 16, v132
    v_mfma_f32_16x16x32_bf16 v[188:191], a[116:119], v[100:103], v[188:191]
    ds_write_b32 v18, v77 offset:1028
    v_and_b32 v41, s64, v132
    s_waitcnt vmcnt(6)
    v_mfma_f32_16x16x32_bf16 v[172:175], a[120:123], v[104:107], v[172:175]
    ds_write_b32 v18, v78 offset:1536
    v_lshlrev_b32 v42, 16, v133
    v_mfma_f32_16x16x32_bf16 v[176:179], a[124:127], v[104:107], v[176:179]
    ds_write_b32 v18, v79 offset:1540
    v_and_b32 v43, s64, v133
    v_mfma_f32_16x16x32_bf16 v[180:183], a[128:131], v[104:107], v[180:183]
    ds_write_b32 v18, v160 offset:2048
    v_lshlrev_b32 v44, 16, v134
    v_mfma_f32_16x16x32_bf16 v[184:187], a[132:135], v[104:107], v[184:187]
    ds_write_b32 v18, v161 offset:2052
    v_and_b32 v45, s64, v134
    v_mfma_f32_16x16x32_bf16 v[188:191], a[136:139], v[104:107], v[188:191]
    ds_write_b32 v18, v162 offset:2560
    v_lshlrev_b32 v46, 16, v135
    s_waitcnt vmcnt(5)
    v_mfma_f32_16x16x32_bf16 v[172:175], a[140:143], v[108:111], v[172:175]
    ds_write_b32 v18, v163 offset:2564
    v_and_b32 v47, s64, v135
    v_mfma_f32_16x16x32_bf16 v[176:179], a[144:147], v[108:111], v[176:179]
    ds_write_b32 v18, v164 offset:3072
    v_lshlrev_b32 v48, 16, v136
    v_mfma_f32_16x16x32_bf16 v[180:183], a[148:151], v[108:111], v[180:183]
    ds_write_b32 v18, v165 offset:3076
    v_and_b32 v49, s64, v136
    v_mfma_f32_16x16x32_bf16 v[184:187], a[152:155], v[108:111], v[184:187]
    ds_write_b32 v18, v166 offset:3584
    v_lshlrev_b32 v50, 16, v137
    v_mfma_f32_16x16x32_bf16 v[188:191], a[156:159], v[108:111], v[188:191]
    ds_write_b32 v18, v167 offset:3588
    v_and_b32 v51, s64, v137
    s_waitcnt vmcnt(4)
    v_mfma_f32_16x16x32_bf16 v[172:175], a[160:163], v[112:115], v[172:175]
    ds_write_b32 v18, v168 offset:4096
    v_mfma_f32_16x16x32_bf16 v[176:179], a[164:167], v[112:115], v[176:179]
    ds_write_b32 v18, v169 offset:4100
    v_mfma_f32_16x16x32_bf16 v[180:183], a[168:171], v[112:115], v[180:183]
    ds_write_b32 v18, v170 offset:4608
    v_mfma_f32_16x16x32_bf16 v[184:187], a[172:175], v[112:115], v[184:187]
    ds_write_b32 v18, v171 offset:4612
    v_mfma_f32_16x16x32_bf16 v[188:191], a[176:179], v[112:115], v[188:191]
    s_waitcnt lgkmcnt(0)
    s_barrier
    s_waitcnt vmcnt(3)
    v_mfma_f32_16x16x32_bf16 v[172:175], a[180:183], v[116:119], v[172:175]
    ds_read_b64 v[192:193], v19 offset:0
    ds_read_b64 v[194:195], v19 offset:512
    v_mfma_f32_16x16x32_bf16 v[176:179], a[184:187], v[116:119], v[176:179]
    ds_read_b64 v[196:197], v19 offset:1024
    ds_read_b64 v[198:199], v19 offset:1536
    v_mfma_f32_16x16x32_bf16 v[180:183], a[188:191], v[116:119], v[180:183]
    ds_read_b64 v[200:201], v19 offset:2048
    ds_read_b64 v[202:203], v19 offset:2560
    v_mfma_f32_16x16x32_bf16 v[184:187], a[192:195], v[116:119], v[184:187]
    ds_read_b64 v[204:205], v19 offset:3072
    ds_read_b64 v[206:207], v19 offset:3584
    v_mfma_f32_16x16x32_bf16 v[188:191], a[196:199], v[116:119], v[188:191]
    ds_read_b64 v[208:209], v19 offset:4096
    ds_read_b64 v[210:211], v19 offset:4608
    s_waitcnt vmcnt(2)
    v_mfma_f32_16x16x32_bf16 v[172:175], a[200:203], v[120:123], v[172:175]
    ds_read_b64 v[212:213], v19 offset:5120
    ds_read_b64 v[214:215], v19 offset:5632
    v_mfma_f32_16x16x32_bf16 v[176:179], a[204:207], v[120:123], v[176:179]
    ds_read_b64 v[216:217], v19 offset:6144
    ds_read_b64 v[218:219], v19 offset:6656
    v_mfma_f32_16x16x32_bf16 v[180:183], a[208:211], v[120:123], v[180:183]
    ds_read_b64 v[220:221], v19 offset:7168
    ds_read_b64 v[222:223], v19 offset:7680
    v_mfma_f32_16x16x32_bf16 v[184:187], a[212:215], v[120:123], v[184:187]
    ds_read_b64 v[224:225], v19 offset:8192
    ds_read_b64 v[226:227], v19 offset:8704
    v_mfma_f32_16x16x32_bf16 v[188:191], a[216:219], v[120:123], v[188:191]
    ds_read_b64 v[228:229], v19 offset:9216
    ds_read_b64 v[230:231], v19 offset:9728
    s_waitcnt vmcnt(1)
    v_mfma_f32_16x16x32_bf16 v[172:175], a[220:223], v[124:127], v[172:175]
    ds_read_b64 v[232:233], v19 offset:10240
    ds_read_b64 v[234:235], v19 offset:10752
    v_mfma_f32_16x16x32_bf16 v[176:179], a[224:227], v[124:127], v[176:179]
    ds_read_b64 v[236:237], v19 offset:11264
    ds_read_b64 v[238:239], v19 offset:11776
    v_mfma_f32_16x16x32_bf16 v[180:183], a[228:231], v[124:127], v[180:183]
    ds_read_b64 v[240:241], v19 offset:12288
    ds_read_b64 v[242:243], v19 offset:12800
    v_mfma_f32_16x16x32_bf16 v[184:187], a[232:235], v[124:127], v[184:187]
    ds_read_b64 v[244:245], v19 offset:13312
    ds_read_b64 v[246:247], v19 offset:13824
    v_mfma_f32_16x16x32_bf16 v[188:191], a[236:239], v[124:127], v[188:191]
    ds_read_b64 v[248:249], v19 offset:14336
    ds_read_b64 v[250:251], v19 offset:14848
    s_waitcnt lgkmcnt(10)
    v_pk_add_f32 v[192:193], v[192:193], v[212:213]
    v_pk_add_f32 v[194:195], v[194:195], v[214:215]
    v_pk_add_f32 v[196:197], v[196:197], v[216:217]
    v_pk_add_f32 v[198:199], v[198:199], v[218:219]
    v_pk_add_f32 v[200:201], v[200:201], v[220:221]
    v_pk_add_f32 v[202:203], v[202:203], v[222:223]
    v_pk_add_f32 v[204:205], v[204:205], v[224:225]
    v_pk_add_f32 v[206:207], v[206:207], v[226:227]
    v_pk_add_f32 v[208:209], v[208:209], v[228:229]
    v_pk_add_f32 v[210:211], v[210:211], v[230:231]
    v_pk_add_f32 v[192:193], v[192:193], v[172:173]
    v_pk_add_f32 v[194:195], v[194:195], v[174:175]
    v_pk_add_f32 v[196:197], v[196:197], v[176:177]
    v_pk_add_f32 v[198:199], v[198:199], v[178:179]
    v_pk_add_f32 v[200:201], v[200:201], v[180:181]
    v_pk_add_f32 v[202:203], v[202:203], v[182:183]
    v_pk_add_f32 v[204:205], v[204:205], v[184:185]
    v_pk_add_f32 v[206:207], v[206:207], v[186:187]
    v_pk_add_f32 v[208:209], v[208:209], v[188:189]
    v_pk_add_f32 v[210:211], v[210:211], v[190:191]
    s_waitcnt lgkmcnt(0)
    v_pk_add_f32 v[192:193], v[192:193], v[232:233]
    v_pk_add_f32 v[194:195], v[194:195], v[234:235]
    v_pk_add_f32 v[196:197], v[196:197], v[236:237]
    v_pk_add_f32 v[198:199], v[198:199], v[238:239]
    v_pk_fma_f32 v[192:193], v[192:193], v[140:141], v[32:33]
    v_pk_fma_f32 v[194:195], v[194:195], v[142:143], v[34:35]
    v_pk_fma_f32 v[196:197], v[196:197], v[144:145], v[36:37]
    v_pk_fma_f32 v[198:199], v[198:199], v[146:147], v[38:39]
    v_cvt_pk_bf16_f32 v128, v192, v193
    v_cvt_pk_bf16_f32 v129, v194, v195
    v_cvt_pk_bf16_f32 v130, v196, v197
    v_cvt_pk_bf16_f32 v131, v198, v199
    buffer_store_dwordx4 v[128:131], v8, s[40:43], s68 offen offset:0
    v_pk_add_f32 v[200:201], v[200:201], v[240:241]
    v_pk_add_f32 v[202:203], v[202:203], v[242:243]
    v_pk_add_f32 v[204:205], v[204:205], v[244:245]
    v_pk_add_f32 v[206:207], v[206:207], v[246:247]
    v_pk_fma_f32 v[200:201], v[200:201], v[148:149], v[40:41]
    v_pk_fma_f32 v[202:203], v[202:203], v[150:151], v[42:43]
    v_pk_fma_f32 v[204:205], v[204:205], v[152:153], v[44:45]
    v_pk_fma_f32 v[206:207], v[206:207], v[154:155], v[46:47]
    v_cvt_pk_bf16_f32 v132, v200, v201
    v_cvt_pk_bf16_f32 v133, v202, v203
    v_cvt_pk_bf16_f32 v134, v204, v205
    v_cvt_pk_bf16_f32 v135, v206, v207
    buffer_store_dwordx4 v[132:135], v8, s[40:43], s68 offen offset:64
    v_pk_add_f32 v[208:209], v[208:209], v[248:249]
    v_pk_add_f32 v[210:211], v[210:211], v[250:251]
    v_pk_fma_f32 v[208:209], v[208:209], v[156:157], v[48:49]
    v_pk_fma_f32 v[210:211], v[210:211], v[158:159], v[50:51]
    v_cvt_pk_bf16_f32 v136, v208, v209
    v_cvt_pk_bf16_f32 v137, v210, v211
    buffer_store_dwordx2 v[136:137], v7, s[40:43], s68 offen offset:128
L_end:
    s_endpgm
L_ldr2:
    s_sleep 4
    buffer_load_dword v125, v123, s[52:55], 0 offen sc1
    s_sub_u32 s7, s7, 1
    s_waitcnt vmcnt(0)
    s_cbranch_scc0 L_ldr
    s_endpgm
L_kvslow:
    buffer_store_dwordx4 v[104:107], v23, s[56:59], s77 offen sc1
    buffer_store_dwordx4 v[108:111], v23, s[56:59], s80 offen sc1
    s_cmp_ge_u32 s5, 2
    s_cbranch_scc1 L_kvp2
    s_add_u32 s69, s77, 196608
    s_add_u32 s70, s80, 196608
    buffer_store_dwordx4 v[112:115], v23, s[56:59], s69 offen sc1
    buffer_store_dwordx4 v[116:119], v23, s[56:59], s70 offen sc1
L_kvp2:
    s_waitcnt vmcnt(0)
    buffer_store_dword v0, v120, s[56:59], s78 offen offset:128 sc1
    s_branch L_kvback
L_l1else:
    s_cmp_lg_u32 s6, 1
    s_cselect_b32 s70, 0, vcc_lo
    s_or_b32 s70, s70, vcc_hi
    s_cmp_eq_u32 s70, -1
    s_cbranch_scc1 L_l1mixed
    buffer_load_dword v10, v121, s[56:59], s72 offen sc1
    s_sub_u32 s7, s7, 1
    s_waitcnt vmcnt(0)
    s_cbranch_scc0 L_l1chk
    s_endpgm
L_l1mixed:
    s_cmp_lg_u32 s6, 1
    s_cbranch_scc1 L_l1ok
    s_mov_b32 s6, 2
    buffer_store_dwordx4 v[104:107], v23, s[56:59], s77 offen sc1
    buffer_store_dwordx4 v[108:111], v23, s[56:59], s80 offen sc1
    s_cmp_ge_u32 s5, 2
    s_cbranch_scc1 L_kvp3
    s_add_u32 s69, s77, 196608
    s_add_u32 s70, s80, 196608
    buffer_store_dwordx4 v[112:115], v23, s[56:59], s69 offen sc1
    buffer_store_dwordx4 v[116:119], v23, s[56:59], s70 offen sc1
L_kvp3:
    s_waitcnt vmcnt(0)
    buffer_store_dword v0, v120, s[56:59], s78 offen offset:128 sc1
    s_branch L_l1ok
Lapoll_1:
    buffer_load_dword v123, v122, s[56:59], s38 offen sc1
    s_waitcnt vmcnt(0)
    v_cmp_ne_u32 vcc, s36, v123
    s_cbranch_vccz Lok_2
    s_sleep 1
    s_sub_u32 s7, s7, 1
    s_cbranch_scc0 Lapoll_1
    s_endpgm
Lapoll_3:
    buffer_load_dword v123, v122, s[56:59], s38 offen sc1
    s_waitcnt vmcnt(0)
    v_cmp_ne_u32 vcc, s36, v123
    s_cbranch_vccz Lok_4
    s_sleep 1
    s_sub_u32 s7, s7, 1
    s_cbranch_scc0 Lapoll_3
    s_endpgm
L_prmagain:
    s_sleep 8
    s_add_u32 s69, s38, 0
    buffer_load_dwordx4 v[32:35], v244, s[56:59], s69 offen sc1
    buffer_load_dwordx4 v[36:39], v245, s[56:59], s69 offen sc1
    s_add_u32 s69, s38, 15360
    buffer_load_dwordx4 v[40:43], v244, s[56:59], s69 offen sc1
    buffer_load_dwordx4 v[44:47], v245, s[56:59], s69 offen sc1
    s_add_u32 s69, s38, 30720
    buffer_load_dwordx4 v[48:51], v244, s[56:59], s69 offen sc1
    buffer_load_dwordx4 v[52:55], v245, s[56:59], s69 offen sc1
    s_add_u32 s69, s38, 46080
    buffer_load_dwordx4 v[56:59], v244, s[56:59], s69 offen sc1
    buffer_load_dwordx4 v[60:63], v245, s[56:59], s69 offen sc1
    s_add_u32 s69, s38, 61440
    buffer_load_dwordx4 v[64:67], v244, s[56:59], s69 offen sc1
    buffer_load_dwordx4 v[68:71], v245, s[56:59], s69 offen sc1
    s_add_u32 s69, s38, 76800
    buffer_load_dwordx4 v[72:75], v244, s[56:59], s69 offen sc1
    buffer_load_dwordx4 v[76:79], v245, s[56:59], s69 offen sc1
    s_add_u32 s69, s38, 92160
    buffer_load_dwordx4 v[80:83], v244, s[56:59], s69 offen sc1
    buffer_load_dwordx4 v[84:87], v245, s[56:59], s69 offen sc1
    s_add_u32 s69, s38, 107520
    buffer_load_dwordx4 v[88:91], v244, s[56:59], s69 offen sc1
    buffer_load_dwordx4 v[92:95], v245, s[56:59], s69 offen sc1
    buffer_load_dwordx4 v[96:99], v2, s[56:59], s101 offen sc1
    s_sub_u32 s7, s7, 1
    s_waitcnt vmcnt(0)
    s_cbranch_scc0 L_prmchk
    s_endpgm
L_st1again:
    buffer_load_dwordx4 v[96:99], v2, s[56:59], s101 offen sc1
    s_sub_u32 s7, s7, 1
    s_waitcnt vmcnt(0)
    s_cbranch_scc0 L_st1chk
    s_endpgm
Lslow_11:
    buffer_store_dwordx4 v[28:31], v10, s[56:59], s74 offen sc1
    s_branch Lback_12
Lapoll_13:
    buffer_load_dword v238, v236, s[56:59], s38 offen sc1
    s_waitcnt vmcnt(0)
    v_cmp_ne_u32 vcc, s36, v238
    s_cbranch_vccz Lok_14
    s_sleep 1
    s_sub_u32 s7, s7, 1
    s_cbranch_scc0 Lapoll_13
    s_endpgm
Lslow_15:
    buffer_store_dwordx2 v[150:151], v30, s[56:59], s77 offen sc1
    s_branch Lback_16
Lslow_19:
    buffer_store_dwordx4 v[192:195], v2, s[56:59], s72 offen sc1
    s_branch Lback_20
Lslow_21:
    buffer_store_dwordx4 v[196:199], v2, s[56:59], s72 offen offset:1024 sc1
    buffer_store_dwordx2 v[200:201], v12, s[56:59], s72 offen offset:2048 sc1
    s_branch Lback_22
Lslow_23:
    buffer_store_dword v0, v11, s[56:59], s81 offen sc1
    s_branch Lback_24
Lslow_27:
    buffer_store_dwordx2 v[150:151], v30, s[56:59], s77 offen sc1
    s_branch Lback_28
Lslow_31:
    buffer_store_dwordx4 v[192:195], v2, s[56:59], s72 offen sc1
    s_branch Lback_32
Lslow_33:
    buffer_store_dwordx4 v[196:199], v2, s[56:59], s72 offen offset:1024 sc1
    buffer_store_dwordx2 v[200:201], v12, s[56:59], s72 offen offset:2048 sc1
    s_branch Lback_34
Lslow_35:
    buffer_store_dword v0, v11, s[56:59], s81 offen sc1
    s_branch Lback_36
Lslow_39:
    buffer_store_dword v0, v11, s[56:59], s14 offen sc1
    s_branch Lback_40
Lslow_41:
    buffer_store_dwordx4 v[160:163], v2, s[56:59], s75 offen sc1
    s_branch Lback_42
Lslow_43:
    buffer_store_dwordx4 v[164:167], v23, s[56:59], s75 offen sc1
    s_branch Lback_44
Lslow_45:
    buffer_store_dword v0, v11, s[56:59], s73 offen sc1
    s_branch Lback_46
Lslow_47:
    buffer_store_dwordx4 v[192:195], v2, s[56:59], s80 offen sc1
    s_branch Lback_48
Lslow_49:
    buffer_store_dwordx4 v[196:199], v23, s[56:59], s80 offen sc1
    s_branch Lback_50
Lapoll_51:
    buffer_load_dword v25, v28, s[56:59], s13 offen sc1
    s_waitcnt vmcnt(0)
    v_cmp_ne_u32 vcc, s36, v25
    s_cbranch_vccz Lok_52
    s_sub_u32 s7, s7, 1
    s_cbranch_scc0 Lapoll_51
    s_endpgm
Lslow_53:
    buffer_store_dwordx4 v[224:227], v2, s[56:59], s12 offen sc1
    s_branch Lback_54
Lslow_55:
    buffer_store_dwordx4 v[228:231], v23, s[56:59], s12 offen sc1
    s_branch Lback_56
Lapoll_57:
    buffer_load_dword v24, v9, s[56:59], s74 offen sc1
    s_waitcnt vmcnt(0)
    v_cmp_ne_u32 vcc, s36, v24
    s_cbranch_vccz Lok_58
    s_sub_u32 s7, s7, 1
    s_cbranch_scc0 Lapoll_57
    s_endpgm
Lslow_59:
    buffer_store_dword v0, v11, s[56:59], s72 offen sc1
    s_branch Lback_60
Lapoll_61:
    buffer_load_dword v24, v9, s[56:59], s38 offen sc1
    s_waitcnt vmcnt(0)
    v_cmp_ne_u32 vcc, s36, v24
    s_cbranch_vccz Lok_62
    s_sub_u32 s7, s7, 1
    s_cbranch_scc0 Lapoll_61
    s_endpgm
L_wb:
    buffer_wbl2 sc1
    s_branch L_wbback
L_codeend:
.section .rodata,"a"
.p2align 6
.amdhsa_kernel adaLN_cond__ssm_conv_h3__glu_gated_reglu__prompt_kernel
  .amdhsa_next_free_vgpr 512
  .amdhsa_next_free_sgpr 102
  .amdhsa_accum_offset 256
  .amdhsa_group_segment_fixed_size 0
  .amdhsa_kernarg_size 120
  .amdhsa_user_sgpr_count 2
  .amdhsa_user_sgpr_kernarg_segment_ptr 1
  .amdhsa_system_sgpr_workgroup_id_x 1
  .amdhsa_float_denorm_mode_32 3
.end_amdhsa_kernel
```
